```python
import torch

def _softmax(x, axis=-1):
    return torch.softmax(x, dim=axis)
def _gelu(x):
    return torch.nn.functional.gelu(x, approximate="tanh")
def _silu(x):
    return torch.nn.functional.silu(x)
def _sigmoid(x):
    return torch.sigmoid(x)
def _layernorm(x, axis=-1, eps=1e-5):
    m = x.mean(dim=axis, keepdim=True)
    v = x.var(dim=axis, keepdim=True, unbiased=False)
    return (x - m) / torch.sqrt(v + eps)
def _scatter_add(tgt, idx, src, axis=0):
    return tgt.clone().index_add_(axis, idx, src)
def _segment_sum(src, seg, n):
    out = torch.zeros((n,) + src.shape[1:], dtype=src.dtype)
    return out.index_add_(0, seg, src)
def _pad(x, pw):
    flat = tuple(v for pair in reversed(pw) for v in pair)
    return torch.nn.functional.pad(x, flat)

kernel_name = 'interleave_layers__grouped_kv_mqa__dense_activation_silu__prompt'

def setup_inputs():

    _w = (lambda a: (lambda t: t.to(torch.bfloat16) if t.is_floating_point() else t)(torch.as_tensor(a)))
    def _A_setup():
        B, S, D, H = 1, 2048, 512, 32
        Dh = D // H
        return {
            "x": _w((lambda *s: torch.randn(*s, dtype=torch.bfloat16) * 0.05)(B, S, D)),
            "wq": _w((lambda *s: torch.randn(*s, dtype=torch.bfloat16) * 0.05)(D, H * Dh)),
            "wk": _w((lambda *s: torch.randn(*s, dtype=torch.bfloat16) * 0.05)(D, Dh)),
            "wv": _w((lambda *s: torch.randn(*s, dtype=torch.bfloat16) * 0.05)(D, Dh)),
            "wo": _w((lambda *s: torch.randn(*s, dtype=torch.bfloat16) * 0.05)(H * Dh, D)),
        }
    _A_in = _A_setup()

    def _B_setup():
        B, S, D, F = 1, 2048, 512, 1376
        return {
            "x": _w((lambda *s: torch.randn(*s, dtype=torch.bfloat16) * 0.05)(B, S, D)),
            "w1": _w((lambda *s: torch.randn(*s, dtype=torch.bfloat16) * 1.6)(D, F) * (D ** -0.5)),
            "w2": _w((lambda *s: torch.randn(*s, dtype=torch.bfloat16) * 0.2)(F, D) * (F ** -0.5)),
        }
    _B_in = _B_setup()

    return {
        "A_x": _A_in["x"],
        "A_wq": _A_in["wq"],
        "A_wk": _A_in["wk"],
        "A_wv": _A_in["wv"],
        "A_wo": _A_in["wo"],
        "B_x": _B_in["x"],
        "B_w1": _B_in["w1"],
        "B_w2": _B_in["w2"],
    }

def reference(A_x, A_wq, A_wk, A_wv, A_wo, B_x, B_w1, B_w2):
    def _A_ref(x, wq, wk, wv, wo):
        B, S, D = x.shape
        H = 32
        Dh = D // H
        q = (lambda x, *d: x.permute(*d))((x @ wq).reshape(B, S, H, Dh), 0, 2, 1, 3)
        k = x @ wk
        v = x @ wv
        scores = torch.einsum("bhqd,bkd->bhqk", q, k) * (Dh ** -0.5)
        p = _softmax(scores, axis=-1)
        o = torch.einsum("bhqk,bkd->bhqd", p, v)
        return (lambda x, *d: x.permute(*d))(o, 0, 2, 1, 3).reshape(B, S, H * Dh) @ wo

    def _B_ref(x, w1, w2):
        h = torch.einsum("bsd,df->bsf", x, w1)
        h = _silu(h)
        out = torch.einsum("bsf,fd->bsd", h, w2)
        return out

    x = A_x
    x = x + _A_ref(_layernorm(x, axis=-1), A_wq, A_wk, A_wv, A_wo)
    x = x + _B_ref(_layernorm(x, axis=-1), B_w1, B_w2)
    x = x + _A_ref(_layernorm(x, axis=-1), A_wq, A_wk, A_wv, A_wo)
    x = x + _B_ref(_layernorm(x, axis=-1), B_w1, B_w2)
    return x
```

```asm
; @launch grid=(256,1,1) block=(256,1,1) lds=162816
.amdgcn_target "amdgcn-amd-amdhsa--gfx950"
.text
.globl interleave_layers__grouped_kv_mqa__dense_activation_silu__prompt_kernel
.p2align 8
.type interleave_layers__grouped_kv_mqa__dense_activation_silu__prompt_kernel,@function
interleave_layers__grouped_kv_mqa__dense_activation_silu__prompt_kernel:
    s_cmp_ge_u32 s2, 256
    s_cbranch_scc1 L_end_1
    s_load_dwordx16 s[16:31], s[0:1], 0
    s_load_dwordx2 s[32:33], s[0:1], 80
    s_load_dwordx2 s[34:35], s[0:1], 64
    s_load_dwordx2 s[66:67], s[0:1], 72
    s_memrealtime s[64:65]
    v_lshrrev_b32 v1, 6, v0
    s_and_b32 s4, s2, 7
    v_readfirstlane_b32 s3, v1
    s_lshl_b32 s4, s4, 5
    s_lshr_b32 s5, s2, 3
    s_add_u32 s4, s4, s5
    s_lshr_b32 s5, s4, 3
    s_and_b32 s6, s4, 7
    s_mov_b32 s7, 0
    s_mov_b32 s56, 1
    v_and_b32 v1, 63, v0
    v_lshlrev_b32 v2, 4, v1
    v_mov_b32 v6, 0
    v_mov_b32 v7, 0
    s_getpc_b64 s[52:53]
L_pcref:
    s_sub_u32 s52, s52, L_pcref-interleave_layers__grouped_kv_mqa__dense_activation_silu__prompt_kernel
    s_subb_u32 s53, s53, 0
    s_cmp_lg_u32 s3, 3
    s_cbranch_scc1 L_nocp_5
    s_lshr_b32 s42, s2, 3
    s_lshl_b32 s42, s42, 7
    v_lshlrev_b32 v0, 12, v1
    v_add_u32 v0, s42, v0
    v_min_u32 v0, L_code_end-interleave_layers__grouped_kv_mqa__dense_activation_silu__prompt_kernel-4, v0
    s_mov_b64 exec, 0xffff
    global_load_dword v87, v0, s[52:53]
    s_mov_b64 exec, -1
L_nocp_5:
    v_and_b32 v3, 15, v1
    v_lshrrev_b32 v4, 4, v1
    s_lshl_b32 s39, s5, 16
    s_lshl_b32 s45, s3, 14
    s_add_u32 s39, s39, s45
    s_lshr_b32 s38, s39, 4
    s_mov_b32 s47, 0x3f803f80
    s_and_b32 s42, s6, 1
    s_add_u32 s42, s42, 1
    s_lshr_b32 s48, s6, 1
    s_cmp_eq_u32 s48, s3
    s_cselect_b32 s60, s42, 0
    v_mov_b32 v120, 0x3f803f80
    v_mov_b32 v121, 0x3f803f80
    v_mov_b32 v122, 0x3f803f80
    v_mov_b32 v123, 0x3f803f80
    v_lshlrev_b32 v84, 1, v4
    v_xor_b32 v84, v84, v3
    v_lshlrev_b32 v84, 4, v84
    v_lshl_add_u32 v84, v3, 10, v84
    v_add_u32 v84, s45, v84
    v_xor_b32 v80, 0, v84
    v_xor_b32 v81, 16, v84
    v_xor_b32 v82, 128, v84
    v_xor_b32 v83, 144, v84
    s_and_b32 s42, s6, 1
    s_lshl_b32 s42, s42, 7
    v_xor_b32 v85, s42, v84
    s_lshr_b32 s42, s6, 1
    s_lshl_b32 s42, s42, 8
    v_add_u32 v85, s42, v85
    v_xor_b32 v86, 16, v85
    v_lshrrev_b32 v5, 2, v3
    v_lshlrev_b32 v164, 11, v4
    v_lshl_add_u32 v164, v5, 7, v164
    v_and_b32 v9, 3, v3
    v_lshl_add_u32 v164, v9, 3, v164
    v_lshrrev_b32 v5, 1, v5
    v_lshl_add_u32 v164, v5, 5, v164
    v_and_b32 v5, 1, v4
    v_lshl_add_u32 v164, v5, 6, v164
    s_lshl_b32 s42, s3, 5
    v_xor_b32 v164, s42, v164
    v_add_u32 v164, 69632, v164
    v_lshlrev_b32 v165, 3, v3
    v_add_u32 v165, 159808, v165
    s_waitcnt lgkmcnt(0)
    s_mov_b32 s8, s32
    s_and_b32 s9, s33, 0xffff
    s_mov_b32 s10, 14680064
    s_mov_b32 s11, 0x20000
    s_mov_b32 s12, s16
    s_and_b32 s13, s17, 0xffff
    s_mov_b32 s14, 2097152
    s_mov_b32 s15, 0x20000
    s_add_u32 s42, s2, s3
    s_cmp_lg_u32 s42, 0
    s_cbranch_scc1 L_nononce_6
    s_or_b32 s64, s64, 1
    v_mov_b32 v12, s64
    v_mov_b32 v13, s65
    s_mov_b64 exec, 1
    global_store_dwordx2 v6, v[12:13], s[66:67] sc1
    s_mov_b64 exec, -1
L_nononce_6:
    s_cmp_lg_u32 s60, 0
    s_cbranch_scc1 L_kvwave_3
    s_mov_b32 s48, s18
    s_and_b32 s49, s19, 0xffff
    s_mov_b32 s50, 524288
    s_mov_b32 s51, 0x20000
    s_lshr_b32 s42, s6, 1
    s_cmp_gt_u32 s3, s42
    s_cselect_b32 s42, 1, 0
    s_sub_u32 s46, s3, s42
    v_lshlrev_b32 v0, 7, v1
    s_cmp_lg_u32 s46, 2
    s_cbranch_scc1 L_tq_7
    s_lshl_b32 s42, s4, 13
    buffer_load_dword v87, v0, s[12:15], s42 offen
    s_branch L_td_8
L_tq_7:
    s_lshr_b32 s42, s2, 3
    s_lshl_b32 s42, s42, 1
    s_add_u32 s42, s42, s46
    s_lshl_b32 s42, s42, 13
    buffer_load_dword v87, v0, s[48:51], s42 offen
L_td_8:
    s_waitcnt vmcnt(0)
    v_xor_b32 v0, 0, v2
    s_add_u32 m0, s45, 0
    s_add_u32 s42, s39, 0
    buffer_load_dwordx4 v0, s[12:15], s42 offen offset:0 lds
    v_xor_b32 v0, 16, v2
    buffer_load_dwordx4 v0, s[12:15], s42 offen offset:1024 lds
    v_xor_b32 v0, 32, v2
    buffer_load_dwordx4 v0, s[12:15], s42 offen offset:2048 lds
    v_xor_b32 v0, 48, v2
    buffer_load_dwordx4 v0, s[12:15], s42 offen offset:3072 lds
    v_xor_b32 v0, 64, v2
    s_add_u32 m0, s45, 4096
    s_add_u32 s42, s39, 4096
    buffer_load_dwordx4 v0, s[12:15], s42 offen offset:0 lds
    v_xor_b32 v0, 80, v2
    buffer_load_dwordx4 v0, s[12:15], s42 offen offset:1024 lds
    v_xor_b32 v0, 96, v2
    buffer_load_dwordx4 v0, s[12:15], s42 offen offset:2048 lds
    v_xor_b32 v0, 112, v2
    buffer_load_dwordx4 v0, s[12:15], s42 offen offset:3072 lds
    v_xor_b32 v0, 128, v2
    s_add_u32 m0, s45, 8192
    s_add_u32 s42, s39, 8192
    buffer_load_dwordx4 v0, s[12:15], s42 offen offset:0 lds
    v_xor_b32 v0, 144, v2
    buffer_load_dwordx4 v0, s[12:15], s42 offen offset:1024 lds
    v_xor_b32 v0, 160, v2
    buffer_load_dwordx4 v0, s[12:15], s42 offen offset:2048 lds
    v_xor_b32 v0, 176, v2
    buffer_load_dwordx4 v0, s[12:15], s42 offen offset:3072 lds
    v_xor_b32 v0, 192, v2
    s_add_u32 m0, s45, 12288
    s_add_u32 s42, s39, 12288
    buffer_load_dwordx4 v0, s[12:15], s42 offen offset:0 lds
    v_xor_b32 v0, 208, v2
    buffer_load_dwordx4 v0, s[12:15], s42 offen offset:1024 lds
    v_xor_b32 v0, 224, v2
    buffer_load_dwordx4 v0, s[12:15], s42 offen offset:2048 lds
    v_xor_b32 v0, 240, v2
    buffer_load_dwordx4 v0, s[12:15], s42 offen offset:3072 lds
    s_mul_i32 s46, s46, 22
    s_min_u32 s46, s46, 42
    v_lshrrev_b32 v5, 3, v1
    v_and_b32 v9, 2, v5
    v_and_b32 v10, 7, v1
    v_xor_b32 v9, v9, v10
    v_lshlrev_b32 v9, 4, v9
    v_lshl_add_u32 v9, v5, 10, v9
    s_lshl_b32 s42, s46, 5
    s_and_b32 s42, s42, 64
    v_xor_b32 v9, s42, v9
    v_xor_b32 v10, 64, v9
    s_lshl_b32 s40, s46, 13
    s_lshl_b32 s42, s6, 7
    s_add_u32 s40, s40, s42
    s_lshl_b32 s41, s46, 10
    s_add_u32 m0, s41, 69632
    s_add_u32 s42, s40, 0
    buffer_load_dwordx4 v9, s[48:51], s42 offen lds
    s_add_u32 m0, s41, 70656
    s_add_u32 s42, s40, 8192
    buffer_load_dwordx4 v9, s[48:51], s42 offen lds
    s_add_u32 m0, s41, 71680
    s_add_u32 s42, s40, 16384
    buffer_load_dwordx4 v10, s[48:51], s42 offen lds
    s_add_u32 m0, s41, 72704
    s_add_u32 s42, s40, 24576
    buffer_load_dwordx4 v10, s[48:51], s42 offen lds
    s_add_u32 m0, s41, 73728
    s_add_u32 s42, s40, 32768
    buffer_load_dwordx4 v9, s[48:51], s42 offen lds
    s_add_u32 m0, s41, 74752
    s_add_u32 s42, s40, 40960
    buffer_load_dwordx4 v9, s[48:51], s42 offen lds
    global_load_dwordx2 v[12:13], v6, s[66:67] sc1
    s_waitcnt vmcnt(7)
    ds_read_b128 v[16:19], v80 offset:0
    ds_read_b128 v[20:23], v81 offset:0
    ds_read_b128 v[24:27], v82 offset:0
    ds_read_b128 v[28:31], v83 offset:0
    ds_read_b128 v[32:35], v80 offset:256
    ds_read_b128 v[36:39], v81 offset:256
    ds_read_b128 v[40:43], v82 offset:256
    ds_read_b128 v[44:47], v83 offset:256
    ds_read_b128 v[48:51], v80 offset:512
    ds_read_b128 v[52:55], v81 offset:512
    ds_read_b128 v[56:59], v82 offset:512
    ds_read_b128 v[60:63], v83 offset:512
    ds_read_b128 v[64:67], v80 offset:768
    ds_read_b128 v[68:71], v81 offset:768
    ds_read_b128 v[72:75], v82 offset:768
    ds_read_b128 v[76:79], v83 offset:768
    ds_read_b128 v[112:115], v85
    ds_read_b128 v[116:119], v86
    v_mov_b32 v144, 0
    v_mov_b32 v145, 0
    v_mov_b32 v146, 0
    v_mov_b32 v147, 0
    s_waitcnt lgkmcnt(15)
    v_dot2_f32_bf16 v144, v16, s47, v144
    v_dot2_f32_bf16 v145, v16, v16, v145
    v_dot2_f32_bf16 v146, v17, s47, v146
    v_dot2_f32_bf16 v147, v17, v17, v147
    v_dot2_f32_bf16 v144, v18, s47, v144
    v_dot2_f32_bf16 v145, v18, v18, v145
    v_dot2_f32_bf16 v146, v19, s47, v146
    v_dot2_f32_bf16 v147, v19, v19, v147
    s_add_u32 m0, s41, 75776
    s_add_u32 s42, s40, 49152
    buffer_load_dwordx4 v10, s[48:51], s42 offen lds
    v_dot2_f32_bf16 v144, v20, s47, v144
    v_dot2_f32_bf16 v145, v20, v20, v145
    v_dot2_f32_bf16 v146, v21, s47, v146
    v_dot2_f32_bf16 v147, v21, v21, v147
    v_dot2_f32_bf16 v144, v22, s47, v144
    v_dot2_f32_bf16 v145, v22, v22, v145
    v_dot2_f32_bf16 v146, v23, s47, v146
    v_dot2_f32_bf16 v147, v23, v23, v147
    s_add_u32 m0, s41, 76800
    s_add_u32 s42, s40, 57344
    buffer_load_dwordx4 v10, s[48:51], s42 offen lds
    v_dot2_f32_bf16 v144, v24, s47, v144
    v_dot2_f32_bf16 v145, v24, v24, v145
    v_dot2_f32_bf16 v146, v25, s47, v146
    v_dot2_f32_bf16 v147, v25, v25, v147
    v_dot2_f32_bf16 v144, v26, s47, v144
    v_dot2_f32_bf16 v145, v26, v26, v145
    v_dot2_f32_bf16 v146, v27, s47, v146
    v_dot2_f32_bf16 v147, v27, v27, v147
    s_add_u32 m0, s41, 77824
    s_add_u32 s42, s40, 65536
    buffer_load_dwordx4 v9, s[48:51], s42 offen lds
    s_waitcnt lgkmcnt(14)
    v_dot2_f32_bf16 v144, v28, s47, v144
    v_dot2_f32_bf16 v145, v28, v28, v145
    v_dot2_f32_bf16 v146, v29, s47, v146
    v_dot2_f32_bf16 v147, v29, v29, v147
    v_dot2_f32_bf16 v144, v30, s47, v144
    v_dot2_f32_bf16 v145, v30, v30, v145
    v_dot2_f32_bf16 v146, v31, s47, v146
    v_dot2_f32_bf16 v147, v31, v31, v147
    s_add_u32 m0, s41, 78848
    s_add_u32 s42, s40, 73728
    buffer_load_dwordx4 v9, s[48:51], s42 offen lds
    s_waitcnt lgkmcnt(13)
    v_dot2_f32_bf16 v144, v32, s47, v144
    v_dot2_f32_bf16 v145, v32, v32, v145
    v_dot2_f32_bf16 v146, v33, s47, v146
    v_dot2_f32_bf16 v147, v33, v33, v147
    v_dot2_f32_bf16 v144, v34, s47, v144
    v_dot2_f32_bf16 v145, v34, v34, v145
    v_dot2_f32_bf16 v146, v35, s47, v146
    v_dot2_f32_bf16 v147, v35, v35, v147
    s_add_u32 m0, s41, 79872
    s_add_u32 s42, s40, 81920
    buffer_load_dwordx4 v10, s[48:51], s42 offen lds
    s_waitcnt lgkmcnt(12)
    v_dot2_f32_bf16 v144, v36, s47, v144
    v_dot2_f32_bf16 v145, v36, v36, v145
    v_dot2_f32_bf16 v146, v37, s47, v146
    v_dot2_f32_bf16 v147, v37, v37, v147
    v_dot2_f32_bf16 v144, v38, s47, v144
    v_dot2_f32_bf16 v145, v38, v38, v145
    v_dot2_f32_bf16 v146, v39, s47, v146
    v_dot2_f32_bf16 v147, v39, v39, v147
    s_add_u32 m0, s41, 80896
    s_add_u32 s42, s40, 90112
    buffer_load_dwordx4 v10, s[48:51], s42 offen lds
    s_waitcnt lgkmcnt(11)
    v_dot2_f32_bf16 v144, v40, s47, v144
    v_dot2_f32_bf16 v145, v40, v40, v145
    v_dot2_f32_bf16 v146, v41, s47, v146
    v_dot2_f32_bf16 v147, v41, v41, v147
    v_dot2_f32_bf16 v144, v42, s47, v144
    v_dot2_f32_bf16 v145, v42, v42, v145
    v_dot2_f32_bf16 v146, v43, s47, v146
    v_dot2_f32_bf16 v147, v43, v43, v147
    s_add_u32 m0, s41, 81920
    s_add_u32 s42, s40, 98304
    buffer_load_dwordx4 v9, s[48:51], s42 offen lds
    s_waitcnt lgkmcnt(10)
    v_dot2_f32_bf16 v144, v44, s47, v144
    v_dot2_f32_bf16 v145, v44, v44, v145
    v_dot2_f32_bf16 v146, v45, s47, v146
    v_dot2_f32_bf16 v147, v45, v45, v147
    v_dot2_f32_bf16 v144, v46, s47, v144
    v_dot2_f32_bf16 v145, v46, v46, v145
    v_dot2_f32_bf16 v146, v47, s47, v146
    v_dot2_f32_bf16 v147, v47, v47, v147
    s_add_u32 m0, s41, 82944
    s_add_u32 s42, s40, 106496
    buffer_load_dwordx4 v9, s[48:51], s42 offen lds
    s_waitcnt lgkmcnt(9)
    v_dot2_f32_bf16 v144, v48, s47, v144
    v_dot2_f32_bf16 v145, v48, v48, v145
    v_dot2_f32_bf16 v146, v49, s47, v146
    v_dot2_f32_bf16 v147, v49, v49, v147
    v_dot2_f32_bf16 v144, v50, s47, v144
    v_dot2_f32_bf16 v145, v50, v50, v145
    v_dot2_f32_bf16 v146, v51, s47, v146
    v_dot2_f32_bf16 v147, v51, v51, v147
    s_add_u32 m0, s41, 83968
    s_add_u32 s42, s40, 114688
    buffer_load_dwordx4 v10, s[48:51], s42 offen lds
    s_waitcnt lgkmcnt(8)
    v_dot2_f32_bf16 v144, v52, s47, v144
    v_dot2_f32_bf16 v145, v52, v52, v145
    v_dot2_f32_bf16 v146, v53, s47, v146
    v_dot2_f32_bf16 v147, v53, v53, v147
    v_dot2_f32_bf16 v144, v54, s47, v144
    v_dot2_f32_bf16 v145, v54, v54, v145
    v_dot2_f32_bf16 v146, v55, s47, v146
    v_dot2_f32_bf16 v147, v55, v55, v147
    s_add_u32 m0, s41, 84992
    s_add_u32 s42, s40, 122880
    buffer_load_dwordx4 v10, s[48:51], s42 offen lds
    s_waitcnt lgkmcnt(7)
    v_dot2_f32_bf16 v144, v56, s47, v144
    v_dot2_f32_bf16 v145, v56, v56, v145
    v_dot2_f32_bf16 v146, v57, s47, v146
    v_dot2_f32_bf16 v147, v57, v57, v147
    v_dot2_f32_bf16 v144, v58, s47, v144
    v_dot2_f32_bf16 v145, v58, v58, v145
    v_dot2_f32_bf16 v146, v59, s47, v146
    v_dot2_f32_bf16 v147, v59, v59, v147
    s_add_u32 m0, s41, 86016
    s_add_u32 s42, s40, 131072
    buffer_load_dwordx4 v9, s[48:51], s42 offen lds
    s_waitcnt lgkmcnt(6)
    v_dot2_f32_bf16 v144, v60, s47, v144
    v_dot2_f32_bf16 v145, v60, v60, v145
    v_dot2_f32_bf16 v146, v61, s47, v146
    v_dot2_f32_bf16 v147, v61, v61, v147
    v_dot2_f32_bf16 v144, v62, s47, v144
    v_dot2_f32_bf16 v145, v62, v62, v145
    v_dot2_f32_bf16 v146, v63, s47, v146
    v_dot2_f32_bf16 v147, v63, v63, v147
    s_add_u32 m0, s41, 87040
    s_add_u32 s42, s40, 139264
    buffer_load_dwordx4 v9, s[48:51], s42 offen lds
    s_waitcnt lgkmcnt(5)
    v_dot2_f32_bf16 v144, v64, s47, v144
    v_dot2_f32_bf16 v145, v64, v64, v145
    v_dot2_f32_bf16 v146, v65, s47, v146
    v_dot2_f32_bf16 v147, v65, v65, v147
    v_dot2_f32_bf16 v144, v66, s47, v144
    v_dot2_f32_bf16 v145, v66, v66, v145
    v_dot2_f32_bf16 v146, v67, s47, v146
    v_dot2_f32_bf16 v147, v67, v67, v147
    s_add_u32 m0, s41, 88064
    s_add_u32 s42, s40, 147456
    buffer_load_dwordx4 v10, s[48:51], s42 offen lds
    s_waitcnt lgkmcnt(4)
    v_dot2_f32_bf16 v144, v68, s47, v144
    v_dot2_f32_bf16 v145, v68, v68, v145
    v_dot2_f32_bf16 v146, v69, s47, v146
    v_dot2_f32_bf16 v147, v69, v69, v147
    v_dot2_f32_bf16 v144, v70, s47, v144
    v_dot2_f32_bf16 v145, v70, v70, v145
    v_dot2_f32_bf16 v146, v71, s47, v146
    v_dot2_f32_bf16 v147, v71, v71, v147
    s_add_u32 m0, s41, 89088
    s_add_u32 s42, s40, 155648
    buffer_load_dwordx4 v10, s[48:51], s42 offen lds
    s_waitcnt lgkmcnt(3)
    v_dot2_f32_bf16 v144, v72, s47, v144
    v_dot2_f32_bf16 v145, v72, v72, v145
    v_dot2_f32_bf16 v146, v73, s47, v146
    v_dot2_f32_bf16 v147, v73, v73, v147
    v_dot2_f32_bf16 v144, v74, s47, v144
    v_dot2_f32_bf16 v145, v74, v74, v145
    v_dot2_f32_bf16 v146, v75, s47, v146
    v_dot2_f32_bf16 v147, v75, v75, v147
    s_add_u32 m0, s41, 90112
    s_add_u32 s42, s40, 163840
    buffer_load_dwordx4 v9, s[48:51], s42 offen lds
    s_waitcnt lgkmcnt(2)
    v_dot2_f32_bf16 v144, v76, s47, v144
    v_dot2_f32_bf16 v145, v76, v76, v145
    v_dot2_f32_bf16 v146, v77, s47, v146
    v_dot2_f32_bf16 v147, v77, v77, v147
    v_dot2_f32_bf16 v144, v78, s47, v144
    v_dot2_f32_bf16 v145, v78, v78, v145
    v_dot2_f32_bf16 v146, v79, s47, v146
    v_dot2_f32_bf16 v147, v79, v79, v147
    s_add_u32 m0, s41, 91136
    s_add_u32 s42, s40, 172032
    buffer_load_dwordx4 v9, s[48:51], s42 offen lds
    s_nop 2
    v_add_f32 v144, v144, v146
    v_add_f32 v145, v145, v147
    v_mov_b32 v146, v144
    v_mov_b32 v147, v145
    s_nop 0
    v_permlane32_swap_b32 v144, v146
    v_permlane32_swap_b32 v145, v147
    v_add_f32 v144, v144, v146
    v_add_f32 v145, v145, v147
    v_mov_b32 v146, v144
    v_mov_b32 v147, v145
    s_nop 0
    v_permlane16_swap_b32 v144, v146
    v_permlane16_swap_b32 v145, v147
    v_add_f32 v144, v144, v146
    v_add_f32 v145, v145, v147
    v_mul_f32 v144, 0xbb000000, v144
    v_mul_f32 v145, 0x3b000000, v145
    v_fma_f32 v145, -v144, v144, v145
    v_max_f32 v145, 0, v145
    v_add_f32 v145, 0x3727c5ac, v145
    v_rsq_f32 v145, v145
    s_nop 0
    s_lshl_b32 s42, s3, 7
    v_add_u32 v5, s42, v165
    ds_write_b64 v5, v[144:145]
    s_mov_b32 s43, 0
    s_waitcnt vmcnt(16)
L_np_9:
    s_add_u32 s43, s43, 1
    v_readfirstlane_b32 s64, v12
    v_readfirstlane_b32 s65, v13
    s_cmp_ge_u32 s43, 100000
    s_cbranch_scc1 L_nd_10
    s_cmp_lg_u32 s64, 0
    s_cbranch_scc1 L_nd_10
    s_sleep 2
    global_load_dwordx2 v[12:13], v6, s[66:67] sc1
    s_waitcnt vmcnt(0)
    s_branch L_np_9
L_nd_10:
    s_getreg_b32 s71, hwreg(HW_REG_XCC_ID, 0, 4)
    s_lshl_b32 s71, s71, 28
    s_and_b32 s42, s65, 0x0fffffff
    s_or_b32 s71, s71, s42
    s_branch L_join_4
L_kvwave_3:
    s_setprio 3
    s_cmp_eq_u32 s60, 2
    s_cbranch_scc1 L_kvv_11
    s_mov_b32 s48, s20
    s_and_b32 s49, s21, 0xffff
    s_mov_b32 s50, 16384
    s_mov_b32 s51, 0x20000
    s_branch L_kvj_12
L_kvv_11:
    s_mov_b32 s48, s22
    s_and_b32 s49, s23, 0xffff
    s_mov_b32 s50, 16384
    s_mov_b32 s51, 0x20000
L_kvj_12:
    v_xor_b32 v0, 0, v2
    s_add_u32 m0, s45, 0
    s_add_u32 s42, s39, 0
    buffer_load_dwordx4 v0, s[12:15], s42 offen offset:0 lds
    v_xor_b32 v0, 16, v2
    buffer_load_dwordx4 v0, s[12:15], s42 offen offset:1024 lds
    v_xor_b32 v0, 32, v2
    buffer_load_dwordx4 v0, s[12:15], s42 offen offset:2048 lds
    v_xor_b32 v0, 48, v2
    buffer_load_dwordx4 v0, s[12:15], s42 offen offset:3072 lds
    v_xor_b32 v0, 64, v2
    s_add_u32 m0, s45, 4096
    s_add_u32 s42, s39, 4096
    buffer_load_dwordx4 v0, s[12:15], s42 offen offset:0 lds
    v_xor_b32 v0, 80, v2
    buffer_load_dwordx4 v0, s[12:15], s42 offen offset:1024 lds
    v_xor_b32 v0, 96, v2
    buffer_load_dwordx4 v0, s[12:15], s42 offen offset:2048 lds
    v_xor_b32 v0, 112, v2
    buffer_load_dwordx4 v0, s[12:15], s42 offen offset:3072 lds
    v_xor_b32 v0, 128, v2
    s_add_u32 m0, s45, 8192
    s_add_u32 s42, s39, 8192
    buffer_load_dwordx4 v0, s[12:15], s42 offen offset:0 lds
    v_xor_b32 v0, 144, v2
    buffer_load_dwordx4 v0, s[12:15], s42 offen offset:1024 lds
    v_xor_b32 v0, 160, v2
    buffer_load_dwordx4 v0, s[12:15], s42 offen offset:2048 lds
    v_xor_b32 v0, 176, v2
    buffer_load_dwordx4 v0, s[12:15], s42 offen offset:3072 lds
    v_xor_b32 v0, 192, v2
    s_add_u32 m0, s45, 12288
    s_add_u32 s42, s39, 12288
    buffer_load_dwordx4 v0, s[12:15], s42 offen offset:0 lds
    v_xor_b32 v0, 208, v2
    buffer_load_dwordx4 v0, s[12:15], s42 offen offset:1024 lds
    v_xor_b32 v0, 224, v2
    buffer_load_dwordx4 v0, s[12:15], s42 offen offset:2048 lds
    v_xor_b32 v0, 240, v2
    buffer_load_dwordx4 v0, s[12:15], s42 offen offset:3072 lds
    s_mov_b32 m0, 143360
    s_mov_b32 s42, 0
    buffer_load_dwordx4 v2, s[48:51], s42 offen offset:0 lds
    buffer_load_dwordx4 v2, s[48:51], s42 offen offset:1024 lds
    buffer_load_dwordx4 v2, s[48:51], s42 offen offset:2048 lds
    buffer_load_dwordx4 v2, s[48:51], s42 offen offset:3072 lds
    s_mov_b32 m0, 147456
    s_mov_b32 s42, 4096
    buffer_load_dwordx4 v2, s[48:51], s42 offen offset:0 lds
    buffer_load_dwordx4 v2, s[48:51], s42 offen offset:1024 lds
    buffer_load_dwordx4 v2, s[48:51], s42 offen offset:2048 lds
    buffer_load_dwordx4 v2, s[48:51], s42 offen offset:3072 lds
    s_mov_b32 m0, 151552
    s_mov_b32 s42, 8192
    buffer_load_dwordx4 v2, s[48:51], s42 offen offset:0 lds
    buffer_load_dwordx4 v2, s[48:51], s42 offen offset:1024 lds
    buffer_load_dwordx4 v2, s[48:51], s42 offen offset:2048 lds
    buffer_load_dwordx4 v2, s[48:51], s42 offen offset:3072 lds
    s_mov_b32 m0, 155648
    s_mov_b32 s42, 12288
    buffer_load_dwordx4 v2, s[48:51], s42 offen offset:0 lds
    buffer_load_dwordx4 v2, s[48:51], s42 offen offset:1024 lds
    buffer_load_dwordx4 v2, s[48:51], s42 offen offset:2048 lds
    buffer_load_dwordx4 v2, s[48:51], s42 offen offset:3072 lds
    global_load_dwordx2 v[12:13], v6, s[66:67] sc1
    s_mov_b32 s58, 3932160
    v_and_b32 v9, 15, v1
    v_lshlrev_b32 v9, 4, v9
    v_bfe_u32 v10, v1, 4, 1
    v_lshl_add_u32 v9, v10, 3, v9
    s_cmp_eq_u32 s60, 2
    s_cbranch_scc1 L_isv_13
    v_lshrrev_b32 v10, 5, v1
    v_lshl_add_u32 v9, v10, 9, v9
    s_lshr_b32 s61, s38, 11
    s_lshl_b32 s61, s61, 10
    s_bfe_u32 s42, s38, 0x1000a
    s_lshl_b32 s42, s42, 8
    s_add_u32 s61, s61, s42
    s_branch L_kvd_14
L_isv_13:
    v_and_b32 v4, 15, v1
    v_lshlrev_b32 v4, 3, v4
    v_add_u32 v4, 160320, v4
    v_lshrrev_b32 v5, 4, v1
    v_lshlrev_b32 v5, 5, v5
    v_add_u32 v5, 160320, v5
    v_lshrrev_b32 v10, 5, v1
    v_mul_u32_u24 v10, 272, v10
    v_add_u32 v9, v9, v10
    s_lshr_b32 s61, s38, 9
    s_mul_i32 s61, s61, 272
    s_add_u32 s61, s61, 65536
L_kvd_14:
    s_add_u32 s61, s61, s58
    s_waitcnt vmcnt(17)
    ds_read_b128 v[16:19], v80 offset:0
    ds_read_b128 v[20:23], v81 offset:0
    ds_read_b128 v[24:27], v82 offset:0
    ds_read_b128 v[28:31], v83 offset:0
    ds_read_b128 v[32:35], v80 offset:256
    ds_read_b128 v[36:39], v81 offset:256
    ds_read_b128 v[40:43], v82 offset:256
    ds_read_b128 v[44:47], v83 offset:256
    ds_read_b128 v[48:51], v80 offset:512
    ds_read_b128 v[52:55], v81 offset:512
    ds_read_b128 v[56:59], v82 offset:512
    ds_read_b128 v[60:63], v83 offset:512
    ds_read_b128 v[64:67], v80 offset:768
    ds_read_b128 v[68:71], v81 offset:768
    ds_read_b128 v[72:75], v82 offset:768
    ds_read_b128 v[76:79], v83 offset:768
    ds_read_b128 v[112:115], v85
    ds_read_b128 v[116:119], v86
    v_mov_b32 v144, 0
    v_mov_b32 v145, 0
    v_mov_b32 v146, 0
    v_mov_b32 v147, 0
    s_waitcnt lgkmcnt(15)
    v_dot2_f32_bf16 v144, v16, s47, v144
    v_dot2_f32_bf16 v145, v16, v16, v145
    v_dot2_f32_bf16 v146, v17, s47, v146
    v_dot2_f32_bf16 v147, v17, v17, v147
    v_dot2_f32_bf16 v144, v18, s47, v144
    v_dot2_f32_bf16 v145, v18, v18, v145
    v_dot2_f32_bf16 v146, v19, s47, v146
    v_dot2_f32_bf16 v147, v19, v19, v147
    v_dot2_f32_bf16 v144, v20, s47, v144
    v_dot2_f32_bf16 v145, v20, v20, v145
    v_dot2_f32_bf16 v146, v21, s47, v146
    v_dot2_f32_bf16 v147, v21, v21, v147
    v_dot2_f32_bf16 v144, v22, s47, v144
    v_dot2_f32_bf16 v145, v22, v22, v145
    v_dot2_f32_bf16 v146, v23, s47, v146
    v_dot2_f32_bf16 v147, v23, v23, v147
    v_dot2_f32_bf16 v144, v24, s47, v144
    v_dot2_f32_bf16 v145, v24, v24, v145
    v_dot2_f32_bf16 v146, v25, s47, v146
    v_dot2_f32_bf16 v147, v25, v25, v147
    v_dot2_f32_bf16 v144, v26, s47, v144
    v_dot2_f32_bf16 v145, v26, v26, v145
    v_dot2_f32_bf16 v146, v27, s47, v146
    v_dot2_f32_bf16 v147, v27, v27, v147
    s_waitcnt lgkmcnt(14)
    v_dot2_f32_bf16 v144, v28, s47, v144
    v_dot2_f32_bf16 v145, v28, v28, v145
    v_dot2_f32_bf16 v146, v29, s47, v146
    v_dot2_f32_bf16 v147, v29, v29, v147
    v_dot2_f32_bf16 v144, v30, s47, v144
    v_dot2_f32_bf16 v145, v30, v30, v145
    v_dot2_f32_bf16 v146, v31, s47, v146
    v_dot2_f32_bf16 v147, v31, v31, v147
    s_waitcnt lgkmcnt(13)
    v_dot2_f32_bf16 v144, v32, s47, v144
    v_dot2_f32_bf16 v145, v32, v32, v145
    v_dot2_f32_bf16 v146, v33, s47, v146
    v_dot2_f32_bf16 v147, v33, v33, v147
    v_dot2_f32_bf16 v144, v34, s47, v144
    v_dot2_f32_bf16 v145, v34, v34, v145
    v_dot2_f32_bf16 v146, v35, s47, v146
    v_dot2_f32_bf16 v147, v35, v35, v147
    s_waitcnt lgkmcnt(12)
    v_dot2_f32_bf16 v144, v36, s47, v144
    v_dot2_f32_bf16 v145, v36, v36, v145
    v_dot2_f32_bf16 v146, v37, s47, v146
    v_dot2_f32_bf16 v147, v37, v37, v147
    v_dot2_f32_bf16 v144, v38, s47, v144
    v_dot2_f32_bf16 v145, v38, v38, v145
    v_dot2_f32_bf16 v146, v39, s47, v146
    v_dot2_f32_bf16 v147, v39, v39, v147
    s_waitcnt lgkmcnt(11)
    v_dot2_f32_bf16 v144, v40, s47, v144
    v_dot2_f32_bf16 v145, v40, v40, v145
    v_dot2_f32_bf16 v146, v41, s47, v146
    v_dot2_f32_bf16 v147, v41, v41, v147
    v_dot2_f32_bf16 v144, v42, s47, v144
    v_dot2_f32_bf16 v145, v42, v42, v145
    v_dot2_f32_bf16 v146, v43, s47, v146
    v_dot2_f32_bf16 v147, v43, v43, v147
    s_waitcnt lgkmcnt(10)
    v_dot2_f32_bf16 v144, v44, s47, v144
    v_dot2_f32_bf16 v145, v44, v44, v145
    v_dot2_f32_bf16 v146, v45, s47, v146
    v_dot2_f32_bf16 v147, v45, v45, v147
    v_dot2_f32_bf16 v144, v46, s47, v144
    v_dot2_f32_bf16 v145, v46, v46, v145
    v_dot2_f32_bf16 v146, v47, s47, v146
    v_dot2_f32_bf16 v147, v47, v47, v147
    s_waitcnt lgkmcnt(9)
    v_dot2_f32_bf16 v144, v48, s47, v144
    v_dot2_f32_bf16 v145, v48, v48, v145
    v_dot2_f32_bf16 v146, v49, s47, v146
    v_dot2_f32_bf16 v147, v49, v49, v147
    v_dot2_f32_bf16 v144, v50, s47, v144
    v_dot2_f32_bf16 v145, v50, v50, v145
    v_dot2_f32_bf16 v146, v51, s47, v146
    v_dot2_f32_bf16 v147, v51, v51, v147
    s_waitcnt lgkmcnt(8)
    v_dot2_f32_bf16 v144, v52, s47, v144
    v_dot2_f32_bf16 v145, v52, v52, v145
    v_dot2_f32_bf16 v146, v53, s47, v146
    v_dot2_f32_bf16 v147, v53, v53, v147
    v_dot2_f32_bf16 v144, v54, s47, v144
    v_dot2_f32_bf16 v145, v54, v54, v145
    v_dot2_f32_bf16 v146, v55, s47, v146
    v_dot2_f32_bf16 v147, v55, v55, v147
    s_waitcnt lgkmcnt(7)
    v_dot2_f32_bf16 v144, v56, s47, v144
    v_dot2_f32_bf16 v145, v56, v56, v145
    v_dot2_f32_bf16 v146, v57, s47, v146
    v_dot2_f32_bf16 v147, v57, v57, v147
    v_dot2_f32_bf16 v144, v58, s47, v144
    v_dot2_f32_bf16 v145, v58, v58, v145
    v_dot2_f32_bf16 v146, v59, s47, v146
    v_dot2_f32_bf16 v147, v59, v59, v147
    s_waitcnt lgkmcnt(6)
    v_dot2_f32_bf16 v144, v60, s47, v144
    v_dot2_f32_bf16 v145, v60, v60, v145
    v_dot2_f32_bf16 v146, v61, s47, v146
    v_dot2_f32_bf16 v147, v61, v61, v147
    v_dot2_f32_bf16 v144, v62, s47, v144
    v_dot2_f32_bf16 v145, v62, v62, v145
    v_dot2_f32_bf16 v146, v63, s47, v146
    v_dot2_f32_bf16 v147, v63, v63, v147
    s_waitcnt vmcnt(1)
    s_waitcnt lgkmcnt(0)
    v_lshrrev_b32 v0, 4, v1
    v_lshlrev_b32 v0, 9, v0
    v_and_b32 v176, 15, v1
    v_lshl_add_u32 v0, v176, 3, v0
    v_add_u32 v0, 143360, v0
    ds_read_b64_tr_b16 v[176:177], v0 offset:0
    ds_read_b64_tr_b16 v[178:179], v0 offset:128
    ds_read_b64_tr_b16 v[180:181], v0 offset:256
    ds_read_b64_tr_b16 v[182:183], v0 offset:384
    ds_read_b64_tr_b16 v[184:185], v0 offset:2048
    ds_read_b64_tr_b16 v[186:187], v0 offset:2176
    ds_read_b64_tr_b16 v[188:189], v0 offset:2304
    ds_read_b64_tr_b16 v[190:191], v0 offset:2432
    ds_read_b64_tr_b16 v[192:193], v0 offset:4096
    ds_read_b64_tr_b16 v[194:195], v0 offset:4224
    ds_read_b64_tr_b16 v[196:197], v0 offset:4352
    ds_read_b64_tr_b16 v[198:199], v0 offset:4480
    ds_read_b64_tr_b16 v[200:201], v0 offset:6144
    ds_read_b64_tr_b16 v[202:203], v0 offset:6272
    ds_read_b64_tr_b16 v[204:205], v0 offset:6400
    ds_read_b64_tr_b16 v[206:207], v0 offset:6528
    ds_read_b64_tr_b16 v[208:209], v0 offset:8192
    ds_read_b64_tr_b16 v[210:211], v0 offset:8320
    ds_read_b64_tr_b16 v[212:213], v0 offset:8448
    ds_read_b64_tr_b16 v[214:215], v0 offset:8576
    ds_read_b64_tr_b16 v[216:217], v0 offset:10240
    ds_read_b64_tr_b16 v[218:219], v0 offset:10368
    ds_read_b64_tr_b16 v[220:221], v0 offset:10496
    ds_read_b64_tr_b16 v[222:223], v0 offset:10624
    ds_read_b64_tr_b16 v[224:225], v0 offset:12288
    ds_read_b64_tr_b16 v[226:227], v0 offset:12416
    ds_read_b64_tr_b16 v[228:229], v0 offset:12544
    ds_read_b64_tr_b16 v[230:231], v0 offset:12672
    ds_read_b64_tr_b16 v[232:233], v0 offset:14336
    ds_read_b64_tr_b16 v[234:235], v0 offset:14464
    ds_read_b64_tr_b16 v[236:237], v0 offset:14592
    ds_read_b64_tr_b16 v[238:239], v0 offset:14720
    v_dot2_f32_bf16 v144, v64, s47, v144
    v_dot2_f32_bf16 v145, v64, v64, v145
    v_dot2_f32_bf16 v146, v65, s47, v146
    v_dot2_f32_bf16 v147, v65, v65, v147
    v_dot2_f32_bf16 v144, v66, s47, v144
    v_dot2_f32_bf16 v145, v66, v66, v145
    v_dot2_f32_bf16 v146, v67, s47, v146
    v_dot2_f32_bf16 v147, v67, v67, v147
    v_dot2_f32_bf16 v144, v68, s47, v144
    v_dot2_f32_bf16 v145, v68, v68, v145
    v_dot2_f32_bf16 v146, v69, s47, v146
    v_dot2_f32_bf16 v147, v69, v69, v147
    v_dot2_f32_bf16 v144, v70, s47, v144
    v_dot2_f32_bf16 v145, v70, v70, v145
    v_dot2_f32_bf16 v146, v71, s47, v146
    v_dot2_f32_bf16 v147, v71, v71, v147
    v_dot2_f32_bf16 v144, v72, s47, v144
    v_dot2_f32_bf16 v145, v72, v72, v145
    v_dot2_f32_bf16 v146, v73, s47, v146
    v_dot2_f32_bf16 v147, v73, v73, v147
    v_dot2_f32_bf16 v144, v74, s47, v144
    v_dot2_f32_bf16 v145, v74, v74, v145
    v_dot2_f32_bf16 v146, v75, s47, v146
    v_dot2_f32_bf16 v147, v75, v75, v147
    v_dot2_f32_bf16 v144, v76, s47, v144
    v_dot2_f32_bf16 v145, v76, v76, v145
    v_dot2_f32_bf16 v146, v77, s47, v146
    v_dot2_f32_bf16 v147, v77, v77, v147
    v_dot2_f32_bf16 v144, v78, s47, v144
    v_dot2_f32_bf16 v145, v78, v78, v145
    v_dot2_f32_bf16 v146, v79, s47, v146
    v_dot2_f32_bf16 v147, v79, v79, v147
    s_nop 2
    v_add_f32 v144, v144, v146
    v_add_f32 v145, v145, v147
    v_mov_b32 v146, v144
    v_mov_b32 v147, v145
    s_nop 0
    v_permlane32_swap_b32 v144, v146
    v_permlane32_swap_b32 v145, v147
    v_add_f32 v144, v144, v146
    v_add_f32 v145, v145, v147
    v_mov_b32 v146, v144
    v_mov_b32 v147, v145
    s_nop 0
    v_permlane16_swap_b32 v144, v146
    v_permlane16_swap_b32 v145, v147
    v_add_f32 v144, v144, v146
    v_add_f32 v145, v145, v147
    v_mul_f32 v144, 0xbb000000, v144
    v_mul_f32 v145, 0x3b000000, v145
    v_fma_f32 v145, -v144, v144, v145
    v_max_f32 v145, 0, v145
    v_add_f32 v145, 0x3727c5ac, v145
    v_rsq_f32 v145, v145
    s_nop 0
    s_lshl_b32 s42, s3, 7
    v_add_u32 v0, s42, v165
    s_waitcnt lgkmcnt(0)
    ds_write_b64 v0, v[144:145]
    s_cmp_eq_u32 s60, 2
    s_cbranch_scc1 L_isv_15
    v_mfma_f32_16x16x32_bf16 v[172:175], v[176:179], v[120:123], 0
    v_mfma_f32_16x16x32_bf16 v[172:175], v[180:183], v[120:123], v[172:175]
    v_mfma_f32_16x16x32_bf16 v[172:175], v[184:187], v[120:123], v[172:175]
    v_mfma_f32_16x16x32_bf16 v[172:175], v[188:191], v[120:123], v[172:175]
    v_mfma_f32_16x16x32_bf16 v[172:175], v[192:195], v[120:123], v[172:175]
    v_mfma_f32_16x16x32_bf16 v[172:175], v[196:199], v[120:123], v[172:175]
    v_mfma_f32_16x16x32_bf16 v[172:175], v[200:203], v[120:123], v[172:175]
    v_mfma_f32_16x16x32_bf16 v[172:175], v[204:207], v[120:123], v[172:175]
    v_mfma_f32_16x16x32_bf16 v[172:175], v[208:211], v[120:123], v[172:175]
    v_mfma_f32_16x16x32_bf16 v[172:175], v[212:215], v[120:123], v[172:175]
    v_mfma_f32_16x16x32_bf16 v[172:175], v[216:219], v[120:123], v[172:175]
    v_mfma_f32_16x16x32_bf16 v[172:175], v[220:223], v[120:123], v[172:175]
    v_mfma_f32_16x16x32_bf16 v[172:175], v[224:227], v[120:123], v[172:175]
    v_mfma_f32_16x16x32_bf16 v[172:175], v[228:231], v[120:123], v[172:175]
    v_mfma_f32_16x16x32_bf16 v[172:175], v[232:235], v[120:123], v[172:175]
    v_mfma_f32_16x16x32_bf16 v[172:175], v[236:239], v[120:123], v[172:175]
    s_branch L_kvd_16
L_isv_15:
    v_mfma_f32_16x16x32_bf16 v[172:175], v[120:123], v[176:179], 0
    v_mfma_f32_16x16x32_bf16 v[172:175], v[120:123], v[180:183], v[172:175]
    v_mfma_f32_16x16x32_bf16 v[172:175], v[120:123], v[184:187], v[172:175]
    v_mfma_f32_16x16x32_bf16 v[172:175], v[120:123], v[188:191], v[172:175]
    v_mfma_f32_16x16x32_bf16 v[172:175], v[120:123], v[192:195], v[172:175]
    v_mfma_f32_16x16x32_bf16 v[172:175], v[120:123], v[196:199], v[172:175]
    v_mfma_f32_16x16x32_bf16 v[172:175], v[120:123], v[200:203], v[172:175]
    v_mfma_f32_16x16x32_bf16 v[172:175], v[120:123], v[204:207], v[172:175]
    v_mfma_f32_16x16x32_bf16 v[172:175], v[120:123], v[208:211], v[172:175]
    v_mfma_f32_16x16x32_bf16 v[172:175], v[120:123], v[212:215], v[172:175]
    v_mfma_f32_16x16x32_bf16 v[172:175], v[120:123], v[216:219], v[172:175]
    v_mfma_f32_16x16x32_bf16 v[172:175], v[120:123], v[220:223], v[172:175]
    v_mfma_f32_16x16x32_bf16 v[172:175], v[120:123], v[224:227], v[172:175]
    v_mfma_f32_16x16x32_bf16 v[172:175], v[120:123], v[228:231], v[172:175]
    v_mfma_f32_16x16x32_bf16 v[172:175], v[120:123], v[232:235], v[172:175]
    v_mfma_f32_16x16x32_bf16 v[172:175], v[120:123], v[236:239], v[172:175]
L_kvd_16:
    s_cmp_eq_u32 s60, 2
    s_cbranch_scc1 L_isv_17
    v_mul_f32 v149, 0x3eb8aa3b, v145
    v_mov_b32 v148, v144
    v_mov_b32 v150, v144
    v_mov_b32 v152, v144
    v_mov_b32 v154, v144
    v_mov_b32 v151, v149
    v_mov_b32 v153, v149
    v_mov_b32 v155, v149
    s_branch L_kvd_18
L_isv_17:
    ds_write_b64 v4, v[144:145]
    s_mov_b32 exec_lo, 1
    s_mov_b32 exec_hi, 1
    buffer_store_dwordx4 v[120:123], v10, s[8:11], s61 offen offset:256 sc1
    s_add_u32 s42, s61, 10092544
    buffer_store_dwordx4 v[120:123], v10, s[8:11], s42 offen offset:256 sc1
    s_mov_b64 exec, -1
    s_waitcnt lgkmcnt(0)
    ds_read_b128 v[148:151], v5
    ds_read_b128 v[152:155], v5 offset:16
L_kvd_18:
    s_cmp_eq_u32 s60, 2
    s_cbranch_scc1 L_isv_19
    v_mfma_f32_16x16x32_bf16 v[166:169], v[176:179], v[16:19], 0
    v_mfma_f32_16x16x32_bf16 v[166:169], v[180:183], v[20:23], v[166:169]
    v_mfma_f32_16x16x32_bf16 v[166:169], v[184:187], v[24:27], v[166:169]
    v_mfma_f32_16x16x32_bf16 v[166:169], v[188:191], v[28:31], v[166:169]
    v_mfma_f32_16x16x32_bf16 v[166:169], v[192:195], v[32:35], v[166:169]
    v_mfma_f32_16x16x32_bf16 v[166:169], v[196:199], v[36:39], v[166:169]
    v_mfma_f32_16x16x32_bf16 v[166:169], v[200:203], v[40:43], v[166:169]
    v_mfma_f32_16x16x32_bf16 v[166:169], v[204:207], v[44:47], v[166:169]
    v_mfma_f32_16x16x32_bf16 v[166:169], v[208:211], v[48:51], v[166:169]
    v_mfma_f32_16x16x32_bf16 v[166:169], v[212:215], v[52:55], v[166:169]
    v_mfma_f32_16x16x32_bf16 v[166:169], v[216:219], v[56:59], v[166:169]
    v_mfma_f32_16x16x32_bf16 v[166:169], v[220:223], v[60:63], v[166:169]
    v_mfma_f32_16x16x32_bf16 v[166:169], v[224:227], v[64:67], v[166:169]
    v_mfma_f32_16x16x32_bf16 v[166:169], v[228:231], v[68:71], v[166:169]
    v_mfma_f32_16x16x32_bf16 v[166:169], v[232:235], v[72:75], v[166:169]
    v_mfma_f32_16x16x32_bf16 v[166:169], v[236:239], v[76:79], v[166:169]
    s_branch L_kvd_20
L_isv_19:
    v_mfma_f32_16x16x32_bf16 v[166:169], v[16:19], v[176:179], 0
    v_mfma_f32_16x16x32_bf16 v[166:169], v[20:23], v[180:183], v[166:169]
    v_mfma_f32_16x16x32_bf16 v[166:169], v[24:27], v[184:187], v[166:169]
    v_mfma_f32_16x16x32_bf16 v[166:169], v[28:31], v[188:191], v[166:169]
    v_mfma_f32_16x16x32_bf16 v[166:169], v[32:35], v[192:195], v[166:169]
    v_mfma_f32_16x16x32_bf16 v[166:169], v[36:39], v[196:199], v[166:169]
    v_mfma_f32_16x16x32_bf16 v[166:169], v[40:43], v[200:203], v[166:169]
    v_mfma_f32_16x16x32_bf16 v[166:169], v[44:47], v[204:207], v[166:169]
    v_mfma_f32_16x16x32_bf16 v[166:169], v[48:51], v[208:211], v[166:169]
    v_mfma_f32_16x16x32_bf16 v[166:169], v[52:55], v[212:215], v[166:169]
    v_mfma_f32_16x16x32_bf16 v[166:169], v[56:59], v[216:219], v[166:169]
    v_mfma_f32_16x16x32_bf16 v[166:169], v[60:63], v[220:223], v[166:169]
    v_mfma_f32_16x16x32_bf16 v[166:169], v[64:67], v[224:227], v[166:169]
    v_mfma_f32_16x16x32_bf16 v[166:169], v[68:71], v[228:231], v[166:169]
    v_mfma_f32_16x16x32_bf16 v[166:169], v[72:75], v[232:235], v[166:169]
    v_mfma_f32_16x16x32_bf16 v[166:169], v[76:79], v[236:239], v[166:169]
L_kvd_20:
    v_add_u32 v0, 160768, v2
    ds_write_b128 v0, v[172:175]
    s_nop 4
    s_waitcnt lgkmcnt(0)
    v_fmac_f32 v166, v148, v172
    v_fmac_f32 v167, v150, v173
    v_fmac_f32 v168, v152, v174
    v_fmac_f32 v169, v154, v175
    v_mul_f32 v166, v149, v166
    v_mul_f32 v167, v151, v167
    v_mul_f32 v168, v153, v168
    v_mul_f32 v169, v155, v169
    v_cvt_pk_bf16_f32 v170, v166, v167
    v_cvt_pk_bf16_f32 v171, v168, v169
    buffer_store_dwordx2 v[170:171], v9, s[8:11], s61 offen sc1
    v_lshrrev_b32 v4, 4, v1
    s_mov_b32 s43, 0
    s_waitcnt vmcnt(1)
L_np_21:
    s_add_u32 s43, s43, 1
    v_readfirstlane_b32 s64, v12
    v_readfirstlane_b32 s65, v13
    s_cmp_ge_u32 s43, 100000
    s_cbranch_scc1 L_nd_22
    s_cmp_lg_u32 s64, 0
    s_cbranch_scc1 L_nd_22
    s_sleep 2
    global_load_dwordx2 v[12:13], v6, s[66:67] sc1
    s_waitcnt vmcnt(0)
    s_branch L_np_21
L_nd_22:
    s_getreg_b32 s71, hwreg(HW_REG_XCC_ID, 0, 4)
    s_lshl_b32 s71, s71, 28
    s_and_b32 s42, s65, 0x0fffffff
    s_or_b32 s71, s71, s42
L_join_4:
    s_lshl_b32 s46, s2, 2
    s_add_u32 s46, s46, s3
    v_lshrrev_b32 v232, 3, v1
    v_and_b32 v233, 7, v1
    v_lshrrev_b32 v235, 2, v3
    v_lshlrev_b32 v236, 10, v4
    v_lshl_add_u32 v236, v235, 7, v236
    v_and_b32 v235, 3, v3
    s_lshl_b32 s42, s3, 14
    s_add_u32 s42, s42, 12288
    v_add_u32 v236, s42, v236
    s_cmp_ge_u32 s46, 128
    s_cbranch_scc1 L_jn_24
    s_mov_b32 s12, s18
    s_and_b32 s13, s19, 0xffff
    s_mov_b32 s14, 524288
    s_mov_b32 s15, 0x20000
    s_and_b32 s40, s46, 7
    s_lshr_b32 s41, s46, 3
    s_lshr_b32 s42, s41, 1
    s_lshl_b32 s42, s42, 3
    s_and_b32 s43, s41, 1
    s_add_u32 s42, s42, s43
    s_mul_i32 s42, s42, 8192
    s_mov_b32 s43, 16384
    v_mul_u32_u24 v232, 1024, v232
    s_mul_i32 s68, s40, 16
    s_add_u32 s68, s68, s41
    s_lshl_b32 s68, s68, 12
    s_add_u32 s68, s68, 0
    s_mov_b32 s69, 1024
    v_lshl_add_u32 v236, v235, 5, v236
    s_mov_b32 s41, 8
    s_branch L_jgo_23
L_jn_24:
    s_sub_u32 s46, s46, 128
    s_cmp_ge_u32 s46, 128
    s_cbranch_scc1 L_jn_25
    s_mov_b32 s12, s24
    s_and_b32 s13, s25, 0xffff
    s_mov_b32 s14, 524288
    s_mov_b32 s15, 0x20000
    s_and_b32 s40, s46, 7
    s_lshr_b32 s41, s46, 3
    s_lshr_b32 s42, s41, 1
    s_lshl_b32 s42, s42, 3
    s_and_b32 s43, s41, 1
    s_add_u32 s42, s42, s43
    s_mul_i32 s42, s42, 8192
    s_mov_b32 s43, 16384
    v_mul_u32_u24 v232, 1024, v232
    s_mul_i32 s68, s40, 16
    s_add_u32 s68, s68, s41
    s_lshl_b32 s68, s68, 12
    s_add_u32 s68, s68, 524288
    s_mov_b32 s69, 1024
    v_lshl_add_u32 v236, v235, 5, v236
    s_mov_b32 s41, 8
    s_branch L_jgo_23
L_jn_25:
    s_sub_u32 s46, s46, 128
    s_cmp_ge_u32 s46, 352
    s_cbranch_scc1 L_jn_26
    s_mov_b32 s12, s28
    s_and_b32 s13, s29, 0xffff
    s_mov_b32 s14, 1409024
    s_mov_b32 s15, 0x20000
    s_mul_i32 s41, s46, 2979
    s_lshr_b32 s41, s41, 16
    s_mul_i32 s40, s41, 22
    s_sub_u32 s40, s46, s40
    s_lshr_b32 s42, s41, 1
    s_lshl_b32 s42, s42, 3
    s_and_b32 s43, s41, 1
    s_add_u32 s42, s42, s43
    s_mul_i32 s42, s42, 22016
    s_mov_b32 s43, 44032
    v_mul_u32_u24 v232, 2752, v232
    s_lshl_b32 s68, s40, 16
    s_lshl_b32 s69, s41, 10
    s_add_u32 s68, s68, s69
    s_add_u32 s68, s68, 1048576
    s_mov_b32 s69, 16384
    v_lshl_add_u32 v236, v235, 3, v236
    s_mov_b32 s41, 32
    s_branch L_jgo_23
L_jn_26:
    s_sub_u32 s46, s46, 352
    s_cmp_ge_u32 s46, 344
    s_cbranch_scc1 L_jn_27
    s_mov_b32 s12, s30
    s_and_b32 s13, s31, 0xffff
    s_mov_b32 s14, 1409024
    s_mov_b32 s15, 0x20000
    s_and_b32 s40, s46, 7
    s_lshr_b32 s41, s46, 3
    v_and_b32 v234, 3, v232
    v_lshrrev_b32 v232, 2, v232
    v_lshl_add_u32 v232, v232, 4, v234
    s_mul_i32 s42, s41, 32768
    s_mov_b32 s43, 4096
    v_mul_u32_u24 v232, 1024, v232
    s_mul_i32 s68, s40, 43
    s_add_u32 s68, s68, s41
    s_lshl_b32 s68, s68, 12
    s_add_u32 s68, s68, 2490368
    s_mov_b32 s69, 1024
    v_lshl_add_u32 v236, v235, 5, v236
    s_mov_b32 s41, 8
    s_branch L_jgo_23
L_jn_27:
    s_sub_u32 s46, s46, 344
    s_mov_b32 s12, s18
    s_and_b32 s13, s19, 0xffff
    s_mov_b32 s14, 0
    s_mov_b32 s15, 0x20000
    s_mov_b32 s68, 14680064
    s_mov_b32 s69, 0
    s_mov_b32 s40, 0
    s_mov_b32 s41, 0
    s_mov_b32 s42, 0
    s_mov_b32 s43, 0
L_jgo_23:
    s_lshl_b32 s40, s40, 7
    s_add_u32 s66, s42, s40
    s_mov_b32 s67, s43
    v_lshl_add_u32 v237, v233, 4, v232
    v_mov_b32 v232, v236
    v_add_u32 v233, s41, v232
    v_add_u32 v234, s41, v233
    v_add_u32 v235, s41, v234
    v_subrev_u32 v80, s45, v80
    v_subrev_u32 v81, s45, v81
    v_subrev_u32 v82, s45, v82
    v_subrev_u32 v83, s45, v83
    s_waitcnt lgkmcnt(0)
    v_lshrrev_b32 v85, 1, v4
    v_lshlrev_b32 v85, 9, v85
    v_lshl_add_u32 v85, v3, 4, v85
    v_and_b32 v86, 1, v4
    v_lshl_add_u32 v85, v86, 3, v85
    s_lshl_b32 s42, s3, 11
    s_add_u32 s42, s42, 135168
    v_add_u32 v85, s42, v85
    s_lshl_b32 s42, s3, 6
    s_add_u32 s42, s42, 160512
    v_lshlrev_b32 v86, 4, v4
    v_add_u32 v86, s42, v86
    s_lshl_b32 s45, s3, 14
    s_lshl_b32 s41, s6, 16
    s_add_u32 s41, s41, s45
    s_add_u32 s36, s41, 0
    s_add_u32 s41, s41, 524288
    s_lshl_b32 s44, s6, 11
    s_add_u32 s44, s44, s39
    s_add_u32 s45, s45, 69632
    s_lshr_b32 s37, s6, 1
    s_lshl_b32 s37, s37, 8
    s_and_b32 s48, s6, 1
    s_lshl_b32 s48, s48, 3
    s_add_u32 s37, s37, s48
    s_mov_b32 s52, 0x30800000
    s_mov_b32 s54, 0x23000000
    s_mov_b32 s58, 14024704
    s_add_u32 s49, s6, 1
    s_lshr_b32 s49, s49, 1
    s_min_u32 s49, s49, 3
    s_mul_i32 s50, s6, 5
    s_add_u32 s49, s49, s50
    s_add_u32 s51, s6, 2
    s_lshr_b32 s51, s51, 1
    s_min_u32 s51, s51, 3
    s_add_u32 s51, s51, s50
    s_add_u32 s51, s51, 5
    s_sub_u32 s51, s51, s49
    s_lshl_b32 s62, s3, 15
    s_lshl_b32 s63, s3, 14
    s_add_u32 s63, s63, 131072
    s_mul_i32 s55, s3, 45056
    s_lshl_b32 s48, s49, 15
    s_add_u32 s48, s48, 1048576
    s_lshl_b32 s42, s51, 15
    s_add_u32 s16, s32, s48
    s_addc_u32 s17, s33, 0
    s_and_b32 s17, s17, 0xffff
    s_mov_b32 s18, s42
    s_mov_b32 s19, 0x20000
    s_mul_i32 s48, s6, 176128
    s_add_u32 s48, s48, 2490368
    s_add_u32 s20, s32, s48
    s_addc_u32 s21, s33, 0
    s_and_b32 s21, s21, 0xffff
    s_mov_b32 s22, 176128
    s_mov_b32 s23, 0x20000
    s_mul_i32 s48, s5, 176128
    s_add_u32 s48, s48, 8388608
    s_add_u32 s28, s32, s48
    s_addc_u32 s29, s33, 0
    s_and_b32 s29, s29, 0xffff
    s_mov_b32 s30, 176128
    s_mov_b32 s31, 0x20000
    s_lshl_b32 s42, s49, 12
    s_add_u32 s48, s48, s42
    s_lshl_b32 s42, s51, 12
    s_add_u32 s24, s32, s48
    s_addc_u32 s25, s33, 0
    s_and_b32 s25, s25, 0xffff
    s_mov_b32 s26, s42
    s_mov_b32 s27, 0x20000
    v_add_u32 v14, 69632, v2
    v_lshlrev_b32 v15, 3, v1
    v_mov_b32 v178, 159744
    ds_write_b32 v178, v6 offset:0
    v_mov_b32 v5, 0xdddddddd
    s_lshl_b32 s48, s3, 14
    v_add_u32 v3, s48, v2
    s_lshl_b32 s48, s3, 10
    s_add_u32 s48, s48, 65536
    v_lshlrev_b32 v11, 2, v1
    v_add_u32 v11, s48, v11
    s_lshr_b32 s40, s3, 1
    s_lshl_b32 s42, s40, 11
    s_lshl_b32 s40, s40, 7
    s_and_b32 s48, s3, 1
    s_lshl_b32 s43, s48, 8
    s_add_u32 s42, s42, s43
    s_lshl_b32 s48, s48, 6
    s_add_u32 s40, s40, s48
    s_add_u32 s40, s40, 65536
    v_lshrrev_b32 v179, 4, v1
    v_lshlrev_b32 v4, 12, v179
    v_and_b32 v179, 15, v1
    v_lshl_add_u32 v4, v179, 4, v4
    v_add_u32 v4, s42, v4
    s_lshl_b32 s53, s7, 15
    s_lshl_b32 s48, s5, 8
    s_add_u32 s53, s53, s48
    s_add_u32 s53, s53, 4128768
    s_lshl_b32 s57, s3, 6
    s_add_u32 s57, s57, s53
    s_lshl_b32 s48, s6, 3
    s_add_u32 s70, s57, s48
    s_lshl_b32 s59, s6, 2
    s_add_u32 s59, s59, s3
    s_lshl_b32 s59, s59, 3
    s_add_u32 s59, s59, s53
    s_mul_i32 s46, s7, 10092544
    s_add_u32 s46, s46, 3932160
    s_mul_i32 s47, s3, 17408
    s_add_u32 s47, s47, s46
    s_add_u32 s47, s47, 65536
    s_lshl_b32 s48, s3, 14
    s_add_u32 s46, s46, s48
    v_and_b32 v178, 31, v1
    v_lshrrev_b32 v179, 5, v1
    v_mul_u32_u24 v10, 272, v179
    v_lshl_add_u32 v10, v178, 4, v10
    v_cmp_lt_u32 vcc, 16, v178
    v_mov_b32 v179, 0x7f000000
    v_lshlrev_b32 v0, 7, v1
    s_lshl_b32 s48, s3, 13
    v_cndmask_b32 v10, v10, v179, vcc
    s_lshl_b32 s42, s7, 15
    s_add_u32 s48, s48, s42
    s_add_u32 s48, s48, 14417920
    s_waitcnt vmcnt(0) lgkmcnt(0)
    s_cmp_eq_u32 s60, 0
    s_cbranch_scc1 L_nopub_28
    s_lshl_b32 s42, s4, 7
    s_add_u32 s42, s42, 14417920
    s_waitcnt vmcnt(0)
    s_mov_b64 exec, 1
    buffer_store_dwordx2 v[12:13], v6, s[8:11], s42 offen sc1
    s_mov_b64 exec, -1
    s_setprio 0
L_nopub_28:
    s_barrier
    ds_read_b64_tr_b16 v[16:17], v164 offset:0
    ds_read_b64_tr_b16 v[18:19], v164 offset:512
    ds_read_b128 v[88:91], v80 offset:0
    ds_read_b128 v[92:95], v80 offset:16384
    ds_read_b128 v[96:99], v80 offset:32768
    ds_read_b128 v[100:103], v80 offset:49152
    ds_read_b64_tr_b16 v[20:21], v164 offset:1024
    ds_read_b64_tr_b16 v[22:23], v164 offset:1536
    ds_read_b128 v[104:107], v81 offset:0
    ds_read_b128 v[108:111], v81 offset:16384
    s_waitcnt lgkmcnt(8)
    v_mfma_f32_16x16x32_bf16 v[140:143], v[16:19], v[120:123], 0
    ds_read_b64_tr_b16 v[24:25], v164 offset:8192
    ds_read_b64_tr_b16 v[26:27], v164 offset:8704
    s_waitcnt lgkmcnt(9)
    v_mfma_f32_16x16x32_bf16 v[124:127], v[16:19], v[88:91], 0
    ds_read_b128 v[88:91], v81 offset:32768
    s_waitcnt lgkmcnt(9)
    v_mfma_f32_16x16x32_bf16 v[128:131], v[16:19], v[92:95], 0
    ds_read_b128 v[92:95], v81 offset:49152
    s_waitcnt lgkmcnt(9)
    v_mfma_f32_16x16x32_bf16 v[132:135], v[16:19], v[96:99], 0
    ds_read_b128 v[96:99], v82 offset:0
    s_waitcnt lgkmcnt(9)
    v_mfma_f32_16x16x32_bf16 v[136:139], v[16:19], v[100:103], 0
    ds_read_b128 v[100:103], v82 offset:16384
    s_waitcnt lgkmcnt(8)
    v_mfma_f32_16x16x32_bf16 v[140:143], v[20:23], v[120:123], v[140:143]
    ds_read_b64_tr_b16 v[28:29], v164 offset:9216
    ds_read_b64_tr_b16 v[30:31], v164 offset:9728
    s_waitcnt lgkmcnt(9)
    v_mfma_f32_16x16x32_bf16 v[124:127], v[20:23], v[104:107], v[124:127]
    ds_read_b128 v[104:107], v82 offset:32768
    s_waitcnt lgkmcnt(9)
    v_mfma_f32_16x16x32_bf16 v[128:131], v[20:23], v[108:111], v[128:131]
    ds_read_b128 v[108:111], v82 offset:49152
    s_waitcnt lgkmcnt(7)
    v_mfma_f32_16x16x32_bf16 v[132:135], v[20:23], v[88:91], v[132:135]
    ds_read_b128 v[88:91], v83 offset:0
    s_waitcnt lgkmcnt(7)
    v_mfma_f32_16x16x32_bf16 v[136:139], v[20:23], v[92:95], v[136:139]
    ds_read_b128 v[92:95], v83 offset:16384
    v_mfma_f32_16x16x32_bf16 v[140:143], v[24:27], v[120:123], v[140:143]
    ds_read_b64_tr_b16 v[32:33], v164 offset:16384
    ds_read_b64_tr_b16 v[34:35], v164 offset:16896
    s_waitcnt lgkmcnt(9)
    v_mfma_f32_16x16x32_bf16 v[124:127], v[24:27], v[96:99], v[124:127]
    ds_read_b128 v[96:99], v83 offset:32768
    s_waitcnt lgkmcnt(9)
    v_mfma_f32_16x16x32_bf16 v[128:131], v[24:27], v[100:103], v[128:131]
    ds_read_b128 v[100:103], v83 offset:49152
    s_waitcnt lgkmcnt(7)
    v_mfma_f32_16x16x32_bf16 v[132:135], v[24:27], v[104:107], v[132:135]
    ds_read_b128 v[104:107], v80 offset:256
    s_waitcnt lgkmcnt(7)
    v_mfma_f32_16x16x32_bf16 v[136:139], v[24:27], v[108:111], v[136:139]
    ds_read_b128 v[108:111], v80 offset:16640
    v_mfma_f32_16x16x32_bf16 v[140:143], v[28:31], v[120:123], v[140:143]
    ds_read_b64_tr_b16 v[36:37], v164 offset:17408
    ds_read_b64_tr_b16 v[38:39], v164 offset:17920
    s_waitcnt lgkmcnt(9)
    v_mfma_f32_16x16x32_bf16 v[124:127], v[28:31], v[88:91], v[124:127]
    ds_read_b128 v[88:91], v80 offset:33024
    s_waitcnt lgkmcnt(9)
    v_mfma_f32_16x16x32_bf16 v[128:131], v[28:31], v[92:95], v[128:131]
    ds_read_b128 v[92:95], v80 offset:49408
    s_waitcnt lgkmcnt(7)
    v_mfma_f32_16x16x32_bf16 v[132:135], v[28:31], v[96:99], v[132:135]
    ds_read_b128 v[96:99], v81 offset:256
    s_waitcnt lgkmcnt(7)
    v_mfma_f32_16x16x32_bf16 v[136:139], v[28:31], v[100:103], v[136:139]
    ds_read_b128 v[100:103], v81 offset:16640
    v_mfma_f32_16x16x32_bf16 v[140:143], v[32:35], v[120:123], v[140:143]
    ds_read_b64_tr_b16 v[40:41], v164 offset:24576
    ds_read_b64_tr_b16 v[42:43], v164 offset:25088
    s_waitcnt lgkmcnt(9)
    v_mfma_f32_16x16x32_bf16 v[124:127], v[32:35], v[104:107], v[124:127]
    ds_read_b128 v[104:107], v81 offset:33024
    s_waitcnt lgkmcnt(9)
    v_mfma_f32_16x16x32_bf16 v[128:131], v[32:35], v[108:111], v[128:131]
    ds_read_b128 v[108:111], v81 offset:49408
    s_waitcnt lgkmcnt(7)
    v_mfma_f32_16x16x32_bf16 v[132:135], v[32:35], v[88:91], v[132:135]
    ds_read_b128 v[88:91], v82 offset:256
    s_waitcnt lgkmcnt(7)
    v_mfma_f32_16x16x32_bf16 v[136:139], v[32:35], v[92:95], v[136:139]
    ds_read_b128 v[92:95], v82 offset:16640
    v_mfma_f32_16x16x32_bf16 v[140:143], v[36:39], v[120:123], v[140:143]
    ds_read_b64_tr_b16 v[44:45], v164 offset:25600
    ds_read_b64_tr_b16 v[46:47], v164 offset:26112
    s_waitcnt lgkmcnt(9)
    v_mfma_f32_16x16x32_bf16 v[124:127], v[36:39], v[96:99], v[124:127]
    ds_read_b128 v[96:99], v82 offset:33024
    s_waitcnt lgkmcnt(9)
    v_mfma_f32_16x16x32_bf16 v[128:131], v[36:39], v[100:103], v[128:131]
    ds_read_b128 v[100:103], v82 offset:49408
    s_waitcnt lgkmcnt(7)
    v_mfma_f32_16x16x32_bf16 v[132:135], v[36:39], v[104:107], v[132:135]
    ds_read_b128 v[104:107], v83 offset:256
    s_waitcnt lgkmcnt(7)
    v_mfma_f32_16x16x32_bf16 v[136:139], v[36:39], v[108:111], v[136:139]
    ds_read_b128 v[108:111], v83 offset:16640
    v_mfma_f32_16x16x32_bf16 v[140:143], v[40:43], v[120:123], v[140:143]
    ds_read_b64_tr_b16 v[48:49], v164 offset:32768
    ds_read_b64_tr_b16 v[50:51], v164 offset:33280
    s_waitcnt lgkmcnt(9)
    v_mfma_f32_16x16x32_bf16 v[124:127], v[40:43], v[88:91], v[124:127]
    ds_read_b128 v[88:91], v83 offset:33024
    s_waitcnt lgkmcnt(9)
    v_mfma_f32_16x16x32_bf16 v[128:131], v[40:43], v[92:95], v[128:131]
    ds_read_b128 v[92:95], v83 offset:49408
    s_waitcnt lgkmcnt(7)
    v_mfma_f32_16x16x32_bf16 v[132:135], v[40:43], v[96:99], v[132:135]
    ds_read_b128 v[96:99], v80 offset:512
    s_waitcnt lgkmcnt(7)
    v_mfma_f32_16x16x32_bf16 v[136:139], v[40:43], v[100:103], v[136:139]
    ds_read_b128 v[100:103], v80 offset:16896
    v_mfma_f32_16x16x32_bf16 v[140:143], v[44:47], v[120:123], v[140:143]
    ds_read_b64_tr_b16 v[52:53], v164 offset:33792
    ds_read_b64_tr_b16 v[54:55], v164 offset:34304
    s_waitcnt lgkmcnt(9)
    v_mfma_f32_16x16x32_bf16 v[124:127], v[44:47], v[104:107], v[124:127]
    ds_read_b128 v[104:107], v80 offset:33280
    s_waitcnt lgkmcnt(9)
    v_mfma_f32_16x16x32_bf16 v[128:131], v[44:47], v[108:111], v[128:131]
    ds_read_b128 v[108:111], v80 offset:49664
    s_waitcnt lgkmcnt(7)
    v_mfma_f32_16x16x32_bf16 v[132:135], v[44:47], v[88:91], v[132:135]
    ds_read_b128 v[88:91], v81 offset:512
    buffer_load_dwordx2 v[176:177], v0, s[8:11], s48 offen sc1
    s_waitcnt lgkmcnt(7)
    v_mfma_f32_16x16x32_bf16 v[136:139], v[44:47], v[92:95], v[136:139]
    ds_read_b128 v[92:95], v81 offset:16896
    v_mfma_f32_16x16x32_bf16 v[140:143], v[48:51], v[120:123], v[140:143]
    ds_read_b64_tr_b16 v[56:57], v164 offset:40960
    ds_read_b64_tr_b16 v[58:59], v164 offset:41472
    s_waitcnt lgkmcnt(9)
    v_mfma_f32_16x16x32_bf16 v[124:127], v[48:51], v[96:99], v[124:127]
    ds_read_b128 v[96:99], v81 offset:33280
    s_waitcnt lgkmcnt(9)
    v_mfma_f32_16x16x32_bf16 v[128:131], v[48:51], v[100:103], v[128:131]
    ds_read_b128 v[100:103], v81 offset:49664
    s_waitcnt lgkmcnt(7)
    v_mfma_f32_16x16x32_bf16 v[132:135], v[48:51], v[104:107], v[132:135]
    ds_read_b128 v[104:107], v82 offset:512
    s_waitcnt lgkmcnt(7)
    v_mfma_f32_16x16x32_bf16 v[136:139], v[48:51], v[108:111], v[136:139]
    ds_read_b128 v[108:111], v82 offset:16896
    v_mfma_f32_16x16x32_bf16 v[140:143], v[52:55], v[120:123], v[140:143]
    ds_read_b64_tr_b16 v[60:61], v164 offset:41984
    ds_read_b64_tr_b16 v[62:63], v164 offset:42496
    s_waitcnt lgkmcnt(9)
    v_mfma_f32_16x16x32_bf16 v[124:127], v[52:55], v[88:91], v[124:127]
    ds_read_b128 v[88:91], v82 offset:33280
    s_waitcnt lgkmcnt(9)
    v_mfma_f32_16x16x32_bf16 v[128:131], v[52:55], v[92:95], v[128:131]
    ds_read_b128 v[92:95], v82 offset:49664
    s_waitcnt lgkmcnt(7)
    v_mfma_f32_16x16x32_bf16 v[132:135], v[52:55], v[96:99], v[132:135]
    ds_read_b128 v[96:99], v83 offset:512
    s_waitcnt lgkmcnt(7)
    v_mfma_f32_16x16x32_bf16 v[136:139], v[52:55], v[100:103], v[136:139]
    ds_read_b128 v[100:103], v83 offset:16896
    v_mfma_f32_16x16x32_bf16 v[140:143], v[56:59], v[120:123], v[140:143]
    ds_read_b64_tr_b16 v[64:65], v164 offset:49152
    ds_read_b64_tr_b16 v[66:67], v164 offset:49664
    s_waitcnt lgkmcnt(9)
    v_mfma_f32_16x16x32_bf16 v[124:127], v[56:59], v[104:107], v[124:127]
    ds_read_b128 v[104:107], v83 offset:33280
    s_waitcnt lgkmcnt(9)
    v_mfma_f32_16x16x32_bf16 v[128:131], v[56:59], v[108:111], v[128:131]
    ds_read_b128 v[108:111], v83 offset:49664
    s_waitcnt lgkmcnt(7)
    v_mfma_f32_16x16x32_bf16 v[132:135], v[56:59], v[88:91], v[132:135]
    ds_read_b128 v[88:91], v80 offset:768
    s_waitcnt lgkmcnt(7)
    v_mfma_f32_16x16x32_bf16 v[136:139], v[56:59], v[92:95], v[136:139]
    ds_read_b128 v[92:95], v80 offset:17152
    v_mfma_f32_16x16x32_bf16 v[140:143], v[60:63], v[120:123], v[140:143]
    ds_read_b64_tr_b16 v[68:69], v164 offset:50176
    ds_read_b64_tr_b16 v[70:71], v164 offset:50688
    s_waitcnt lgkmcnt(9)
    v_mfma_f32_16x16x32_bf16 v[124:127], v[60:63], v[96:99], v[124:127]
    ds_read_b128 v[96:99], v80 offset:33536
    s_waitcnt lgkmcnt(9)
    v_mfma_f32_16x16x32_bf16 v[128:131], v[60:63], v[100:103], v[128:131]
    ds_read_b128 v[100:103], v80 offset:49920
    s_waitcnt lgkmcnt(7)
    v_mfma_f32_16x16x32_bf16 v[132:135], v[60:63], v[104:107], v[132:135]
    ds_read_b128 v[104:107], v81 offset:768
    s_waitcnt lgkmcnt(7)
    v_mfma_f32_16x16x32_bf16 v[136:139], v[60:63], v[108:111], v[136:139]
    ds_read_b128 v[108:111], v81 offset:17152
    v_mfma_f32_16x16x32_bf16 v[140:143], v[64:67], v[120:123], v[140:143]
    ds_read_b64_tr_b16 v[72:73], v164 offset:57344
    ds_read_b64_tr_b16 v[74:75], v164 offset:57856
    s_waitcnt lgkmcnt(9)
    v_mfma_f32_16x16x32_bf16 v[124:127], v[64:67], v[88:91], v[124:127]
    ds_read_b128 v[88:91], v81 offset:33536
    s_waitcnt lgkmcnt(9)
    v_mfma_f32_16x16x32_bf16 v[128:131], v[64:67], v[92:95], v[128:131]
    ds_read_b128 v[92:95], v81 offset:49920
    s_waitcnt lgkmcnt(7)
    v_mfma_f32_16x16x32_bf16 v[132:135], v[64:67], v[96:99], v[132:135]
    ds_read_b128 v[96:99], v82 offset:768
    s_waitcnt lgkmcnt(7)
    v_mfma_f32_16x16x32_bf16 v[136:139], v[64:67], v[100:103], v[136:139]
    ds_read_b128 v[100:103], v82 offset:17152
    v_mfma_f32_16x16x32_bf16 v[140:143], v[68:71], v[120:123], v[140:143]
    ds_read_b64_tr_b16 v[76:77], v164 offset:58368
    ds_read_b64_tr_b16 v[78:79], v164 offset:58880
    s_waitcnt lgkmcnt(9)
    v_mfma_f32_16x16x32_bf16 v[124:127], v[68:71], v[104:107], v[124:127]
    ds_read_b128 v[104:107], v82 offset:33536
    s_waitcnt lgkmcnt(9)
    v_mfma_f32_16x16x32_bf16 v[128:131], v[68:71], v[108:111], v[128:131]
    ds_read_b128 v[108:111], v82 offset:49920
    s_waitcnt lgkmcnt(7)
    v_mfma_f32_16x16x32_bf16 v[132:135], v[68:71], v[88:91], v[132:135]
    ds_read_b128 v[88:91], v83 offset:768
    s_waitcnt lgkmcnt(7)
    v_mfma_f32_16x16x32_bf16 v[136:139], v[68:71], v[92:95], v[136:139]
    ds_read_b128 v[92:95], v83 offset:17152
    v_mfma_f32_16x16x32_bf16 v[140:143], v[72:75], v[120:123], v[140:143]
    s_waitcnt lgkmcnt(7)
    v_mfma_f32_16x16x32_bf16 v[124:127], v[72:75], v[96:99], v[124:127]
    ds_read_b128 v[96:99], v83 offset:33536
    s_waitcnt lgkmcnt(7)
    v_mfma_f32_16x16x32_bf16 v[128:131], v[72:75], v[100:103], v[128:131]
    ds_read_b128 v[100:103], v83 offset:49920
    s_waitcnt lgkmcnt(5)
    v_mfma_f32_16x16x32_bf16 v[132:135], v[72:75], v[104:107], v[132:135]
    ds_read_b64 v[156:157], v165 offset:0
    s_waitcnt lgkmcnt(5)
    v_mfma_f32_16x16x32_bf16 v[136:139], v[72:75], v[108:111], v[136:139]
    ds_read_b64 v[158:159], v165 offset:128
    v_mfma_f32_16x16x32_bf16 v[140:143], v[76:79], v[120:123], v[140:143]
    s_waitcnt lgkmcnt(5)
    v_mfma_f32_16x16x32_bf16 v[124:127], v[76:79], v[88:91], v[124:127]
    ds_read_b64 v[160:161], v165 offset:256
    s_waitcnt lgkmcnt(5)
    v_mfma_f32_16x16x32_bf16 v[128:131], v[76:79], v[92:95], v[128:131]
    ds_read_b64 v[162:163], v165 offset:384
    s_waitcnt lgkmcnt(5)
    v_mfma_f32_16x16x32_bf16 v[132:135], v[76:79], v[96:99], v[132:135]
    s_waitcnt lgkmcnt(4)
    v_mfma_f32_16x16x32_bf16 v[136:139], v[76:79], v[100:103], v[136:139]
    s_mov_b32 s43, 0
    s_branch L_pchk_31
L_poll_29:
    buffer_load_dwordx2 v[176:177], v0, s[8:11], s48 offen sc1
L_pchk_31:
    s_add_u32 s43, s43, 1
    s_waitcnt vmcnt(0)
    v_cmp_ne_u64 vcc, s[64:65], v[176:177]
    s_cmp_ge_u32 s43, 100000
    s_cbranch_scc1 L_polled_30
    s_nop 1
    s_cbranch_vccz L_polled_30
    s_mov_b64 exec, vcc
    s_sleep 2
    s_branch L_poll_29
L_polled_30:
    s_mov_b64 exec, -1
    s_waitcnt lgkmcnt(0)
    ds_write_b128 v86, v[140:143]
    s_add_u32 s60, s46, 0
    buffer_load_dwordx4 a[0:3], v2, s[8:11], s60 offen offset:0 sc1
    s_add_u32 s61, s47, 0
    buffer_load_dwordx4 a[64:67], v10, s[8:11], s61 offen offset:0 sc1
    buffer_load_dwordx4 a[68:71], v10, s[8:11], s61 offen offset:544 sc1
    v_fmac_f32 v124, v156, v140
    v_fmac_f32 v125, v156, v141
    v_fmac_f32 v126, v156, v142
    v_fmac_f32 v127, v156, v143
    v_mul_f32 v124, v157, v124
    v_mul_f32 v125, v157, v125
    v_mul_f32 v126, v157, v126
    v_mul_f32 v127, v157, v127
    v_cvt_pk_bf16_f32 v88, v124, v125
    v_cvt_pk_bf16_f32 v89, v126, v127
    ds_write_b64 v85, v[88:89] offset:0
    buffer_load_dwordx4 a[4:7], v2, s[8:11], s60 offen offset:1024 sc1
    buffer_load_dwordx4 a[72:75], v10, s[8:11], s61 offen offset:1088 sc1
    buffer_load_dwordx4 a[76:79], v10, s[8:11], s61 offen offset:1632 sc1
    v_fmac_f32 v128, v158, v140
    v_fmac_f32 v129, v158, v141
    v_fmac_f32 v130, v158, v142
    v_fmac_f32 v131, v158, v143
    v_mul_f32 v128, v159, v128
    v_mul_f32 v129, v159, v129
    v_mul_f32 v130, v159, v130
    v_mul_f32 v131, v159, v131
    v_cvt_pk_bf16_f32 v90, v128, v129
    v_cvt_pk_bf16_f32 v91, v130, v131
    ds_write_b64 v85, v[90:91] offset:256
    buffer_load_dwordx4 a[8:11], v2, s[8:11], s60 offen offset:2048 sc1
    buffer_load_dwordx4 a[80:83], v10, s[8:11], s61 offen offset:2176 sc1
    buffer_load_dwordx4 a[84:87], v10, s[8:11], s61 offen offset:2720 sc1
    v_fmac_f32 v132, v160, v140
    v_fmac_f32 v133, v160, v141
    v_fmac_f32 v134, v160, v142
    v_fmac_f32 v135, v160, v143
    v_mul_f32 v132, v161, v132
    v_mul_f32 v133, v161, v133
    v_mul_f32 v134, v161, v134
    v_mul_f32 v135, v161, v135
    v_cvt_pk_bf16_f32 v92, v132, v133
    v_cvt_pk_bf16_f32 v93, v134, v135
    ds_write_b64 v85, v[92:93] offset:1024
    buffer_load_dwordx4 a[12:15], v2, s[8:11], s60 offen offset:3072 sc1
    s_add_u32 s61, s47, 3264
    buffer_load_dwordx4 a[88:91], v10, s[8:11], s61 offen offset:0 sc1
    buffer_load_dwordx4 a[92:95], v10, s[8:11], s61 offen offset:544 sc1
    v_fmac_f32 v136, v162, v140
    v_fmac_f32 v137, v162, v141
    v_fmac_f32 v138, v162, v142
    v_fmac_f32 v139, v162, v143
    v_mul_f32 v136, v163, v136
    v_mul_f32 v137, v163, v137
    v_mul_f32 v138, v163, v138
    v_mul_f32 v139, v163, v139
    v_cvt_pk_bf16_f32 v94, v136, v137
    v_cvt_pk_bf16_f32 v95, v138, v139
    ds_write_b64 v85, v[94:95] offset:1280
L_top_2:
    s_waitcnt lgkmcnt(0)
    s_barrier
    v_add_u32 v0, 135168, v2
    ds_read_b128 v[16:19], v0 offset:0
    ds_read_b128 v[20:23], v0 offset:1024
    ds_read_b128 v[24:27], v0 offset:2048
    ds_read_b128 v[28:31], v0 offset:3072
    ds_read_b128 v[32:35], v0 offset:4096
    ds_read_b128 v[36:39], v0 offset:5120
    ds_read_b128 v[40:43], v0 offset:6144
    ds_read_b128 v[44:47], v0 offset:7168
    v_mfma_f32_32x32x8_bf16 v[80:95], v[6:7], v[6:7], 0
    v_mfma_f32_32x32x8_bf16 v[96:111], v[6:7], v[6:7], 0
    s_waitcnt lgkmcnt(0)
    s_waitcnt vmcnt(11)
    v_mfma_f32_32x32x16_bf16 v[48:63], a[0:3], v[16:19], 0
    s_nop 7
    s_nop 3
    v_exp_f32 v48, v48
    v_exp_f32 v49, v49
    s_add_u32 s60, s46, 4096
    buffer_load_dwordx4 a[16:19], v2, s[8:11], s60 offen offset:0 sc1
    buffer_load_dwordx4 a[96:99], v10, s[8:11], s61 offen offset:1088 sc1
    buffer_load_dwordx4 a[100:103], v10, s[8:11], s61 offen offset:1632 sc1
    v_exp_f32 v50, v50
    v_exp_f32 v51, v51
    v_exp_f32 v52, v52
    s_waitcnt vmcnt(11)
    v_mfma_f32_32x32x16_bf16 v[64:79], a[4:7], v[16:19], 0
    v_exp_f32 v53, v53
    v_exp_f32 v54, v54
    v_exp_f32 v55, v55
    v_exp_f32 v56, v56
    v_exp_f32 v57, v57
    v_smfmac_f32_32x32x32_bf16 v[80:95], a[64:67], v[48:55], v5
    v_exp_f32 v58, v58
    v_exp_f32 v59, v59
    v_exp_f32 v60, v60
    v_exp_f32 v61, v61
    v_exp_f32 v62, v62
    v_exp_f32 v63, v63
    v_exp_f32 v64, v64
    v_exp_f32 v65, v65
    v_smfmac_f32_32x32x32_bf16 v[80:95], a[68:71], v[56:63], v5
    buffer_load_dwordx4 a[20:23], v2, s[8:11], s60 offen offset:1024 sc1
    buffer_load_dwordx4 a[104:107], v10, s[8:11], s61 offen offset:2176 sc1
    buffer_load_dwordx4 a[108:111], v10, s[8:11], s61 offen offset:2720 sc1
    v_exp_f32 v66, v66
    v_exp_f32 v67, v67
    v_exp_f32 v68, v68
    s_waitcnt vmcnt(11)
    v_mfma_f32_32x32x16_bf16 v[48:63], a[8:11], v[16:19], 0
    v_exp_f32 v69, v69
    v_exp_f32 v70, v70
    v_exp_f32 v71, v71
    v_exp_f32 v72, v72
    v_exp_f32 v73, v73
    v_smfmac_f32_32x32x32_bf16 v[80:95], a[72:75], v[64:71], v5
    v_exp_f32 v74, v74
    v_exp_f32 v75, v75
    v_exp_f32 v76, v76
    v_exp_f32 v77, v77
    v_exp_f32 v78, v78
    v_exp_f32 v79, v79
    v_exp_f32 v48, v48
    v_exp_f32 v49, v49
    v_smfmac_f32_32x32x32_bf16 v[80:95], a[76:79], v[72:79], v5
    buffer_load_dwordx4 a[24:27], v2, s[8:11], s60 offen offset:2048 sc1
    s_add_u32 s61, s47, 6528
    buffer_load_dwordx4 a[112:115], v10, s[8:11], s61 offen offset:0 sc1
    buffer_load_dwordx4 a[116:119], v10, s[8:11], s61 offen offset:544 sc1
    v_exp_f32 v50, v50
    v_exp_f32 v51, v51
    v_exp_f32 v52, v52
    s_waitcnt vmcnt(11)
    v_mfma_f32_32x32x16_bf16 v[64:79], a[12:15], v[16:19], 0
    v_exp_f32 v53, v53
    v_exp_f32 v54, v54
    v_exp_f32 v55, v55
    v_exp_f32 v56, v56
    v_exp_f32 v57, v57
    v_smfmac_f32_32x32x32_bf16 v[80:95], a[80:83], v[48:55], v5
    v_exp_f32 v58, v58
    v_exp_f32 v59, v59
    v_exp_f32 v60, v60
    v_exp_f32 v61, v61
    v_exp_f32 v62, v62
    v_exp_f32 v63, v63
    v_exp_f32 v64, v64
    v_exp_f32 v65, v65
    v_smfmac_f32_32x32x32_bf16 v[80:95], a[84:87], v[56:63], v5
    buffer_load_dwordx4 a[28:31], v2, s[8:11], s60 offen offset:3072 sc1
    buffer_load_dwordx4 a[120:123], v10, s[8:11], s61 offen offset:1088 sc1
    buffer_load_dwordx4 a[124:127], v10, s[8:11], s61 offen offset:1632 sc1
    v_exp_f32 v66, v66
    v_exp_f32 v67, v67
    v_exp_f32 v68, v68
    s_waitcnt vmcnt(11)
    v_mfma_f32_32x32x16_bf16 v[48:63], a[16:19], v[16:19], 0
    v_exp_f32 v69, v69
    v_exp_f32 v70, v70
    v_exp_f32 v71, v71
    v_exp_f32 v72, v72
    v_exp_f32 v73, v73
    v_smfmac_f32_32x32x32_bf16 v[80:95], a[88:91], v[64:71], v5
    v_exp_f32 v74, v74
    v_exp_f32 v75, v75
    v_exp_f32 v76, v76
    v_exp_f32 v77, v77
    v_exp_f32 v78, v78
    v_exp_f32 v79, v79
    v_exp_f32 v48, v48
    v_exp_f32 v49, v49
    v_smfmac_f32_32x32x32_bf16 v[80:95], a[92:95], v[72:79], v5
    s_add_u32 s60, s46, 8192
    buffer_load_dwordx4 a[32:35], v2, s[8:11], s60 offen offset:0 sc1
    buffer_load_dwordx4 a[128:131], v10, s[8:11], s61 offen offset:2176 sc1
    buffer_load_dwordx4 a[132:135], v10, s[8:11], s61 offen offset:2720 sc1
    v_exp_f32 v50, v50
    v_exp_f32 v51, v51
    v_exp_f32 v52, v52
    s_waitcnt vmcnt(11)
    v_mfma_f32_32x32x16_bf16 v[64:79], a[20:23], v[16:19], 0
    v_exp_f32 v53, v53
    v_exp_f32 v54, v54
    v_exp_f32 v55, v55
    v_exp_f32 v56, v56
    v_exp_f32 v57, v57
    v_smfmac_f32_32x32x32_bf16 v[80:95], a[96:99], v[48:55], v5
    v_exp_f32 v58, v58
    v_exp_f32 v59, v59
    v_exp_f32 v60, v60
    v_exp_f32 v61, v61
    v_exp_f32 v62, v62
    v_exp_f32 v63, v63
    v_exp_f32 v64, v64
    v_exp_f32 v65, v65
    v_smfmac_f32_32x32x32_bf16 v[80:95], a[100:103], v[56:63], v5
    buffer_load_dwordx4 a[36:39], v2, s[8:11], s60 offen offset:1024 sc1
    s_add_u32 s61, s47, 9792
    buffer_load_dwordx4 a[136:139], v10, s[8:11], s61 offen offset:0 sc1
    buffer_load_dwordx4 a[140:143], v10, s[8:11], s61 offen offset:544 sc1
    v_exp_f32 v66, v66
    v_exp_f32 v67, v67
    v_exp_f32 v68, v68
    s_waitcnt vmcnt(11)
    v_mfma_f32_32x32x16_bf16 v[48:63], a[24:27], v[16:19], 0
    v_exp_f32 v69, v69
    v_exp_f32 v70, v70
    v_exp_f32 v71, v71
    v_exp_f32 v72, v72
    v_exp_f32 v73, v73
    v_smfmac_f32_32x32x32_bf16 v[80:95], a[104:107], v[64:71], v5
    v_exp_f32 v74, v74
    v_exp_f32 v75, v75
    v_exp_f32 v76, v76
    v_exp_f32 v77, v77
    v_exp_f32 v78, v78
    v_exp_f32 v79, v79
    v_exp_f32 v48, v48
    v_exp_f32 v49, v49
    v_smfmac_f32_32x32x32_bf16 v[80:95], a[108:111], v[72:79], v5
    buffer_load_dwordx4 a[40:43], v2, s[8:11], s60 offen offset:2048 sc1
    buffer_load_dwordx4 a[144:147], v10, s[8:11], s61 offen offset:1088 sc1
    buffer_load_dwordx4 a[148:151], v10, s[8:11], s61 offen offset:1632 sc1
    v_exp_f32 v50, v50
    v_exp_f32 v51, v51
    v_exp_f32 v52, v52
    s_waitcnt vmcnt(11)
    v_mfma_f32_32x32x16_bf16 v[64:79], a[28:31], v[16:19], 0
    v_exp_f32 v53, v53
    v_exp_f32 v54, v54
    v_exp_f32 v55, v55
    v_exp_f32 v56, v56
    v_exp_f32 v57, v57
    v_smfmac_f32_32x32x32_bf16 v[80:95], a[112:115], v[48:55], v5
    v_exp_f32 v58, v58
    v_exp_f32 v59, v59
    v_exp_f32 v60, v60
    v_exp_f32 v61, v61
    v_exp_f32 v62, v62
    v_exp_f32 v63, v63
    v_exp_f32 v64, v64
    v_exp_f32 v65, v65
    v_smfmac_f32_32x32x32_bf16 v[80:95], a[116:119], v[56:63], v5
    buffer_load_dwordx4 a[44:47], v2, s[8:11], s60 offen offset:3072 sc1
    buffer_load_dwordx4 a[152:155], v10, s[8:11], s61 offen offset:2176 sc1
    buffer_load_dwordx4 a[156:159], v10, s[8:11], s61 offen offset:2720 sc1
    v_exp_f32 v66, v66
    v_exp_f32 v67, v67
    v_exp_f32 v68, v68
    s_waitcnt vmcnt(11)
    v_mfma_f32_32x32x16_bf16 v[48:63], a[32:35], v[16:19], 0
    v_exp_f32 v69, v69
    v_exp_f32 v70, v70
    v_exp_f32 v71, v71
    v_exp_f32 v72, v72
    v_exp_f32 v73, v73
    v_smfmac_f32_32x32x32_bf16 v[80:95], a[120:123], v[64:71], v5
    v_exp_f32 v74, v74
    v_exp_f32 v75, v75
    v_exp_f32 v76, v76
    v_exp_f32 v77, v77
    v_exp_f32 v78, v78
    v_exp_f32 v79, v79
    v_exp_f32 v48, v48
    v_exp_f32 v49, v49
    v_smfmac_f32_32x32x32_bf16 v[80:95], a[124:127], v[72:79], v5
    s_add_u32 s60, s46, 12288
    buffer_load_dwordx4 a[48:51], v2, s[8:11], s60 offen offset:0 sc1
    s_add_u32 s61, s47, 13056
    buffer_load_dwordx4 a[160:163], v10, s[8:11], s61 offen offset:0 sc1
    buffer_load_dwordx4 a[164:167], v10, s[8:11], s61 offen offset:544 sc1
    v_exp_f32 v50, v50
    v_exp_f32 v51, v51
    v_exp_f32 v52, v52
    s_waitcnt vmcnt(11)
    v_mfma_f32_32x32x16_bf16 v[64:79], a[36:39], v[16:19], 0
    v_exp_f32 v53, v53
    v_exp_f32 v54, v54
    v_exp_f32 v55, v55
    v_exp_f32 v56, v56
    v_exp_f32 v57, v57
    v_smfmac_f32_32x32x32_bf16 v[80:95], a[128:131], v[48:55], v5
    v_exp_f32 v58, v58
    v_exp_f32 v59, v59
    v_exp_f32 v60, v60
    v_exp_f32 v61, v61
    v_exp_f32 v62, v62
    v_exp_f32 v63, v63
    v_exp_f32 v64, v64
    v_exp_f32 v65, v65
    v_smfmac_f32_32x32x32_bf16 v[80:95], a[132:135], v[56:63], v5
    buffer_load_dwordx4 a[52:55], v2, s[8:11], s60 offen offset:1024 sc1
    buffer_load_dwordx4 a[168:171], v10, s[8:11], s61 offen offset:1088 sc1
    buffer_load_dwordx4 a[172:175], v10, s[8:11], s61 offen offset:1632 sc1
    v_exp_f32 v66, v66
    v_exp_f32 v67, v67
    v_exp_f32 v68, v68
    s_waitcnt vmcnt(11)
    v_mfma_f32_32x32x16_bf16 v[48:63], a[40:43], v[16:19], 0
    v_exp_f32 v69, v69
    v_exp_f32 v70, v70
    v_exp_f32 v71, v71
    v_exp_f32 v72, v72
    v_exp_f32 v73, v73
    v_smfmac_f32_32x32x32_bf16 v[80:95], a[136:139], v[64:71], v5
    v_exp_f32 v74, v74
    v_exp_f32 v75, v75
    v_exp_f32 v76, v76
    v_exp_f32 v77, v77
    v_exp_f32 v78, v78
    v_exp_f32 v79, v79
    v_exp_f32 v48, v48
    v_exp_f32 v49, v49
    v_smfmac_f32_32x32x32_bf16 v[80:95], a[140:143], v[72:79], v5
    buffer_load_dwordx4 a[56:59], v2, s[8:11], s60 offen offset:2048 sc1
    buffer_load_dwordx4 a[176:179], v10, s[8:11], s61 offen offset:2176 sc1
    buffer_load_dwordx4 a[180:183], v10, s[8:11], s61 offen offset:2720 sc1
    v_exp_f32 v50, v50
    v_exp_f32 v51, v51
    v_exp_f32 v52, v52
    s_waitcnt vmcnt(11)
    v_mfma_f32_32x32x16_bf16 v[64:79], a[44:47], v[16:19], 0
    v_exp_f32 v53, v53
    v_exp_f32 v54, v54
    v_exp_f32 v55, v55
    v_exp_f32 v56, v56
    v_exp_f32 v57, v57
    v_smfmac_f32_32x32x32_bf16 v[80:95], a[144:147], v[48:55], v5
    v_exp_f32 v58, v58
    v_exp_f32 v59, v59
    v_exp_f32 v60, v60
    v_exp_f32 v61, v61
    v_exp_f32 v62, v62
    v_exp_f32 v63, v63
    v_exp_f32 v64, v64
    v_exp_f32 v65, v65
    v_smfmac_f32_32x32x32_bf16 v[80:95], a[148:151], v[56:63], v5
    buffer_load_dwordx4 a[60:63], v2, s[8:11], s60 offen offset:3072 sc1
    s_add_u32 s61, s47, 16320
    buffer_load_dwordx4 a[184:187], v10, s[8:11], s61 offen offset:0 sc1
    buffer_load_dwordx4 a[188:191], v10, s[8:11], s61 offen offset:544 sc1
    v_exp_f32 v66, v66
    v_exp_f32 v67, v67
    v_exp_f32 v68, v68
    s_waitcnt vmcnt(11)
    v_mfma_f32_32x32x16_bf16 v[48:63], a[48:51], v[16:19], 0
    v_exp_f32 v69, v69
    v_exp_f32 v70, v70
    v_exp_f32 v71, v71
    v_exp_f32 v72, v72
    v_exp_f32 v73, v73
    v_smfmac_f32_32x32x32_bf16 v[80:95], a[152:155], v[64:71], v5
    v_exp_f32 v74, v74
    v_exp_f32 v75, v75
    v_exp_f32 v76, v76
    v_exp_f32 v77, v77
    v_exp_f32 v78, v78
    v_exp_f32 v79, v79
    v_exp_f32 v48, v48
    v_exp_f32 v49, v49
    v_smfmac_f32_32x32x32_bf16 v[80:95], a[156:159], v[72:79], v5
    v_exp_f32 v50, v50
    v_exp_f32 v51, v51
    v_exp_f32 v52, v52
    s_waitcnt vmcnt(8)
    v_mfma_f32_32x32x16_bf16 v[64:79], a[52:55], v[16:19], 0
    v_exp_f32 v53, v53
    v_exp_f32 v54, v54
    v_exp_f32 v55, v55
    v_exp_f32 v56, v56
    v_exp_f32 v57, v57
    v_smfmac_f32_32x32x32_bf16 v[80:95], a[160:163], v[48:55], v5
    v_exp_f32 v58, v58
    v_exp_f32 v59, v59
    v_exp_f32 v60, v60
    v_exp_f32 v61, v61
    v_exp_f32 v62, v62
    v_exp_f32 v63, v63
    v_exp_f32 v64, v64
    v_exp_f32 v65, v65
    v_smfmac_f32_32x32x32_bf16 v[80:95], a[164:167], v[56:63], v5
    v_exp_f32 v66, v66
    v_exp_f32 v67, v67
    v_exp_f32 v68, v68
    s_waitcnt vmcnt(5)
    v_mfma_f32_32x32x16_bf16 v[48:63], a[56:59], v[16:19], 0
    v_exp_f32 v69, v69
    v_exp_f32 v70, v70
    v_exp_f32 v71, v71
    v_exp_f32 v72, v72
    v_exp_f32 v73, v73
    v_smfmac_f32_32x32x32_bf16 v[80:95], a[168:171], v[64:71], v5
    v_exp_f32 v74, v74
    v_exp_f32 v75, v75
    v_exp_f32 v76, v76
    v_exp_f32 v77, v77
    v_exp_f32 v78, v78
    v_exp_f32 v79, v79
    v_exp_f32 v48, v48
    v_exp_f32 v49, v49
    v_smfmac_f32_32x32x32_bf16 v[80:95], a[172:175], v[72:79], v5
    v_exp_f32 v50, v50
    v_exp_f32 v51, v51
    v_exp_f32 v52, v52
    s_waitcnt vmcnt(2)
    v_mfma_f32_32x32x16_bf16 v[64:79], a[60:63], v[16:19], 0
    v_exp_f32 v53, v53
    v_exp_f32 v54, v54
    v_exp_f32 v55, v55
    v_exp_f32 v56, v56
    v_exp_f32 v57, v57
    v_smfmac_f32_32x32x32_bf16 v[80:95], a[176:179], v[48:55], v5
    v_exp_f32 v58, v58
    v_exp_f32 v59, v59
    v_exp_f32 v60, v60
    v_exp_f32 v61, v61
    v_exp_f32 v62, v62
    v_exp_f32 v63, v63
    v_exp_f32 v64, v64
    v_exp_f32 v65, v65
    v_smfmac_f32_32x32x32_bf16 v[80:95], a[180:183], v[56:63], v5
    v_exp_f32 v66, v66
    v_exp_f32 v67, v67
    v_exp_f32 v68, v68
    v_mfma_f32_32x32x16_bf16 v[48:63], a[0:3], v[20:23], 0
    v_exp_f32 v69, v69
    v_exp_f32 v70, v70
    v_exp_f32 v71, v71
    v_exp_f32 v72, v72
    v_exp_f32 v73, v73
    s_waitcnt vmcnt(1)
    v_smfmac_f32_32x32x32_bf16 v[80:95], a[184:187], v[64:71], v5
    v_exp_f32 v74, v74
    v_exp_f32 v75, v75
    v_exp_f32 v76, v76
    v_exp_f32 v77, v77
    v_exp_f32 v78, v78
    v_exp_f32 v79, v79
    v_exp_f32 v48, v48
    v_exp_f32 v49, v49
    s_waitcnt vmcnt(0)
    v_smfmac_f32_32x32x32_bf16 v[80:95], a[188:191], v[72:79], v5
    v_exp_f32 v50, v50
    v_exp_f32 v51, v51
    v_exp_f32 v52, v52
    v_mfma_f32_32x32x16_bf16 v[64:79], a[4:7], v[20:23], 0
    v_exp_f32 v53, v53
    v_exp_f32 v54, v54
    v_exp_f32 v55, v55
    v_exp_f32 v56, v56
    v_exp_f32 v57, v57
    v_smfmac_f32_32x32x32_bf16 v[96:111], a[64:67], v[48:55], v5
    s_cmp_lg_u32 s7, 0
    s_cbranch_scc1 L_l0_32
    buffer_load_dwordx4 v[240:243], v237, s[12:15], s66 offen
    s_add_u32 s66, s66, s67
    buffer_load_dwordx4 v[244:247], v237, s[12:15], s66 offen
    s_add_u32 s66, s66, s67
    buffer_load_dwordx4 v[248:251], v237, s[12:15], s66 offen
    s_add_u32 s66, s66, s67
    buffer_load_dwordx4 v[252:255], v237, s[12:15], s66 offen
    s_add_u32 s66, s66, s67
    s_mov_b32 s12, s32
    s_and_b32 s13, s33, 0xffff
    s_mov_b32 s14, 14680064
    s_mov_b32 s15, 0x20000
L_l0_32:
    v_exp_f32 v58, v58
    v_exp_f32 v59, v59
    v_exp_f32 v60, v60
    v_exp_f32 v61, v61
    v_exp_f32 v62, v62
    v_exp_f32 v63, v63
    v_exp_f32 v64, v64
    v_exp_f32 v65, v65
    v_smfmac_f32_32x32x32_bf16 v[96:111], a[68:71], v[56:63], v5
    ds_write_b128 v3, v[80:83] offset:0
    v_exp_f32 v66, v66
    v_exp_f32 v67, v67
    v_exp_f32 v68, v68
    v_mfma_f32_32x32x16_bf16 v[48:63], a[8:11], v[20:23], 0
    v_exp_f32 v69, v69
    v_exp_f32 v70, v70
    v_exp_f32 v71, v71
    v_exp_f32 v72, v72
    v_exp_f32 v73, v73
    v_smfmac_f32_32x32x32_bf16 v[96:111], a[72:75], v[64:71], v5
    v_exp_f32 v74, v74
    v_exp_f32 v75, v75
    v_exp_f32 v76, v76
    v_exp_f32 v77, v77
    v_exp_f32 v78, v78
    v_exp_f32 v79, v79
    v_exp_f32 v48, v48
    v_exp_f32 v49, v49
    v_smfmac_f32_32x32x32_bf16 v[96:111], a[76:79], v[72:79], v5
    ds_write_b128 v3, v[84:87] offset:1024
    v_exp_f32 v50, v50
    v_exp_f32 v51, v51
    v_exp_f32 v52, v52
    v_mfma_f32_32x32x16_bf16 v[64:79], a[12:15], v[20:23], 0
    v_exp_f32 v53, v53
    v_exp_f32 v54, v54
    v_exp_f32 v55, v55
    v_exp_f32 v56, v56
    v_exp_f32 v57, v57
    v_smfmac_f32_32x32x32_bf16 v[96:111], a[80:83], v[48:55], v5
    v_exp_f32 v58, v58
    v_exp_f32 v59, v59
    v_exp_f32 v60, v60
    v_exp_f32 v61, v61
    v_exp_f32 v62, v62
    v_exp_f32 v63, v63
    v_exp_f32 v64, v64
    v_exp_f32 v65, v65
    v_smfmac_f32_32x32x32_bf16 v[96:111], a[84:87], v[56:63], v5
    s_mov_b32 exec_hi, 0
    ds_write_b32 v11, v88 offset:0
    s_mov_b32 exec_hi, -1
    v_exp_f32 v66, v66
    v_exp_f32 v67, v67
    v_exp_f32 v68, v68
    v_mfma_f32_32x32x16_bf16 v[48:63], a[16:19], v[20:23], 0
    v_exp_f32 v69, v69
    v_exp_f32 v70, v70
    v_exp_f32 v71, v71
    v_exp_f32 v72, v72
    v_exp_f32 v73, v73
    v_smfmac_f32_32x32x32_bf16 v[96:111], a[88:91], v[64:71], v5
    v_exp_f32 v74, v74
    v_exp_f32 v75, v75
    v_exp_f32 v76, v76
    v_exp_f32 v77, v77
    v_exp_f32 v78, v78
    v_exp_f32 v79, v79
    v_exp_f32 v48, v48
    v_exp_f32 v49, v49
    v_smfmac_f32_32x32x32_bf16 v[96:111], a[92:95], v[72:79], v5
    v_exp_f32 v50, v50
    v_exp_f32 v51, v51
    v_exp_f32 v52, v52
    v_mfma_f32_32x32x16_bf16 v[64:79], a[20:23], v[20:23], 0
    v_exp_f32 v53, v53
    v_exp_f32 v54, v54
    v_exp_f32 v55, v55
    v_exp_f32 v56, v56
    v_exp_f32 v57, v57
    v_smfmac_f32_32x32x32_bf16 v[96:111], a[96:99], v[48:55], v5
    v_exp_f32 v58, v58
    v_exp_f32 v59, v59
    v_exp_f32 v60, v60
    v_exp_f32 v61, v61
    v_exp_f32 v62, v62
    v_exp_f32 v63, v63
    v_exp_f32 v64, v64
    v_exp_f32 v65, v65
    v_smfmac_f32_32x32x32_bf16 v[96:111], a[100:103], v[56:63], v5
    v_exp_f32 v66, v66
    v_exp_f32 v67, v67
    v_exp_f32 v68, v68
    v_mfma_f32_32x32x16_bf16 v[48:63], a[24:27], v[20:23], 0
    v_exp_f32 v69, v69
    v_exp_f32 v70, v70
    v_exp_f32 v71, v71
    v_exp_f32 v72, v72
    v_exp_f32 v73, v73
    v_smfmac_f32_32x32x32_bf16 v[96:111], a[104:107], v[64:71], v5
    v_exp_f32 v74, v74
    v_exp_f32 v75, v75
    v_exp_f32 v76, v76
    v_exp_f32 v77, v77
    v_exp_f32 v78, v78
    v_exp_f32 v79, v79
    v_exp_f32 v48, v48
    v_exp_f32 v49, v49
    v_smfmac_f32_32x32x32_bf16 v[96:111], a[108:111], v[72:79], v5
    s_waitcnt lgkmcnt(0)
    v_exp_f32 v50, v50
    v_exp_f32 v51, v51
    v_exp_f32 v52, v52
    v_mfma_f32_32x32x16_bf16 v[64:79], a[28:31], v[20:23], 0
    v_exp_f32 v53, v53
    v_exp_f32 v54, v54
    v_exp_f32 v55, v55
    v_exp_f32 v56, v56
    v_exp_f32 v57, v57
    v_smfmac_f32_32x32x32_bf16 v[96:111], a[112:115], v[48:55], v5
    v_exp_f32 v58, v58
    v_exp_f32 v59, v59
    v_exp_f32 v60, v60
    v_exp_f32 v61, v61
    v_mfma_f32_32x32x8_bf16 v[80:95], v[6:7], v[6:7], 0
    v_exp_f32 v62, v62
    v_exp_f32 v63, v63
    v_exp_f32 v64, v64
    v_exp_f32 v65, v65
    v_smfmac_f32_32x32x32_bf16 v[96:111], a[116:119], v[56:63], v5
    v_exp_f32 v66, v66
    v_exp_f32 v67, v67
    v_exp_f32 v68, v68
    v_mfma_f32_32x32x16_bf16 v[48:63], a[32:35], v[20:23], 0
    v_exp_f32 v69, v69
    v_exp_f32 v70, v70
    v_exp_f32 v71, v71
    v_exp_f32 v72, v72
    v_exp_f32 v73, v73
    v_smfmac_f32_32x32x32_bf16 v[96:111], a[120:123], v[64:71], v5
    v_exp_f32 v74, v74
    v_exp_f32 v75, v75
    v_exp_f32 v76, v76
    v_exp_f32 v77, v77
    v_exp_f32 v78, v78
    v_exp_f32 v79, v79
    v_exp_f32 v48, v48
    v_exp_f32 v49, v49
    v_smfmac_f32_32x32x32_bf16 v[96:111], a[124:127], v[72:79], v5
    v_exp_f32 v50, v50
    v_exp_f32 v51, v51
    v_exp_f32 v52, v52
    v_mfma_f32_32x32x16_bf16 v[64:79], a[36:39], v[20:23], 0
    v_exp_f32 v53, v53
    v_exp_f32 v54, v54
    v_exp_f32 v55, v55
    v_exp_f32 v56, v56
    v_exp_f32 v57, v57
    v_smfmac_f32_32x32x32_bf16 v[96:111], a[128:131], v[48:55], v5
    v_exp_f32 v58, v58
    v_exp_f32 v59, v59
    v_exp_f32 v60, v60
    v_exp_f32 v61, v61
    v_exp_f32 v62, v62
    v_exp_f32 v63, v63
    v_exp_f32 v64, v64
    v_exp_f32 v65, v65
    v_smfmac_f32_32x32x32_bf16 v[96:111], a[132:135], v[56:63], v5
    v_exp_f32 v66, v66
    v_exp_f32 v67, v67
    v_exp_f32 v68, v68
    v_mfma_f32_32x32x16_bf16 v[48:63], a[40:43], v[20:23], 0
    v_exp_f32 v69, v69
    v_exp_f32 v70, v70
    v_exp_f32 v71, v71
    v_exp_f32 v72, v72
    v_exp_f32 v73, v73
    v_smfmac_f32_32x32x32_bf16 v[96:111], a[136:139], v[64:71], v5
    v_exp_f32 v74, v74
    v_exp_f32 v75, v75
    v_exp_f32 v76, v76
    v_exp_f32 v77, v77
    v_exp_f32 v78, v78
    v_exp_f32 v79, v79
    v_exp_f32 v48, v48
    v_exp_f32 v49, v49
    v_smfmac_f32_32x32x32_bf16 v[96:111], a[140:143], v[72:79], v5
    v_exp_f32 v50, v50
    v_exp_f32 v51, v51
    v_exp_f32 v52, v52
    v_mfma_f32_32x32x16_bf16 v[64:79], a[44:47], v[20:23], 0
    v_exp_f32 v53, v53
    v_exp_f32 v54, v54
    v_exp_f32 v55, v55
    v_exp_f32 v56, v56
    v_exp_f32 v57, v57
    v_smfmac_f32_32x32x32_bf16 v[96:111], a[144:147], v[48:55], v5
    v_exp_f32 v58, v58
    v_exp_f32 v59, v59
    v_exp_f32 v60, v60
    v_exp_f32 v61, v61
    v_exp_f32 v62, v62
    v_exp_f32 v63, v63
    v_exp_f32 v64, v64
    v_exp_f32 v65, v65
    v_smfmac_f32_32x32x32_bf16 v[96:111], a[148:151], v[56:63], v5
    v_exp_f32 v66, v66
    v_exp_f32 v67, v67
    v_exp_f32 v68, v68
    v_mfma_f32_32x32x16_bf16 v[48:63], a[48:51], v[20:23], 0
    v_exp_f32 v69, v69
    v_exp_f32 v70, v70
    v_exp_f32 v71, v71
    v_exp_f32 v72, v72
    v_exp_f32 v73, v73
    v_smfmac_f32_32x32x32_bf16 v[96:111], a[152:155], v[64:71], v5
    v_exp_f32 v74, v74
    v_exp_f32 v75, v75
    v_exp_f32 v76, v76
    v_exp_f32 v77, v77
    v_exp_f32 v78, v78
    v_exp_f32 v79, v79
    v_exp_f32 v48, v48
    v_exp_f32 v49, v49
    v_smfmac_f32_32x32x32_bf16 v[96:111], a[156:159], v[72:79], v5
    v_exp_f32 v50, v50
    v_exp_f32 v51, v51
    v_exp_f32 v52, v52
    v_mfma_f32_32x32x16_bf16 v[64:79], a[52:55], v[20:23], 0
    v_exp_f32 v53, v53
    v_exp_f32 v54, v54
    v_exp_f32 v55, v55
    v_exp_f32 v56, v56
    v_exp_f32 v57, v57
    v_smfmac_f32_32x32x32_bf16 v[96:111], a[160:163], v[48:55], v5
    v_exp_f32 v58, v58
    v_exp_f32 v59, v59
    v_exp_f32 v60, v60
    v_exp_f32 v61, v61
    v_exp_f32 v62, v62
    v_exp_f32 v63, v63
    v_exp_f32 v64, v64
    v_exp_f32 v65, v65
    v_smfmac_f32_32x32x32_bf16 v[96:111], a[164:167], v[56:63], v5
    v_exp_f32 v66, v66
    v_exp_f32 v67, v67
    v_exp_f32 v68, v68
    v_mfma_f32_32x32x16_bf16 v[48:63], a[56:59], v[20:23], 0
    v_exp_f32 v69, v69
    v_exp_f32 v70, v70
    v_exp_f32 v71, v71
    v_exp_f32 v72, v72
    v_exp_f32 v73, v73
    v_smfmac_f32_32x32x32_bf16 v[96:111], a[168:171], v[64:71], v5
    v_exp_f32 v74, v74
    v_exp_f32 v75, v75
    v_exp_f32 v76, v76
    v_exp_f32 v77, v77
    v_exp_f32 v78, v78
    v_exp_f32 v79, v79
    v_exp_f32 v48, v48
    v_exp_f32 v49, v49
    v_smfmac_f32_32x32x32_bf16 v[96:111], a[172:175], v[72:79], v5
    v_exp_f32 v50, v50
    v_exp_f32 v51, v51
    v_exp_f32 v52, v52
    v_mfma_f32_32x32x16_bf16 v[64:79], a[60:63], v[20:23], 0
    v_exp_f32 v53, v53
    v_exp_f32 v54, v54
    v_exp_f32 v55, v55
    v_exp_f32 v56, v56
    v_exp_f32 v57, v57
    v_smfmac_f32_32x32x32_bf16 v[96:111], a[176:179], v[48:55], v5
    s_cmp_lg_u32 s7, 0
    s_cbranch_scc1 L_l0_33
    s_waitcnt vmcnt(0)
    ds_write_b128 v3, v[240:243] offset:12288
    ds_write_b128 v3, v[244:247] offset:13312
    ds_write_b128 v3, v[248:251] offset:14336
    ds_write_b128 v3, v[252:255] offset:15360
L_l0_33:
    v_exp_f32 v58, v58
    v_exp_f32 v59, v59
    v_exp_f32 v60, v60
    v_exp_f32 v61, v61
    v_exp_f32 v62, v62
    v_exp_f32 v63, v63
    v_exp_f32 v64, v64
    v_exp_f32 v65, v65
    v_smfmac_f32_32x32x32_bf16 v[96:111], a[180:183], v[56:63], v5
    v_exp_f32 v66, v66
    v_exp_f32 v67, v67
    v_exp_f32 v68, v68
    v_mfma_f32_32x32x16_bf16 v[48:63], a[0:3], v[24:27], 0
    v_exp_f32 v69, v69
    v_exp_f32 v70, v70
    v_exp_f32 v71, v71
    v_exp_f32 v72, v72
    v_exp_f32 v73, v73
    v_smfmac_f32_32x32x32_bf16 v[96:111], a[184:187], v[64:71], v5
    s_cmp_lg_u32 s7, 0
    s_cbranch_scc1 L_l0_34
    s_waitcnt lgkmcnt(0)
    ds_read_b64_tr_b16 v[240:241], v232
    ds_read_b64_tr_b16 v[242:243], v232 offset:512
    ds_read_b64_tr_b16 v[244:245], v233
    ds_read_b64_tr_b16 v[246:247], v233 offset:512
    ds_read_b64_tr_b16 v[248:249], v234
    ds_read_b64_tr_b16 v[250:251], v234 offset:512
    ds_read_b64_tr_b16 v[252:253], v235
    ds_read_b64_tr_b16 v[254:255], v235 offset:512
L_l0_34:
    v_exp_f32 v74, v74
    v_exp_f32 v75, v75
    v_exp_f32 v76, v76
    v_exp_f32 v77, v77
    v_exp_f32 v78, v78
    v_exp_f32 v79, v79
    v_exp_f32 v48, v48
    v_exp_f32 v49, v49
    v_smfmac_f32_32x32x32_bf16 v[96:111], a[188:191], v[72:79], v5
    v_exp_f32 v50, v50
    v_exp_f32 v51, v51
    v_exp_f32 v52, v52
    v_mfma_f32_32x32x16_bf16 v[64:79], a[4:7], v[24:27], 0
    v_exp_f32 v53, v53
    v_exp_f32 v54, v54
    v_exp_f32 v55, v55
    v_exp_f32 v56, v56
    v_exp_f32 v57, v57
    v_smfmac_f32_32x32x32_bf16 v[80:95], a[64:67], v[48:55], v5
    s_cmp_lg_u32 s7, 0
    s_cbranch_scc1 L_l0_35
    s_waitcnt lgkmcnt(0)
    buffer_store_dwordx4 v[240:243], v2, s[8:11], s68 offen sc1
    s_add_u32 s68, s68, s69
    buffer_store_dwordx4 v[244:247], v2, s[8:11], s68 offen sc1
    s_add_u32 s68, s68, s69
    buffer_store_dwordx4 v[248:251], v2, s[8:11], s68 offen sc1
    s_add_u32 s68, s68, s69
    buffer_store_dwordx4 v[252:255], v2, s[8:11], s68 offen sc1
    s_add_u32 s68, s68, s69
L_l0_35:
    v_exp_f32 v58, v58
    v_exp_f32 v59, v59
    v_exp_f32 v60, v60
    v_exp_f32 v61, v61
    v_exp_f32 v62, v62
    v_exp_f32 v63, v63
    v_exp_f32 v64, v64
    v_exp_f32 v65, v65
    v_smfmac_f32_32x32x32_bf16 v[80:95], a[68:71], v[56:63], v5
    ds_write_b128 v3, v[96:99] offset:2048
    v_exp_f32 v66, v66
    v_exp_f32 v67, v67
    v_exp_f32 v68, v68
    v_mfma_f32_32x32x16_bf16 v[48:63], a[8:11], v[24:27], 0
    v_exp_f32 v69, v69
    v_exp_f32 v70, v70
    v_exp_f32 v71, v71
    v_exp_f32 v72, v72
    v_exp_f32 v73, v73
    v_smfmac_f32_32x32x32_bf16 v[80:95], a[72:75], v[64:71], v5
    v_exp_f32 v74, v74
    v_exp_f32 v75, v75
    v_exp_f32 v76, v76
    v_exp_f32 v77, v77
    v_exp_f32 v78, v78
    v_exp_f32 v79, v79
    v_exp_f32 v48, v48
    v_exp_f32 v49, v49
    v_smfmac_f32_32x32x32_bf16 v[80:95], a[76:79], v[72:79], v5
    ds_write_b128 v3, v[100:103] offset:3072
    v_exp_f32 v50, v50
    v_exp_f32 v51, v51
    v_exp_f32 v52, v52
    v_mfma_f32_32x32x16_bf16 v[64:79], a[12:15], v[24:27], 0
    v_exp_f32 v53, v53
    v_exp_f32 v54, v54
    v_exp_f32 v55, v55
    v_exp_f32 v56, v56
    v_exp_f32 v57, v57
    v_smfmac_f32_32x32x32_bf16 v[80:95], a[80:83], v[48:55], v5
    v_exp_f32 v58, v58
    v_exp_f32 v59, v59
    v_exp_f32 v60, v60
    v_exp_f32 v61, v61
    v_exp_f32 v62, v62
    v_exp_f32 v63, v63
    v_exp_f32 v64, v64
    v_exp_f32 v65, v65
    v_smfmac_f32_32x32x32_bf16 v[80:95], a[84:87], v[56:63], v5
    s_mov_b32 exec_hi, 0
    ds_write_b32 v11, v104 offset:128
    s_mov_b32 exec_hi, -1
    v_exp_f32 v66, v66
    v_exp_f32 v67, v67
    v_exp_f32 v68, v68
    v_mfma_f32_32x32x16_bf16 v[48:63], a[16:19], v[24:27], 0
    v_exp_f32 v69, v69
    v_exp_f32 v70, v70
    v_exp_f32 v71, v71
    v_exp_f32 v72, v72
    v_exp_f32 v73, v73
    v_smfmac_f32_32x32x32_bf16 v[80:95], a[88:91], v[64:71], v5
    v_exp_f32 v74, v74
    v_exp_f32 v75, v75
    v_exp_f32 v76, v76
    v_exp_f32 v77, v77
    v_exp_f32 v78, v78
    v_exp_f32 v79, v79
    v_exp_f32 v48, v48
    v_exp_f32 v49, v49
    v_smfmac_f32_32x32x32_bf16 v[80:95], a[92:95], v[72:79], v5
    v_exp_f32 v50, v50
    v_exp_f32 v51, v51
    v_exp_f32 v52, v52
    v_mfma_f32_32x32x16_bf16 v[64:79], a[20:23], v[24:27], 0
    v_exp_f32 v53, v53
    v_exp_f32 v54, v54
    v_exp_f32 v55, v55
    v_exp_f32 v56, v56
    v_exp_f32 v57, v57
    v_smfmac_f32_32x32x32_bf16 v[80:95], a[96:99], v[48:55], v5
    v_exp_f32 v58, v58
    v_exp_f32 v59, v59
    v_exp_f32 v60, v60
    v_exp_f32 v61, v61
    v_exp_f32 v62, v62
    v_exp_f32 v63, v63
    v_exp_f32 v64, v64
    v_exp_f32 v65, v65
    v_smfmac_f32_32x32x32_bf16 v[80:95], a[100:103], v[56:63], v5
    v_exp_f32 v66, v66
    v_exp_f32 v67, v67
    v_exp_f32 v68, v68
    v_mfma_f32_32x32x16_bf16 v[48:63], a[24:27], v[24:27], 0
    v_exp_f32 v69, v69
    v_exp_f32 v70, v70
    v_exp_f32 v71, v71
    v_exp_f32 v72, v72
    v_exp_f32 v73, v73
    v_smfmac_f32_32x32x32_bf16 v[80:95], a[104:107], v[64:71], v5
    v_exp_f32 v74, v74
    v_exp_f32 v75, v75
    v_exp_f32 v76, v76
    v_exp_f32 v77, v77
    v_exp_f32 v78, v78
    v_exp_f32 v79, v79
    v_exp_f32 v48, v48
    v_exp_f32 v49, v49
    v_smfmac_f32_32x32x32_bf16 v[80:95], a[108:111], v[72:79], v5
    s_waitcnt lgkmcnt(0)
    v_exp_f32 v50, v50
    v_exp_f32 v51, v51
    v_exp_f32 v52, v52
    v_mfma_f32_32x32x16_bf16 v[64:79], a[28:31], v[24:27], 0
    v_exp_f32 v53, v53
    v_exp_f32 v54, v54
    v_exp_f32 v55, v55
    v_exp_f32 v56, v56
    v_exp_f32 v57, v57
    v_smfmac_f32_32x32x32_bf16 v[80:95], a[112:115], v[48:55], v5
    s_cmp_lg_u32 s7, 0
    s_cbranch_scc1 L_l0_36
    s_waitcnt vmcnt(0)
    s_lshl_b32 s48, s4, 2
    s_add_u32 s48, s48, s3
    s_lshl_b32 s48, s48, 3
    s_add_u32 s48, s48, 4096000
    v_mov_b32 v120, s64
    v_mov_b32 v121, s71
    s_mov_b64 exec, 1
    buffer_store_dwordx2 v[120:121], v6, s[8:11], s48 offen sc1
    s_mov_b64 exec, -1
L_l0_36:
    v_exp_f32 v58, v58
    v_exp_f32 v59, v59
    v_exp_f32 v60, v60
    v_exp_f32 v61, v61
    v_mfma_f32_32x32x8_bf16 v[96:111], v[6:7], v[6:7], 0
    v_exp_f32 v62, v62
    v_exp_f32 v63, v63
    v_exp_f32 v64, v64
    v_exp_f32 v65, v65
    v_smfmac_f32_32x32x32_bf16 v[80:95], a[116:119], v[56:63], v5
    v_exp_f32 v66, v66
    v_exp_f32 v67, v67
    v_exp_f32 v68, v68
    v_mfma_f32_32x32x16_bf16 v[48:63], a[32:35], v[24:27], 0
    v_exp_f32 v69, v69
    v_exp_f32 v70, v70
    v_exp_f32 v71, v71
    v_exp_f32 v72, v72
    v_exp_f32 v73, v73
    v_smfmac_f32_32x32x32_bf16 v[80:95], a[120:123], v[64:71], v5
    v_exp_f32 v74, v74
    v_exp_f32 v75, v75
    v_exp_f32 v76, v76
    v_exp_f32 v77, v77
    v_exp_f32 v78, v78
    v_exp_f32 v79, v79
    v_exp_f32 v48, v48
    v_exp_f32 v49, v49
    v_smfmac_f32_32x32x32_bf16 v[80:95], a[124:127], v[72:79], v5
    v_exp_f32 v50, v50
    v_exp_f32 v51, v51
    v_exp_f32 v52, v52
    v_mfma_f32_32x32x16_bf16 v[64:79], a[36:39], v[24:27], 0
    v_exp_f32 v53, v53
    v_exp_f32 v54, v54
    v_exp_f32 v55, v55
    v_exp_f32 v56, v56
    v_exp_f32 v57, v57
    v_smfmac_f32_32x32x32_bf16 v[80:95], a[128:131], v[48:55], v5
    v_exp_f32 v58, v58
    v_exp_f32 v59, v59
    v_exp_f32 v60, v60
    v_exp_f32 v61, v61
    v_exp_f32 v62, v62
    v_exp_f32 v63, v63
    v_exp_f32 v64, v64
    v_exp_f32 v65, v65
    v_smfmac_f32_32x32x32_bf16 v[80:95], a[132:135], v[56:63], v5
    v_exp_f32 v66, v66
    v_exp_f32 v67, v67
    v_exp_f32 v68, v68
    v_mfma_f32_32x32x16_bf16 v[48:63], a[40:43], v[24:27], 0
    v_exp_f32 v69, v69
    v_exp_f32 v70, v70
    v_exp_f32 v71, v71
    v_exp_f32 v72, v72
    v_exp_f32 v73, v73
    v_smfmac_f32_32x32x32_bf16 v[80:95], a[136:139], v[64:71], v5
    v_exp_f32 v74, v74
    v_exp_f32 v75, v75
    v_exp_f32 v76, v76
    v_exp_f32 v77, v77
    v_exp_f32 v78, v78
    v_exp_f32 v79, v79
    v_exp_f32 v48, v48
    v_exp_f32 v49, v49
    v_smfmac_f32_32x32x32_bf16 v[80:95], a[140:143], v[72:79], v5
    v_exp_f32 v50, v50
    v_exp_f32 v51, v51
    v_exp_f32 v52, v52
    v_mfma_f32_32x32x16_bf16 v[64:79], a[44:47], v[24:27], 0
    v_exp_f32 v53, v53
    v_exp_f32 v54, v54
    v_exp_f32 v55, v55
    v_exp_f32 v56, v56
    v_exp_f32 v57, v57
    v_smfmac_f32_32x32x32_bf16 v[80:95], a[144:147], v[48:55], v5
    v_exp_f32 v58, v58
    v_exp_f32 v59, v59
    v_exp_f32 v60, v60
    v_exp_f32 v61, v61
    v_exp_f32 v62, v62
    v_exp_f32 v63, v63
    v_exp_f32 v64, v64
    v_exp_f32 v65, v65
    v_smfmac_f32_32x32x32_bf16 v[80:95], a[148:151], v[56:63], v5
    v_exp_f32 v66, v66
    v_exp_f32 v67, v67
    v_exp_f32 v68, v68
    v_mfma_f32_32x32x16_bf16 v[48:63], a[48:51], v[24:27], 0
    v_exp_f32 v69, v69
    v_exp_f32 v70, v70
    v_exp_f32 v71, v71
    v_exp_f32 v72, v72
    v_exp_f32 v73, v73
    v_smfmac_f32_32x32x32_bf16 v[80:95], a[152:155], v[64:71], v5
    v_exp_f32 v74, v74
    v_exp_f32 v75, v75
    v_exp_f32 v76, v76
    v_exp_f32 v77, v77
    v_exp_f32 v78, v78
    v_exp_f32 v79, v79
    v_exp_f32 v48, v48
    v_exp_f32 v49, v49
    v_smfmac_f32_32x32x32_bf16 v[80:95], a[156:159], v[72:79], v5
    v_exp_f32 v50, v50
    v_exp_f32 v51, v51
    v_exp_f32 v52, v52
    v_mfma_f32_32x32x16_bf16 v[64:79], a[52:55], v[24:27], 0
    v_exp_f32 v53, v53
    v_exp_f32 v54, v54
    v_exp_f32 v55, v55
    v_exp_f32 v56, v56
    v_exp_f32 v57, v57
    v_smfmac_f32_32x32x32_bf16 v[80:95], a[160:163], v[48:55], v5
    v_exp_f32 v58, v58
    v_exp_f32 v59, v59
    v_exp_f32 v60, v60
    v_exp_f32 v61, v61
    v_exp_f32 v62, v62
    v_exp_f32 v63, v63
    v_exp_f32 v64, v64
    v_exp_f32 v65, v65
    v_smfmac_f32_32x32x32_bf16 v[80:95], a[164:167], v[56:63], v5
    v_exp_f32 v66, v66
    v_exp_f32 v67, v67
    v_exp_f32 v68, v68
    v_mfma_f32_32x32x16_bf16 v[48:63], a[56:59], v[24:27], 0
    v_exp_f32 v69, v69
    v_exp_f32 v70, v70
    v_exp_f32 v71, v71
    v_exp_f32 v72, v72
    v_exp_f32 v73, v73
    v_smfmac_f32_32x32x32_bf16 v[80:95], a[168:171], v[64:71], v5
    v_exp_f32 v74, v74
    v_exp_f32 v75, v75
    v_exp_f32 v76, v76
    v_exp_f32 v77, v77
    v_exp_f32 v78, v78
    v_exp_f32 v79, v79
    v_exp_f32 v48, v48
    v_exp_f32 v49, v49
    v_smfmac_f32_32x32x32_bf16 v[80:95], a[172:175], v[72:79], v5
    v_exp_f32 v50, v50
    v_exp_f32 v51, v51
    v_exp_f32 v52, v52
    v_mfma_f32_32x32x16_bf16 v[64:79], a[60:63], v[24:27], 0
    v_exp_f32 v53, v53
    v_exp_f32 v54, v54
    v_exp_f32 v55, v55
    v_exp_f32 v56, v56
    v_exp_f32 v57, v57
    v_smfmac_f32_32x32x32_bf16 v[80:95], a[176:179], v[48:55], v5
    v_exp_f32 v58, v58
    v_exp_f32 v59, v59
    v_exp_f32 v60, v60
    v_exp_f32 v61, v61
    v_exp_f32 v62, v62
    v_exp_f32 v63, v63
    v_exp_f32 v64, v64
    v_exp_f32 v65, v65
    v_smfmac_f32_32x32x32_bf16 v[80:95], a[180:183], v[56:63], v5
    v_exp_f32 v66, v66
    v_exp_f32 v67, v67
    v_exp_f32 v68, v68
    v_mfma_f32_32x32x16_bf16 v[48:63], a[0:3], v[28:31], 0
    v_exp_f32 v69, v69
    v_exp_f32 v70, v70
    v_exp_f32 v71, v71
    v_exp_f32 v72, v72
    v_exp_f32 v73, v73
    v_smfmac_f32_32x32x32_bf16 v[80:95], a[184:187], v[64:71], v5
    v_exp_f32 v74, v74
    v_exp_f32 v75, v75
    v_exp_f32 v76, v76
    v_exp_f32 v77, v77
    v_exp_f32 v78, v78
    v_exp_f32 v79, v79
    v_exp_f32 v48, v48
    v_exp_f32 v49, v49
    v_smfmac_f32_32x32x32_bf16 v[80:95], a[188:191], v[72:79], v5
    v_exp_f32 v50, v50
    v_exp_f32 v51, v51
    v_exp_f32 v52, v52
    v_mfma_f32_32x32x16_bf16 v[64:79], a[4:7], v[28:31], 0
    v_exp_f32 v53, v53
    v_exp_f32 v54, v54
    v_exp_f32 v55, v55
    v_exp_f32 v56, v56
    v_exp_f32 v57, v57
    v_smfmac_f32_32x32x32_bf16 v[96:111], a[64:67], v[48:55], v5
    v_exp_f32 v58, v58
    v_exp_f32 v59, v59
    v_exp_f32 v60, v60
    v_exp_f32 v61, v61
    v_exp_f32 v62, v62
    v_exp_f32 v63, v63
    v_exp_f32 v64, v64
    v_exp_f32 v65, v65
    v_smfmac_f32_32x32x32_bf16 v[96:111], a[68:71], v[56:63], v5
    ds_write_b128 v3, v[80:83] offset:4096
    v_exp_f32 v66, v66
    v_exp_f32 v67, v67
    v_exp_f32 v68, v68
    v_mfma_f32_32x32x16_bf16 v[48:63], a[8:11], v[28:31], 0
    v_exp_f32 v69, v69
    v_exp_f32 v70, v70
    v_exp_f32 v71, v71
    v_exp_f32 v72, v72
    v_exp_f32 v73, v73
    v_smfmac_f32_32x32x32_bf16 v[96:111], a[72:75], v[64:71], v5
    v_exp_f32 v74, v74
    v_exp_f32 v75, v75
    v_exp_f32 v76, v76
    v_exp_f32 v77, v77
    v_exp_f32 v78, v78
    v_exp_f32 v79, v79
    v_exp_f32 v48, v48
    v_exp_f32 v49, v49
    v_smfmac_f32_32x32x32_bf16 v[96:111], a[76:79], v[72:79], v5
    ds_write_b128 v3, v[84:87] offset:5120
    v_exp_f32 v50, v50
    v_exp_f32 v51, v51
    v_exp_f32 v52, v52
    v_mfma_f32_32x32x16_bf16 v[64:79], a[12:15], v[28:31], 0
    v_exp_f32 v53, v53
    v_exp_f32 v54, v54
    v_exp_f32 v55, v55
    v_exp_f32 v56, v56
    v_exp_f32 v57, v57
    v_smfmac_f32_32x32x32_bf16 v[96:111], a[80:83], v[48:55], v5
    s_cmp_lg_u32 s7, 0
    s_cbranch_scc1 L_l0_37
    s_lshl_b32 s48, s3, 11
    s_add_u32 s48, s48, 4096000
    buffer_load_dwordx4 v[124:127], v2, s[8:11], s48 offen offset:0 sc1
    buffer_load_dwordx4 v[128:131], v2, s[8:11], s48 offen offset:1024 sc1
    s_lshl_b32 s48, s5, 8
    s_add_u32 s48, s48, 4096000
    v_and_b32 v122, 0xff, v15
    buffer_load_dwordx2 v[132:133], v122, s[8:11], s48 offen sc1
L_l0_37:
    v_exp_f32 v58, v58
    v_exp_f32 v59, v59
    v_exp_f32 v60, v60
    v_exp_f32 v61, v61
    v_exp_f32 v62, v62
    v_exp_f32 v63, v63
    v_exp_f32 v64, v64
    v_exp_f32 v65, v65
    v_smfmac_f32_32x32x32_bf16 v[96:111], a[84:87], v[56:63], v5
    s_mov_b32 exec_hi, 0
    ds_write_b32 v11, v88 offset:256
    s_mov_b32 exec_hi, -1
    v_exp_f32 v66, v66
    v_exp_f32 v67, v67
    v_exp_f32 v68, v68
    v_mfma_f32_32x32x16_bf16 v[48:63], a[16:19], v[28:31], 0
    v_exp_f32 v69, v69
    v_exp_f32 v70, v70
    v_exp_f32 v71, v71
    v_exp_f32 v72, v72
    v_exp_f32 v73, v73
    v_smfmac_f32_32x32x32_bf16 v[96:111], a[88:91], v[64:71], v5
    v_exp_f32 v74, v74
    v_exp_f32 v75, v75
    v_exp_f32 v76, v76
    v_exp_f32 v77, v77
    v_exp_f32 v78, v78
    v_exp_f32 v79, v79
    v_exp_f32 v48, v48
    v_exp_f32 v49, v49
    v_smfmac_f32_32x32x32_bf16 v[96:111], a[92:95], v[72:79], v5
    v_exp_f32 v50, v50
    v_exp_f32 v51, v51
    v_exp_f32 v52, v52
    v_mfma_f32_32x32x16_bf16 v[64:79], a[20:23], v[28:31], 0
    v_exp_f32 v53, v53
    v_exp_f32 v54, v54
    v_exp_f32 v55, v55
    v_exp_f32 v56, v56
    v_exp_f32 v57, v57
    v_smfmac_f32_32x32x32_bf16 v[96:111], a[96:99], v[48:55], v5
    v_exp_f32 v58, v58
    v_exp_f32 v59, v59
    v_exp_f32 v60, v60
    v_exp_f32 v61, v61
    v_exp_f32 v62, v62
    v_exp_f32 v63, v63
    v_exp_f32 v64, v64
    v_exp_f32 v65, v65
    v_smfmac_f32_32x32x32_bf16 v[96:111], a[100:103], v[56:63], v5
    v_exp_f32 v66, v66
    v_exp_f32 v67, v67
    v_exp_f32 v68, v68
    v_mfma_f32_32x32x16_bf16 v[48:63], a[24:27], v[28:31], 0
    v_exp_f32 v69, v69
    v_exp_f32 v70, v70
    v_exp_f32 v71, v71
    v_exp_f32 v72, v72
    v_exp_f32 v73, v73
    v_smfmac_f32_32x32x32_bf16 v[96:111], a[104:107], v[64:71], v5
    v_exp_f32 v74, v74
    v_exp_f32 v75, v75
    v_exp_f32 v76, v76
    v_exp_f32 v77, v77
    v_exp_f32 v78, v78
    v_exp_f32 v79, v79
    v_exp_f32 v48, v48
    v_exp_f32 v49, v49
    v_smfmac_f32_32x32x32_bf16 v[96:111], a[108:111], v[72:79], v5
    s_waitcnt lgkmcnt(0)
    v_exp_f32 v50, v50
    v_exp_f32 v51, v51
    v_exp_f32 v52, v52
    v_mfma_f32_32x32x16_bf16 v[64:79], a[28:31], v[28:31], 0
    v_exp_f32 v53, v53
    v_exp_f32 v54, v54
    v_exp_f32 v55, v55
    v_exp_f32 v56, v56
    v_exp_f32 v57, v57
    v_smfmac_f32_32x32x32_bf16 v[96:111], a[112:115], v[48:55], v5
    v_exp_f32 v58, v58
    v_exp_f32 v59, v59
    v_exp_f32 v60, v60
    v_exp_f32 v61, v61
    v_mfma_f32_32x32x8_bf16 v[80:95], v[6:7], v[6:7], 0
    v_exp_f32 v62, v62
    v_exp_f32 v63, v63
    v_exp_f32 v64, v64
    v_exp_f32 v65, v65
    v_smfmac_f32_32x32x32_bf16 v[96:111], a[116:119], v[56:63], v5
    v_exp_f32 v66, v66
    v_exp_f32 v67, v67
    v_exp_f32 v68, v68
    v_mfma_f32_32x32x16_bf16 v[48:63], a[32:35], v[28:31], 0
    v_exp_f32 v69, v69
    v_exp_f32 v70, v70
    v_exp_f32 v71, v71
    v_exp_f32 v72, v72
    v_exp_f32 v73, v73
    v_smfmac_f32_32x32x32_bf16 v[96:111], a[120:123], v[64:71], v5
    v_exp_f32 v74, v74
    v_exp_f32 v75, v75
    v_exp_f32 v76, v76
    v_exp_f32 v77, v77
    v_exp_f32 v78, v78
    v_exp_f32 v79, v79
    v_exp_f32 v48, v48
    v_exp_f32 v49, v49
    v_smfmac_f32_32x32x32_bf16 v[96:111], a[124:127], v[72:79], v5
    v_exp_f32 v50, v50
    v_exp_f32 v51, v51
    v_exp_f32 v52, v52
    v_mfma_f32_32x32x16_bf16 v[64:79], a[36:39], v[28:31], 0
    v_exp_f32 v53, v53
    v_exp_f32 v54, v54
    v_exp_f32 v55, v55
    v_exp_f32 v56, v56
    v_exp_f32 v57, v57
    v_smfmac_f32_32x32x32_bf16 v[96:111], a[128:131], v[48:55], v5
    s_cmp_lg_u32 s7, 0
    s_cbranch_scc1 L_l0_38
    s_mov_b32 s43, 0
    s_waitcnt vmcnt(0)
L_wchk_39:
    s_waitcnt vmcnt(0)
    v_xor_b32 v124, s64, v124
    v_xor_b32 v125, s71, v125
    v_xor_b32 v126, s64, v126
    v_xor_b32 v127, s71, v127
    v_xor_b32 v128, s64, v128
    v_xor_b32 v129, s71, v129
    v_xor_b32 v130, s64, v130
    v_xor_b32 v131, s71, v131
    v_xor_b32 v132, s64, v132
    v_xor_b32 v133, s71, v133
    v_cmp_ne_u32 s[48:49], 0, v133
    v_or3_b32 v124, v124, v126, v128
    v_or3_b32 v125, v125, v127, v129
    v_or3_b32 v124, v124, v130, v132
    v_or3_b32 v125, v125, v131, v133
    v_and_b32 v125, 0x0fffffff, v125
    v_or_b32 v124, v124, v125
    v_cmp_ne_u32 vcc, 0, v124
    s_cmp_lg_u64 s[48:49], 0
    s_cselect_b32 s56, 1, 0
    s_add_u32 s43, s43, 1
    s_cmp_ge_u32 s43, 100000
    s_cbranch_scc1 L_wok_40
    s_cbranch_vccz L_wok_40
    s_sleep 16
    s_lshl_b32 s48, s3, 11
    s_add_u32 s48, s48, 4096000
    buffer_load_dwordx4 v[124:127], v2, s[8:11], s48 offen offset:0 sc1
    buffer_load_dwordx4 v[128:131], v2, s[8:11], s48 offen offset:1024 sc1
    s_lshl_b32 s48, s5, 8
    s_add_u32 s48, s48, 4096000
    v_and_b32 v122, 0xff, v15
    buffer_load_dwordx2 v[132:133], v122, s[8:11], s48 offen sc1
    s_branch L_wchk_39
L_wok_40:
    s_barrier
L_l0_38:
    v_exp_f32 v58, v58
    v_exp_f32 v59, v59
    v_exp_f32 v60, v60
    v_exp_f32 v61, v61
    v_exp_f32 v62, v62
    v_exp_f32 v63, v63
    v_exp_f32 v64, v64
    v_exp_f32 v65, v65
    v_smfmac_f32_32x32x32_bf16 v[96:111], a[132:135], v[56:63], v5
    v_exp_f32 v66, v66
    v_exp_f32 v67, v67
    v_exp_f32 v68, v68
    v_mfma_f32_32x32x16_bf16 v[48:63], a[40:43], v[28:31], 0
    v_exp_f32 v69, v69
    v_exp_f32 v70, v70
    v_exp_f32 v71, v71
    v_exp_f32 v72, v72
    v_exp_f32 v73, v73
    v_smfmac_f32_32x32x32_bf16 v[96:111], a[136:139], v[64:71], v5
    s_mov_b32 s49, 0
    s_add_u32 m0, s45, s49
    s_add_u32 s49, s41, s49
    buffer_load_dwordx4 v2, s[8:11], s49 offen offset:0 sc1 lds
    v_exp_f32 v74, v74
    v_exp_f32 v75, v75
    v_exp_f32 v76, v76
    v_exp_f32 v77, v77
    v_exp_f32 v78, v78
    v_exp_f32 v79, v79
    v_exp_f32 v48, v48
    v_exp_f32 v49, v49
    v_smfmac_f32_32x32x32_bf16 v[96:111], a[140:143], v[72:79], v5
    v_exp_f32 v50, v50
    v_exp_f32 v51, v51
    v_exp_f32 v52, v52
    v_mfma_f32_32x32x16_bf16 v[64:79], a[44:47], v[28:31], 0
    v_exp_f32 v53, v53
    v_exp_f32 v54, v54
    v_exp_f32 v55, v55
    v_exp_f32 v56, v56
    v_exp_f32 v57, v57
    v_smfmac_f32_32x32x32_bf16 v[96:111], a[144:147], v[48:55], v5
    buffer_load_dwordx4 v2, s[8:11], s49 offen offset:1024 sc1 lds
    v_exp_f32 v58, v58
    v_exp_f32 v59, v59
    v_exp_f32 v60, v60
    v_exp_f32 v61, v61
    v_exp_f32 v62, v62
    v_exp_f32 v63, v63
    v_exp_f32 v64, v64
    v_exp_f32 v65, v65
    v_smfmac_f32_32x32x32_bf16 v[96:111], a[148:151], v[56:63], v5
    v_exp_f32 v66, v66
    v_exp_f32 v67, v67
    v_exp_f32 v68, v68
    v_mfma_f32_32x32x16_bf16 v[48:63], a[48:51], v[28:31], 0
    v_exp_f32 v69, v69
    v_exp_f32 v70, v70
    v_exp_f32 v71, v71
    v_exp_f32 v72, v72
    v_exp_f32 v73, v73
    v_smfmac_f32_32x32x32_bf16 v[96:111], a[152:155], v[64:71], v5
    buffer_load_dwordx4 v2, s[8:11], s49 offen offset:2048 sc1 lds
    v_exp_f32 v74, v74
    v_exp_f32 v75, v75
    v_exp_f32 v76, v76
    v_exp_f32 v77, v77
    v_exp_f32 v78, v78
    v_exp_f32 v79, v79
    v_exp_f32 v48, v48
    v_exp_f32 v49, v49
    v_smfmac_f32_32x32x32_bf16 v[96:111], a[156:159], v[72:79], v5
    v_exp_f32 v50, v50
    v_exp_f32 v51, v51
    v_exp_f32 v52, v52
    v_mfma_f32_32x32x16_bf16 v[64:79], a[52:55], v[28:31], 0
    s_cmp_lg_u32 s7, 0
    s_cbranch_scc1 L_l0_41
    v_lshlrev_b32 v9, 7, v1
    s_mul_i32 s50, s3, 6144
    s_mov_b64 exec, 0xff
    buffer_load_dword v8, v9, s[24:27], s50 offen sc1
    s_mov_b64 exec, -1
    s_add_u32 s50, s50, 1024
L_l0_41:
    v_exp_f32 v53, v53
    v_exp_f32 v54, v54
    v_exp_f32 v55, v55
    v_exp_f32 v56, v56
    v_exp_f32 v57, v57
    v_smfmac_f32_32x32x32_bf16 v[96:111], a[160:163], v[48:55], v5
    buffer_load_dwordx4 v2, s[8:11], s49 offen offset:3072 sc1 lds
    v_exp_f32 v58, v58
    v_exp_f32 v59, v59
    v_exp_f32 v60, v60
    v_exp_f32 v61, v61
    v_exp_f32 v62, v62
    v_exp_f32 v63, v63
    v_exp_f32 v64, v64
    v_exp_f32 v65, v65
    v_smfmac_f32_32x32x32_bf16 v[96:111], a[164:167], v[56:63], v5
    v_exp_f32 v66, v66
    v_exp_f32 v67, v67
    v_exp_f32 v68, v68
    v_mfma_f32_32x32x16_bf16 v[48:63], a[56:59], v[28:31], 0
    v_exp_f32 v69, v69
    v_exp_f32 v70, v70
    v_exp_f32 v71, v71
    v_exp_f32 v72, v72
    v_exp_f32 v73, v73
    v_smfmac_f32_32x32x32_bf16 v[96:111], a[168:171], v[64:71], v5
    s_mov_b32 s49, 4096
    s_add_u32 m0, s45, s49
    s_add_u32 s49, s41, s49
    buffer_load_dwordx4 v2, s[8:11], s49 offen offset:0 sc1 lds
    v_exp_f32 v74, v74
    v_exp_f32 v75, v75
    v_exp_f32 v76, v76
    v_exp_f32 v77, v77
    v_exp_f32 v78, v78
    v_exp_f32 v79, v79
    v_exp_f32 v48, v48
    v_exp_f32 v49, v49
    v_smfmac_f32_32x32x32_bf16 v[96:111], a[172:175], v[72:79], v5
    buffer_load_dwordx4 v2, s[8:11], s49 offen offset:1024 sc1 lds
    v_exp_f32 v50, v50
    v_exp_f32 v51, v51
    v_exp_f32 v52, v52
    v_mfma_f32_32x32x16_bf16 v[64:79], a[60:63], v[28:31], 0
    v_exp_f32 v53, v53
    v_exp_f32 v54, v54
    v_exp_f32 v55, v55
    v_exp_f32 v56, v56
    v_exp_f32 v57, v57
    v_smfmac_f32_32x32x32_bf16 v[96:111], a[176:179], v[48:55], v5
    buffer_load_dwordx4 v2, s[8:11], s49 offen offset:2048 sc1 lds
    v_exp_f32 v58, v58
    v_exp_f32 v59, v59
    v_exp_f32 v60, v60
    v_exp_f32 v61, v61
    v_exp_f32 v62, v62
    v_exp_f32 v63, v63
    v_exp_f32 v64, v64
    v_exp_f32 v65, v65
    v_smfmac_f32_32x32x32_bf16 v[96:111], a[180:183], v[56:63], v5
    v_exp_f32 v66, v66
    v_exp_f32 v67, v67
    v_exp_f32 v68, v68
    v_mfma_f32_32x32x16_bf16 v[48:63], a[0:3], v[32:35], 0
    v_exp_f32 v69, v69
    v_exp_f32 v70, v70
    v_exp_f32 v71, v71
    v_exp_f32 v72, v72
    v_exp_f32 v73, v73
    v_smfmac_f32_32x32x32_bf16 v[96:111], a[184:187], v[64:71], v5
    buffer_load_dwordx4 v2, s[8:11], s49 offen offset:3072 sc1 lds
    v_exp_f32 v74, v74
    v_exp_f32 v75, v75
    v_exp_f32 v76, v76
    v_exp_f32 v77, v77
    v_exp_f32 v78, v78
    v_exp_f32 v79, v79
    v_exp_f32 v48, v48
    v_exp_f32 v49, v49
    v_smfmac_f32_32x32x32_bf16 v[96:111], a[188:191], v[72:79], v5
    v_exp_f32 v50, v50
    v_exp_f32 v51, v51
    v_exp_f32 v52, v52
    v_mfma_f32_32x32x16_bf16 v[64:79], a[4:7], v[32:35], 0
    v_exp_f32 v53, v53
    v_exp_f32 v54, v54
    v_exp_f32 v55, v55
    v_exp_f32 v56, v56
    v_exp_f32 v57, v57
    v_smfmac_f32_32x32x32_bf16 v[80:95], a[64:67], v[48:55], v5
    s_mov_b32 s49, 8192
    s_add_u32 m0, s45, s49
    s_add_u32 s49, s41, s49
    buffer_load_dwordx4 v2, s[8:11], s49 offen offset:0 sc1 lds
    v_exp_f32 v58, v58
    v_exp_f32 v59, v59
    v_exp_f32 v60, v60
    v_exp_f32 v61, v61
    v_exp_f32 v62, v62
    v_exp_f32 v63, v63
    v_exp_f32 v64, v64
    v_exp_f32 v65, v65
    v_smfmac_f32_32x32x32_bf16 v[80:95], a[68:71], v[56:63], v5
    ds_write_b128 v3, v[96:99] offset:6144
    v_exp_f32 v66, v66
    v_exp_f32 v67, v67
    v_exp_f32 v68, v68
    v_mfma_f32_32x32x16_bf16 v[48:63], a[8:11], v[32:35], 0
    s_cmp_lg_u32 s7, 0
    s_cbranch_scc1 L_l0_42
    s_mov_b64 exec, 0xff
    buffer_load_dword v8, v9, s[24:27], s50 offen sc1
    s_mov_b64 exec, -1
    s_add_u32 s50, s50, 1024
L_l0_42:
    v_exp_f32 v69, v69
    v_exp_f32 v70, v70
    v_exp_f32 v71, v71
    v_exp_f32 v72, v72
    v_exp_f32 v73, v73
    v_smfmac_f32_32x32x32_bf16 v[80:95], a[72:75], v[64:71], v5
    buffer_load_dwordx4 v2, s[8:11], s49 offen offset:1024 sc1 lds
    v_exp_f32 v74, v74
    v_exp_f32 v75, v75
    v_exp_f32 v76, v76
    v_exp_f32 v77, v77
    v_exp_f32 v78, v78
    v_exp_f32 v79, v79
    v_exp_f32 v48, v48
    v_exp_f32 v49, v49
    v_smfmac_f32_32x32x32_bf16 v[80:95], a[76:79], v[72:79], v5
    ds_write_b128 v3, v[100:103] offset:7168
    v_exp_f32 v50, v50
    v_exp_f32 v51, v51
    v_exp_f32 v52, v52
    v_mfma_f32_32x32x16_bf16 v[64:79], a[12:15], v[32:35], 0
    v_exp_f32 v53, v53
    v_exp_f32 v54, v54
    v_exp_f32 v55, v55
    v_exp_f32 v56, v56
    v_exp_f32 v57, v57
    v_smfmac_f32_32x32x32_bf16 v[80:95], a[80:83], v[48:55], v5
    buffer_load_dwordx4 v2, s[8:11], s49 offen offset:2048 sc1 lds
    v_exp_f32 v58, v58
    v_exp_f32 v59, v59
    v_exp_f32 v60, v60
    v_exp_f32 v61, v61
    v_exp_f32 v62, v62
    v_exp_f32 v63, v63
    v_exp_f32 v64, v64
    v_exp_f32 v65, v65
    v_smfmac_f32_32x32x32_bf16 v[80:95], a[84:87], v[56:63], v5
    s_mov_b32 exec_hi, 0
    ds_write_b32 v11, v104 offset:384
    s_mov_b32 exec_hi, -1
    v_exp_f32 v66, v66
    v_exp_f32 v67, v67
    v_exp_f32 v68, v68
    v_mfma_f32_32x32x16_bf16 v[48:63], a[16:19], v[32:35], 0
    v_exp_f32 v69, v69
    v_exp_f32 v70, v70
    v_exp_f32 v71, v71
    v_exp_f32 v72, v72
    v_exp_f32 v73, v73
    v_smfmac_f32_32x32x32_bf16 v[80:95], a[88:91], v[64:71], v5
    buffer_load_dwordx4 v2, s[8:11], s49 offen offset:3072 sc1 lds
    v_exp_f32 v74, v74
    v_exp_f32 v75, v75
    v_exp_f32 v76, v76
    v_exp_f32 v77, v77
    v_exp_f32 v78, v78
    v_exp_f32 v79, v79
    v_exp_f32 v48, v48
    v_exp_f32 v49, v49
    v_smfmac_f32_32x32x32_bf16 v[80:95], a[92:95], v[72:79], v5
    s_mov_b32 s49, 12288
    s_add_u32 m0, s45, s49
    s_add_u32 s49, s41, s49
    buffer_load_dwordx4 v2, s[8:11], s49 offen offset:0 sc1 lds
    v_exp_f32 v50, v50
    v_exp_f32 v51, v51
    v_exp_f32 v52, v52
    v_mfma_f32_32x32x16_bf16 v[64:79], a[20:23], v[32:35], 0
    v_exp_f32 v53, v53
    v_exp_f32 v54, v54
    v_exp_f32 v55, v55
    v_exp_f32 v56, v56
    v_exp_f32 v57, v57
    v_smfmac_f32_32x32x32_bf16 v[80:95], a[96:99], v[48:55], v5
    buffer_load_dwordx4 v2, s[8:11], s49 offen offset:1024 sc1 lds
    v_exp_f32 v58, v58
    v_exp_f32 v59, v59
    v_exp_f32 v60, v60
    v_exp_f32 v61, v61
    v_exp_f32 v62, v62
    v_exp_f32 v63, v63
    v_exp_f32 v64, v64
    v_exp_f32 v65, v65
    v_smfmac_f32_32x32x32_bf16 v[80:95], a[100:103], v[56:63], v5
    v_exp_f32 v66, v66
    v_exp_f32 v67, v67
    v_exp_f32 v68, v68
    v_mfma_f32_32x32x16_bf16 v[48:63], a[24:27], v[32:35], 0
    v_exp_f32 v69, v69
    v_exp_f32 v70, v70
    v_exp_f32 v71, v71
    v_exp_f32 v72, v72
    v_exp_f32 v73, v73
    v_smfmac_f32_32x32x32_bf16 v[80:95], a[104:107], v[64:71], v5
    buffer_load_dwordx4 v2, s[8:11], s49 offen offset:2048 sc1 lds
    v_exp_f32 v74, v74
    v_exp_f32 v75, v75
    v_exp_f32 v76, v76
    v_exp_f32 v77, v77
    v_exp_f32 v78, v78
    v_exp_f32 v79, v79
    v_exp_f32 v48, v48
    v_exp_f32 v49, v49
    v_smfmac_f32_32x32x32_bf16 v[80:95], a[108:111], v[72:79], v5
    s_waitcnt lgkmcnt(0)
    v_exp_f32 v50, v50
    v_exp_f32 v51, v51
    v_exp_f32 v52, v52
    v_mfma_f32_32x32x16_bf16 v[64:79], a[28:31], v[32:35], 0
    s_cmp_lg_u32 s7, 0
    s_cbranch_scc1 L_l0_43
    s_mov_b64 exec, 0xff
    buffer_load_dword v8, v9, s[24:27], s50 offen sc1
    s_mov_b64 exec, -1
    s_add_u32 s50, s50, 1024
L_l0_43:
    v_exp_f32 v53, v53
    v_exp_f32 v54, v54
    v_exp_f32 v55, v55
    v_exp_f32 v56, v56
    v_exp_f32 v57, v57
    v_smfmac_f32_32x32x32_bf16 v[80:95], a[112:115], v[48:55], v5
    buffer_load_dwordx4 v2, s[8:11], s49 offen offset:3072 sc1 lds
    v_exp_f32 v58, v58
    v_exp_f32 v59, v59
    v_exp_f32 v60, v60
    v_exp_f32 v61, v61
    v_mfma_f32_32x32x8_bf16 v[96:111], v[6:7], v[6:7], 0
    v_exp_f32 v62, v62
    v_exp_f32 v63, v63
    v_exp_f32 v64, v64
    v_exp_f32 v65, v65
    v_smfmac_f32_32x32x32_bf16 v[80:95], a[116:119], v[56:63], v5
    v_exp_f32 v66, v66
    v_exp_f32 v67, v67
    v_exp_f32 v68, v68
    v_mfma_f32_32x32x16_bf16 v[48:63], a[32:35], v[32:35], 0
    v_exp_f32 v69, v69
    v_exp_f32 v70, v70
    v_exp_f32 v71, v71
    v_exp_f32 v72, v72
    v_exp_f32 v73, v73
    v_smfmac_f32_32x32x32_bf16 v[80:95], a[120:123], v[64:71], v5
    s_mov_b32 s61, 0
    s_add_u32 s51, s62, s61
    s_add_u32 s60, s51, 16384
    s_add_u32 s61, s63, s61
    buffer_load_dwordx4 v[120:123], v2, s[16:19], s51 offen offset:0 sc1
    v_exp_f32 v74, v74
    v_exp_f32 v75, v75
    v_exp_f32 v76, v76
    v_exp_f32 v77, v77
    v_exp_f32 v78, v78
    v_exp_f32 v79, v79
    v_exp_f32 v48, v48
    v_exp_f32 v49, v49
    v_smfmac_f32_32x32x32_bf16 v[80:95], a[124:127], v[72:79], v5
    v_exp_f32 v50, v50
    v_exp_f32 v51, v51
    v_exp_f32 v52, v52
    v_mfma_f32_32x32x16_bf16 v[64:79], a[36:39], v[32:35], 0
    v_exp_f32 v53, v53
    v_exp_f32 v54, v54
    v_exp_f32 v55, v55
    v_exp_f32 v56, v56
    v_exp_f32 v57, v57
    v_smfmac_f32_32x32x32_bf16 v[80:95], a[128:131], v[48:55], v5
    buffer_load_dwordx4 v[124:127], v2, s[16:19], s60 offen offset:0 sc1
    v_exp_f32 v58, v58
    v_exp_f32 v59, v59
    v_exp_f32 v60, v60
    v_exp_f32 v61, v61
    v_exp_f32 v62, v62
    v_exp_f32 v63, v63
    v_exp_f32 v64, v64
    v_exp_f32 v65, v65
    v_smfmac_f32_32x32x32_bf16 v[80:95], a[132:135], v[56:63], v5
    buffer_load_dwordx4 v[128:131], v2, s[16:19], s61 offen offset:0 sc1
    v_exp_f32 v66, v66
    v_exp_f32 v67, v67
    v_exp_f32 v68, v68
    v_mfma_f32_32x32x16_bf16 v[48:63], a[40:43], v[32:35], 0
    v_exp_f32 v69, v69
    v_exp_f32 v70, v70
    v_exp_f32 v71, v71
    v_exp_f32 v72, v72
    v_exp_f32 v73, v73
    v_smfmac_f32_32x32x32_bf16 v[80:95], a[136:139], v[64:71], v5
    buffer_load_dwordx4 v[132:135], v2, s[16:19], s51 offen offset:1024 sc1
    v_exp_f32 v74, v74
    v_exp_f32 v75, v75
    v_exp_f32 v76, v76
    v_exp_f32 v77, v77
    v_exp_f32 v78, v78
    v_exp_f32 v79, v79
    v_exp_f32 v48, v48
    v_exp_f32 v49, v49
    v_smfmac_f32_32x32x32_bf16 v[80:95], a[140:143], v[72:79], v5
    v_exp_f32 v50, v50
    v_exp_f32 v51, v51
    v_exp_f32 v52, v52
    v_mfma_f32_32x32x16_bf16 v[64:79], a[44:47], v[32:35], 0
    v_exp_f32 v53, v53
    v_exp_f32 v54, v54
    v_exp_f32 v55, v55
    v_exp_f32 v56, v56
    v_exp_f32 v57, v57
    v_smfmac_f32_32x32x32_bf16 v[80:95], a[144:147], v[48:55], v5
    buffer_load_dwordx4 v[136:139], v2, s[16:19], s60 offen offset:1024 sc1
    v_exp_f32 v58, v58
    v_exp_f32 v59, v59
    v_exp_f32 v60, v60
    v_exp_f32 v61, v61
    v_exp_f32 v62, v62
    v_exp_f32 v63, v63
    v_exp_f32 v64, v64
    v_exp_f32 v65, v65
    v_smfmac_f32_32x32x32_bf16 v[80:95], a[148:151], v[56:63], v5
    v_exp_f32 v66, v66
    v_exp_f32 v67, v67
    v_exp_f32 v68, v68
    v_mfma_f32_32x32x16_bf16 v[48:63], a[48:51], v[32:35], 0
    s_cmp_lg_u32 s7, 0
    s_cbranch_scc1 L_l0_44
    s_mov_b64 exec, 0xff
    buffer_load_dword v8, v9, s[24:27], s50 offen sc1
    s_mov_b64 exec, -1
    s_add_u32 s50, s50, 1024
L_l0_44:
    v_exp_f32 v69, v69
    v_exp_f32 v70, v70
    v_exp_f32 v71, v71
    v_exp_f32 v72, v72
    v_exp_f32 v73, v73
    v_smfmac_f32_32x32x32_bf16 v[80:95], a[152:155], v[64:71], v5
    buffer_load_dwordx4 v[140:143], v2, s[16:19], s61 offen offset:1024 sc1
    v_exp_f32 v74, v74
    v_exp_f32 v75, v75
    v_exp_f32 v76, v76
    v_exp_f32 v77, v77
    v_exp_f32 v78, v78
    v_exp_f32 v79, v79
    v_exp_f32 v48, v48
    v_exp_f32 v49, v49
    v_smfmac_f32_32x32x32_bf16 v[80:95], a[156:159], v[72:79], v5
    v_exp_f32 v50, v50
    v_exp_f32 v51, v51
    v_exp_f32 v52, v52
    v_mfma_f32_32x32x16_bf16 v[64:79], a[52:55], v[32:35], 0
    v_exp_f32 v53, v53
    v_exp_f32 v54, v54
    v_exp_f32 v55, v55
    v_exp_f32 v56, v56
    v_exp_f32 v57, v57
    v_smfmac_f32_32x32x32_bf16 v[80:95], a[160:163], v[48:55], v5
    buffer_load_dwordx4 v[144:147], v2, s[16:19], s51 offen offset:2048 sc1
    v_exp_f32 v58, v58
    v_exp_f32 v59, v59
    v_exp_f32 v60, v60
    v_exp_f32 v61, v61
    v_exp_f32 v62, v62
    v_exp_f32 v63, v63
    v_exp_f32 v64, v64
    v_exp_f32 v65, v65
    v_smfmac_f32_32x32x32_bf16 v[80:95], a[164:167], v[56:63], v5
    v_exp_f32 v66, v66
    v_exp_f32 v67, v67
    v_exp_f32 v68, v68
    v_mfma_f32_32x32x16_bf16 v[48:63], a[56:59], v[32:35], 0
    v_exp_f32 v69, v69
    v_exp_f32 v70, v70
    v_exp_f32 v71, v71
    v_exp_f32 v72, v72
    v_exp_f32 v73, v73
    v_smfmac_f32_32x32x32_bf16 v[80:95], a[168:171], v[64:71], v5
    buffer_load_dwordx4 v[148:151], v2, s[16:19], s60 offen offset:2048 sc1
    v_exp_f32 v74, v74
    v_exp_f32 v75, v75
    v_exp_f32 v76, v76
    v_exp_f32 v77, v77
    v_exp_f32 v78, v78
    v_exp_f32 v79, v79
    v_exp_f32 v48, v48
    v_exp_f32 v49, v49
    v_smfmac_f32_32x32x32_bf16 v[80:95], a[172:175], v[72:79], v5
    buffer_load_dwordx4 v[152:155], v2, s[16:19], s61 offen offset:2048 sc1
    v_exp_f32 v50, v50
    v_exp_f32 v51, v51
    v_exp_f32 v52, v52
    v_mfma_f32_32x32x16_bf16 v[64:79], a[60:63], v[32:35], 0
    v_exp_f32 v53, v53
    v_exp_f32 v54, v54
    v_exp_f32 v55, v55
    v_exp_f32 v56, v56
    v_exp_f32 v57, v57
    v_smfmac_f32_32x32x32_bf16 v[80:95], a[176:179], v[48:55], v5
    buffer_load_dwordx4 v[156:159], v2, s[16:19], s51 offen offset:3072 sc1
    v_exp_f32 v58, v58
    v_exp_f32 v59, v59
    v_exp_f32 v60, v60
    v_exp_f32 v61, v61
    v_exp_f32 v62, v62
    v_exp_f32 v63, v63
    v_exp_f32 v64, v64
    v_exp_f32 v65, v65
    v_smfmac_f32_32x32x32_bf16 v[80:95], a[180:183], v[56:63], v5
    v_exp_f32 v66, v66
    v_exp_f32 v67, v67
    v_exp_f32 v68, v68
    v_mfma_f32_32x32x16_bf16 v[48:63], a[0:3], v[36:39], 0
    v_exp_f32 v69, v69
    v_exp_f32 v70, v70
    v_exp_f32 v71, v71
    v_exp_f32 v72, v72
    v_exp_f32 v73, v73
    v_smfmac_f32_32x32x32_bf16 v[80:95], a[184:187], v[64:71], v5
    buffer_load_dwordx4 v[160:163], v2, s[16:19], s60 offen offset:3072 sc1
    v_exp_f32 v74, v74
    v_exp_f32 v75, v75
    v_exp_f32 v76, v76
    v_exp_f32 v77, v77
    v_exp_f32 v78, v78
    v_exp_f32 v79, v79
    v_exp_f32 v48, v48
    v_exp_f32 v49, v49
    v_smfmac_f32_32x32x32_bf16 v[80:95], a[188:191], v[72:79], v5
    v_exp_f32 v50, v50
    v_exp_f32 v51, v51
    v_exp_f32 v52, v52
    v_mfma_f32_32x32x16_bf16 v[64:79], a[4:7], v[36:39], 0
    s_cmp_lg_u32 s7, 0
    s_cbranch_scc1 L_l0_45
    s_mov_b64 exec, 0xff
    buffer_load_dword v8, v9, s[24:27], s50 offen sc1
    s_mov_b64 exec, -1
    s_add_u32 s50, s50, 1024
L_l0_45:
    v_exp_f32 v53, v53
    v_exp_f32 v54, v54
    v_exp_f32 v55, v55
    v_exp_f32 v56, v56
    v_exp_f32 v57, v57
    v_smfmac_f32_32x32x32_bf16 v[96:111], a[64:67], v[48:55], v5
    buffer_load_dwordx4 v[164:167], v2, s[16:19], s61 offen offset:3072 sc1
    v_exp_f32 v58, v58
    v_exp_f32 v59, v59
    v_exp_f32 v60, v60
    v_exp_f32 v61, v61
    v_exp_f32 v62, v62
    v_exp_f32 v63, v63
    v_exp_f32 v64, v64
    v_exp_f32 v65, v65
    v_smfmac_f32_32x32x32_bf16 v[96:111], a[68:71], v[56:63], v5
    ds_write_b128 v3, v[80:83] offset:8192
    v_exp_f32 v66, v66
    v_exp_f32 v67, v67
    v_exp_f32 v68, v68
    v_mfma_f32_32x32x16_bf16 v[48:63], a[8:11], v[36:39], 0
    v_exp_f32 v69, v69
    v_exp_f32 v70, v70
    v_exp_f32 v71, v71
    v_exp_f32 v72, v72
    v_exp_f32 v73, v73
    v_smfmac_f32_32x32x32_bf16 v[96:111], a[72:75], v[64:71], v5
    s_mov_b32 s61, 4096
    s_add_u32 s51, s62, s61
    s_add_u32 s60, s51, 16384
    s_add_u32 s61, s63, s61
    buffer_load_dwordx4 v[168:171], v2, s[16:19], s51 offen offset:0 sc1
    v_exp_f32 v74, v74
    v_exp_f32 v75, v75
    v_exp_f32 v76, v76
    v_exp_f32 v77, v77
    v_exp_f32 v78, v78
    v_exp_f32 v79, v79
    v_exp_f32 v48, v48
    v_exp_f32 v49, v49
    v_smfmac_f32_32x32x32_bf16 v[96:111], a[76:79], v[72:79], v5
    ds_write_b128 v3, v[84:87] offset:9216
    v_exp_f32 v50, v50
    v_exp_f32 v51, v51
    v_exp_f32 v52, v52
    v_mfma_f32_32x32x16_bf16 v[64:79], a[12:15], v[36:39], 0
    v_exp_f32 v53, v53
    v_exp_f32 v54, v54
    v_exp_f32 v55, v55
    v_exp_f32 v56, v56
    v_exp_f32 v57, v57
    v_smfmac_f32_32x32x32_bf16 v[96:111], a[80:83], v[48:55], v5
    buffer_load_dwordx4 v[172:175], v2, s[16:19], s60 offen offset:0 sc1
    v_exp_f32 v58, v58
    v_exp_f32 v59, v59
    v_exp_f32 v60, v60
    v_exp_f32 v61, v61
    v_exp_f32 v62, v62
    v_exp_f32 v63, v63
    v_exp_f32 v64, v64
    v_exp_f32 v65, v65
    v_smfmac_f32_32x32x32_bf16 v[96:111], a[84:87], v[56:63], v5
    s_mov_b32 exec_hi, 0
    ds_write_b32 v11, v88 offset:512
    s_mov_b32 exec_hi, -1
    v_exp_f32 v66, v66
    v_exp_f32 v67, v67
    v_exp_f32 v68, v68
    v_mfma_f32_32x32x16_bf16 v[48:63], a[16:19], v[36:39], 0
    v_exp_f32 v69, v69
    v_exp_f32 v70, v70
    v_exp_f32 v71, v71
    v_exp_f32 v72, v72
    v_exp_f32 v73, v73
    v_smfmac_f32_32x32x32_bf16 v[96:111], a[88:91], v[64:71], v5
    buffer_load_dwordx4 v[176:179], v2, s[16:19], s61 offen offset:0 sc1
    v_exp_f32 v74, v74
    v_exp_f32 v75, v75
    v_exp_f32 v76, v76
    v_exp_f32 v77, v77
    v_exp_f32 v78, v78
    v_exp_f32 v79, v79
    v_exp_f32 v48, v48
    v_exp_f32 v49, v49
    v_smfmac_f32_32x32x32_bf16 v[96:111], a[92:95], v[72:79], v5
    buffer_load_dwordx4 v[180:183], v2, s[16:19], s51 offen offset:1024 sc1
    v_exp_f32 v50, v50
    v_exp_f32 v51, v51
    v_exp_f32 v52, v52
    v_mfma_f32_32x32x16_bf16 v[64:79], a[20:23], v[36:39], 0
    v_exp_f32 v53, v53
    v_exp_f32 v54, v54
    v_exp_f32 v55, v55
    v_exp_f32 v56, v56
    v_exp_f32 v57, v57
    v_smfmac_f32_32x32x32_bf16 v[96:111], a[96:99], v[48:55], v5
    buffer_load_dwordx4 v[184:187], v2, s[16:19], s60 offen offset:1024 sc1
    v_exp_f32 v58, v58
    v_exp_f32 v59, v59
    v_exp_f32 v60, v60
    v_exp_f32 v61, v61
    v_exp_f32 v62, v62
    v_exp_f32 v63, v63
    v_exp_f32 v64, v64
    v_exp_f32 v65, v65
    v_smfmac_f32_32x32x32_bf16 v[96:111], a[100:103], v[56:63], v5
    v_exp_f32 v66, v66
    v_exp_f32 v67, v67
    v_exp_f32 v68, v68
    v_mfma_f32_32x32x16_bf16 v[48:63], a[24:27], v[36:39], 0
    s_cmp_lg_u32 s7, 0
    s_cbranch_scc1 L_l0_46
    s_mov_b64 exec, 0xff
    buffer_load_dword v8, v9, s[24:27], s50 offen sc1
    s_mov_b64 exec, -1
    s_add_u32 s50, s50, 1024
L_l0_46:
    v_exp_f32 v69, v69
    v_exp_f32 v70, v70
    v_exp_f32 v71, v71
    v_exp_f32 v72, v72
    v_exp_f32 v73, v73
    v_smfmac_f32_32x32x32_bf16 v[96:111], a[104:107], v[64:71], v5
    buffer_load_dwordx4 v[188:191], v2, s[16:19], s61 offen offset:1024 sc1
    v_exp_f32 v74, v74
    v_exp_f32 v75, v75
    v_exp_f32 v76, v76
    v_exp_f32 v77, v77
    v_exp_f32 v78, v78
    v_exp_f32 v79, v79
    v_exp_f32 v48, v48
    v_exp_f32 v49, v49
    v_smfmac_f32_32x32x32_bf16 v[96:111], a[108:111], v[72:79], v5
    s_waitcnt lgkmcnt(0)
    v_exp_f32 v50, v50
    v_exp_f32 v51, v51
    v_exp_f32 v52, v52
    v_mfma_f32_32x32x16_bf16 v[64:79], a[28:31], v[36:39], 0
    v_exp_f32 v53, v53
    v_exp_f32 v54, v54
    v_exp_f32 v55, v55
    v_exp_f32 v56, v56
    v_exp_f32 v57, v57
    v_smfmac_f32_32x32x32_bf16 v[96:111], a[112:115], v[48:55], v5
    buffer_load_dwordx4 v[192:195], v2, s[16:19], s51 offen offset:2048 sc1
    v_exp_f32 v58, v58
    v_exp_f32 v59, v59
    v_exp_f32 v60, v60
    v_exp_f32 v61, v61
    v_mfma_f32_32x32x8_bf16 v[80:95], v[6:7], v[6:7], 0
    v_exp_f32 v62, v62
    v_exp_f32 v63, v63
    v_exp_f32 v64, v64
    v_exp_f32 v65, v65
    v_smfmac_f32_32x32x32_bf16 v[96:111], a[116:119], v[56:63], v5
    v_exp_f32 v66, v66
    v_exp_f32 v67, v67
    v_exp_f32 v68, v68
    v_mfma_f32_32x32x16_bf16 v[48:63], a[32:35], v[36:39], 0
    v_exp_f32 v69, v69
    v_exp_f32 v70, v70
    v_exp_f32 v71, v71
    v_exp_f32 v72, v72
    v_exp_f32 v73, v73
    v_smfmac_f32_32x32x32_bf16 v[96:111], a[120:123], v[64:71], v5
    buffer_load_dwordx4 v[196:199], v2, s[16:19], s60 offen offset:2048 sc1
    v_exp_f32 v74, v74
    v_exp_f32 v75, v75
    v_exp_f32 v76, v76
    v_exp_f32 v77, v77
    v_exp_f32 v78, v78
    v_exp_f32 v79, v79
    v_exp_f32 v48, v48
    v_exp_f32 v49, v49
    v_smfmac_f32_32x32x32_bf16 v[96:111], a[124:127], v[72:79], v5
    v_exp_f32 v50, v50
    v_exp_f32 v51, v51
    v_exp_f32 v52, v52
    v_mfma_f32_32x32x16_bf16 v[64:79], a[36:39], v[36:39], 0
    v_exp_f32 v53, v53
    v_exp_f32 v54, v54
    v_exp_f32 v55, v55
    v_exp_f32 v56, v56
    v_exp_f32 v57, v57
    v_smfmac_f32_32x32x32_bf16 v[96:111], a[128:131], v[48:55], v5
    buffer_load_dwordx4 v[200:203], v2, s[16:19], s61 offen offset:2048 sc1
    v_exp_f32 v58, v58
    v_exp_f32 v59, v59
    v_exp_f32 v60, v60
    v_exp_f32 v61, v61
    v_exp_f32 v62, v62
    v_exp_f32 v63, v63
    v_exp_f32 v64, v64
    v_exp_f32 v65, v65
    v_smfmac_f32_32x32x32_bf16 v[96:111], a[132:135], v[56:63], v5
    buffer_load_dwordx4 v[204:207], v2, s[16:19], s51 offen offset:3072 sc1
    v_exp_f32 v66, v66
    v_exp_f32 v67, v67
    v_exp_f32 v68, v68
    v_mfma_f32_32x32x16_bf16 v[48:63], a[40:43], v[36:39], 0
    v_exp_f32 v69, v69
    v_exp_f32 v70, v70
    v_exp_f32 v71, v71
    v_exp_f32 v72, v72
    v_exp_f32 v73, v73
    v_smfmac_f32_32x32x32_bf16 v[96:111], a[136:139], v[64:71], v5
    buffer_load_dwordx4 v[208:211], v2, s[16:19], s60 offen offset:3072 sc1
    v_exp_f32 v74, v74
    v_exp_f32 v75, v75
    v_exp_f32 v76, v76
    v_exp_f32 v77, v77
    v_exp_f32 v78, v78
    v_exp_f32 v79, v79
    v_exp_f32 v48, v48
    v_exp_f32 v49, v49
    v_smfmac_f32_32x32x32_bf16 v[96:111], a[140:143], v[72:79], v5
    v_exp_f32 v50, v50
    v_exp_f32 v51, v51
    v_exp_f32 v52, v52
    v_mfma_f32_32x32x16_bf16 v[64:79], a[44:47], v[36:39], 0
    s_waitcnt vmcnt(23)
    s_cmp_lg_u32 s7, 0
    s_cbranch_scc1 L_l0_47
    s_add_u32 s50, s44, 6291456
    s_mov_b64 exec, 0xff
    buffer_load_dword v8, v9, s[8:11], s50 offen sc1
    s_mov_b64 exec, -1
    s_add_u32 s50, s50, 1024
L_l0_47:
    v_exp_f32 v53, v53
    v_exp_f32 v54, v54
    v_exp_f32 v55, v55
    v_exp_f32 v56, v56
    v_exp_f32 v57, v57
    v_smfmac_f32_32x32x32_bf16 v[96:111], a[144:147], v[48:55], v5
    buffer_load_dwordx4 v[212:215], v2, s[16:19], s61 offen offset:3072 sc1
    v_exp_f32 v58, v58
    v_exp_f32 v59, v59
    v_exp_f32 v60, v60
    v_exp_f32 v61, v61
    v_exp_f32 v62, v62
    v_exp_f32 v63, v63
    v_exp_f32 v64, v64
    v_exp_f32 v65, v65
    v_smfmac_f32_32x32x32_bf16 v[96:111], a[148:151], v[56:63], v5
    v_exp_f32 v66, v66
    v_exp_f32 v67, v67
    v_exp_f32 v68, v68
    v_mfma_f32_32x32x16_bf16 v[48:63], a[48:51], v[36:39], 0
    v_exp_f32 v69, v69
    v_exp_f32 v70, v70
    v_exp_f32 v71, v71
    v_exp_f32 v72, v72
    v_exp_f32 v73, v73
    v_smfmac_f32_32x32x32_bf16 v[96:111], a[152:155], v[64:71], v5
    s_mov_b32 s61, 8192
    s_add_u32 s51, s62, s61
    s_add_u32 s60, s51, 16384
    s_add_u32 s61, s63, s61
    buffer_load_dwordx4 v[216:219], v2, s[16:19], s51 offen offset:0 sc1
    v_exp_f32 v74, v74
    v_exp_f32 v75, v75
    v_exp_f32 v76, v76
    v_exp_f32 v77, v77
    v_exp_f32 v78, v78
    v_exp_f32 v79, v79
    v_exp_f32 v48, v48
    v_exp_f32 v49, v49
    v_smfmac_f32_32x32x32_bf16 v[96:111], a[156:159], v[72:79], v5
    v_exp_f32 v50, v50
    v_exp_f32 v51, v51
    v_exp_f32 v52, v52
    v_mfma_f32_32x32x16_bf16 v[64:79], a[52:55], v[36:39], 0
    v_exp_f32 v53, v53
    v_exp_f32 v54, v54
    v_exp_f32 v55, v55
    v_exp_f32 v56, v56
    v_exp_f32 v57, v57
    v_smfmac_f32_32x32x32_bf16 v[96:111], a[160:163], v[48:55], v5
    buffer_load_dwordx4 v[220:223], v2, s[16:19], s60 offen offset:0 sc1
    v_exp_f32 v58, v58
    v_exp_f32 v59, v59
    v_exp_f32 v60, v60
    v_exp_f32 v61, v61
    v_exp_f32 v62, v62
    v_exp_f32 v63, v63
    v_exp_f32 v64, v64
    v_exp_f32 v65, v65
    v_smfmac_f32_32x32x32_bf16 v[96:111], a[164:167], v[56:63], v5
    v_exp_f32 v66, v66
    v_exp_f32 v67, v67
    v_exp_f32 v68, v68
    v_mfma_f32_32x32x16_bf16 v[48:63], a[56:59], v[36:39], 0
    v_exp_f32 v69, v69
    v_exp_f32 v70, v70
    v_exp_f32 v71, v71
    v_exp_f32 v72, v72
    v_exp_f32 v73, v73
    v_smfmac_f32_32x32x32_bf16 v[96:111], a[168:171], v[64:71], v5
    buffer_load_dwordx4 v[224:227], v2, s[16:19], s61 offen offset:0 sc1
    v_exp_f32 v74, v74
    v_exp_f32 v75, v75
    v_exp_f32 v76, v76
    v_exp_f32 v77, v77
    v_exp_f32 v78, v78
    v_exp_f32 v79, v79
    v_exp_f32 v48, v48
    v_exp_f32 v49, v49
    v_smfmac_f32_32x32x32_bf16 v[96:111], a[172:175], v[72:79], v5
    buffer_load_dwordx4 v[228:231], v2, s[16:19], s51 offen offset:1024 sc1
    v_exp_f32 v50, v50
    v_exp_f32 v51, v51
    v_exp_f32 v52, v52
    v_mfma_f32_32x32x16_bf16 v[64:79], a[60:63], v[36:39], 0
    v_exp_f32 v53, v53
    v_exp_f32 v54, v54
    v_exp_f32 v55, v55
    v_exp_f32 v56, v56
    v_exp_f32 v57, v57
    v_smfmac_f32_32x32x32_bf16 v[96:111], a[176:179], v[48:55], v5
    buffer_load_dwordx4 v[232:235], v2, s[16:19], s60 offen offset:1024 sc1
    v_exp_f32 v58, v58
    v_exp_f32 v59, v59
    v_exp_f32 v60, v60
    v_exp_f32 v61, v61
    v_exp_f32 v62, v62
    v_exp_f32 v63, v63
    v_exp_f32 v64, v64
    v_exp_f32 v65, v65
    v_smfmac_f32_32x32x32_bf16 v[96:111], a[180:183], v[56:63], v5
    v_exp_f32 v66, v66
    v_exp_f32 v67, v67
    v_exp_f32 v68, v68
    v_mfma_f32_32x32x16_bf16 v[48:63], a[0:3], v[40:43], 0
    s_cmp_lg_u32 s7, 0
    s_cbranch_scc1 L_l0_48
    s_mov_b64 exec, 0xff
    buffer_load_dword v8, v9, s[8:11], s50 offen sc1
    s_mov_b64 exec, -1
    s_add_u32 s50, s50, 1024
L_l0_48:
    v_exp_f32 v69, v69
    v_exp_f32 v70, v70
    v_exp_f32 v71, v71
    v_exp_f32 v72, v72
    v_exp_f32 v73, v73
    v_smfmac_f32_32x32x32_bf16 v[96:111], a[184:187], v[64:71], v5
    buffer_load_dwordx4 v[236:239], v2, s[16:19], s61 offen offset:1024 sc1
    v_exp_f32 v74, v74
    v_exp_f32 v75, v75
    v_exp_f32 v76, v76
    v_exp_f32 v77, v77
    v_exp_f32 v78, v78
    v_exp_f32 v79, v79
    v_exp_f32 v48, v48
    v_exp_f32 v49, v49
    v_smfmac_f32_32x32x32_bf16 v[96:111], a[188:191], v[72:79], v5
    v_exp_f32 v50, v50
    v_exp_f32 v51, v51
    v_exp_f32 v52, v52
    v_mfma_f32_32x32x16_bf16 v[64:79], a[4:7], v[40:43], 0
    v_exp_f32 v53, v53
    v_exp_f32 v54, v54
    v_exp_f32 v55, v55
    v_exp_f32 v56, v56
    v_exp_f32 v57, v57
    v_smfmac_f32_32x32x32_bf16 v[80:95], a[64:67], v[48:55], v5
    buffer_load_dwordx4 v[240:243], v2, s[16:19], s51 offen offset:2048 sc1
    v_exp_f32 v58, v58
    v_exp_f32 v59, v59
    v_exp_f32 v60, v60
    v_exp_f32 v61, v61
    v_exp_f32 v62, v62
    v_exp_f32 v63, v63
    v_exp_f32 v64, v64
    v_exp_f32 v65, v65
    v_smfmac_f32_32x32x32_bf16 v[80:95], a[68:71], v[56:63], v5
    ds_write_b128 v3, v[96:99] offset:10240
    v_exp_f32 v66, v66
    v_exp_f32 v67, v67
    v_exp_f32 v68, v68
    v_mfma_f32_32x32x16_bf16 v[48:63], a[8:11], v[40:43], 0
    v_exp_f32 v69, v69
    v_exp_f32 v70, v70
    v_exp_f32 v71, v71
    v_exp_f32 v72, v72
    v_exp_f32 v73, v73
    v_smfmac_f32_32x32x32_bf16 v[80:95], a[72:75], v[64:71], v5
    buffer_load_dwordx4 v[244:247], v2, s[16:19], s60 offen offset:2048 sc1
    v_exp_f32 v74, v74
    v_exp_f32 v75, v75
    v_exp_f32 v76, v76
    v_exp_f32 v77, v77
    v_exp_f32 v78, v78
    v_exp_f32 v79, v79
    v_exp_f32 v48, v48
    v_exp_f32 v49, v49
    v_smfmac_f32_32x32x32_bf16 v[80:95], a[76:79], v[72:79], v5
    ds_write_b128 v3, v[100:103] offset:11264
    v_exp_f32 v50, v50
    v_exp_f32 v51, v51
    v_exp_f32 v52, v52
    v_mfma_f32_32x32x16_bf16 v[64:79], a[12:15], v[40:43], 0
    v_exp_f32 v53, v53
    v_exp_f32 v54, v54
    v_exp_f32 v55, v55
    v_exp_f32 v56, v56
    v_exp_f32 v57, v57
    v_smfmac_f32_32x32x32_bf16 v[80:95], a[80:83], v[48:55], v5
    buffer_load_dwordx4 v[248:251], v2, s[16:19], s61 offen offset:2048 sc1
    v_exp_f32 v58, v58
    v_exp_f32 v59, v59
    v_exp_f32 v60, v60
    v_exp_f32 v61, v61
    v_exp_f32 v62, v62
    v_exp_f32 v63, v63
    v_exp_f32 v64, v64
    v_exp_f32 v65, v65
    v_smfmac_f32_32x32x32_bf16 v[80:95], a[84:87], v[56:63], v5
    s_mov_b32 exec_hi, 0
    ds_write_b32 v11, v104 offset:640
    s_mov_b32 exec_hi, -1
    v_exp_f32 v66, v66
    v_exp_f32 v67, v67
    v_exp_f32 v68, v68
    v_mfma_f32_32x32x16_bf16 v[48:63], a[16:19], v[40:43], 0
    v_exp_f32 v69, v69
    v_exp_f32 v70, v70
    v_exp_f32 v71, v71
    v_exp_f32 v72, v72
    v_exp_f32 v73, v73
    v_smfmac_f32_32x32x32_bf16 v[80:95], a[88:91], v[64:71], v5
    buffer_load_dwordx4 v[252:255], v2, s[16:19], s51 offen offset:3072 sc1
    v_exp_f32 v74, v74
    v_exp_f32 v75, v75
    v_exp_f32 v76, v76
    v_exp_f32 v77, v77
    v_exp_f32 v78, v78
    v_exp_f32 v79, v79
    v_exp_f32 v48, v48
    v_exp_f32 v49, v49
    v_smfmac_f32_32x32x32_bf16 v[80:95], a[92:95], v[72:79], v5
    buffer_load_dwordx4 a[192:195], v2, s[16:19], s60 offen offset:3072 sc1
    v_exp_f32 v50, v50
    v_exp_f32 v51, v51
    v_exp_f32 v52, v52
    v_mfma_f32_32x32x16_bf16 v[64:79], a[20:23], v[40:43], 0
    s_cmp_lg_u32 s7, 0
    s_cbranch_scc1 L_l0_49
    s_add_u32 s50, s38, 14221312
    s_mov_b64 exec, 0xff
    buffer_load_dword v8, v9, s[8:11], s50 offen sc1
    s_mov_b64 exec, -1
    s_add_u32 s50, s50, 1024
L_l0_49:
    v_exp_f32 v53, v53
    v_exp_f32 v54, v54
    v_exp_f32 v55, v55
    v_exp_f32 v56, v56
    v_exp_f32 v57, v57
    v_smfmac_f32_32x32x32_bf16 v[80:95], a[96:99], v[48:55], v5
    buffer_load_dwordx4 a[196:199], v2, s[16:19], s61 offen offset:3072 sc1
    v_exp_f32 v58, v58
    v_exp_f32 v59, v59
    v_exp_f32 v60, v60
    v_exp_f32 v61, v61
    v_exp_f32 v62, v62
    v_exp_f32 v63, v63
    v_exp_f32 v64, v64
    v_exp_f32 v65, v65
    v_smfmac_f32_32x32x32_bf16 v[80:95], a[100:103], v[56:63], v5
    v_exp_f32 v66, v66
    v_exp_f32 v67, v67
    v_exp_f32 v68, v68
    v_mfma_f32_32x32x16_bf16 v[48:63], a[24:27], v[40:43], 0
    v_exp_f32 v69, v69
    v_exp_f32 v70, v70
    v_exp_f32 v71, v71
    v_exp_f32 v72, v72
    v_exp_f32 v73, v73
    v_smfmac_f32_32x32x32_bf16 v[80:95], a[104:107], v[64:71], v5
    s_mov_b32 s61, 12288
    s_add_u32 s51, s62, s61
    s_add_u32 s60, s51, 16384
    s_add_u32 s61, s63, s61
    buffer_load_dwordx4 a[200:203], v2, s[16:19], s51 offen offset:0 sc1
    v_exp_f32 v74, v74
    v_exp_f32 v75, v75
    v_exp_f32 v76, v76
    v_exp_f32 v77, v77
    v_exp_f32 v78, v78
    v_exp_f32 v79, v79
    v_exp_f32 v48, v48
    v_exp_f32 v49, v49
    v_smfmac_f32_32x32x32_bf16 v[80:95], a[108:111], v[72:79], v5
    s_waitcnt lgkmcnt(0)
    v_exp_f32 v50, v50
    v_exp_f32 v51, v51
    v_exp_f32 v52, v52
    v_mfma_f32_32x32x16_bf16 v[64:79], a[28:31], v[40:43], 0
    v_exp_f32 v53, v53
    v_exp_f32 v54, v54
    v_exp_f32 v55, v55
    v_exp_f32 v56, v56
    v_exp_f32 v57, v57
    v_smfmac_f32_32x32x32_bf16 v[80:95], a[112:115], v[48:55], v5
    buffer_load_dwordx4 a[204:207], v2, s[16:19], s60 offen offset:0 sc1
    v_exp_f32 v58, v58
    v_exp_f32 v59, v59
    v_exp_f32 v60, v60
    v_exp_f32 v61, v61
    v_mfma_f32_32x32x8_bf16 v[96:111], v[6:7], v[6:7], 0
    v_exp_f32 v62, v62
    v_exp_f32 v63, v63
    v_exp_f32 v64, v64
    v_exp_f32 v65, v65
    v_smfmac_f32_32x32x32_bf16 v[80:95], a[116:119], v[56:63], v5
    v_exp_f32 v66, v66
    v_exp_f32 v67, v67
    v_exp_f32 v68, v68
    v_mfma_f32_32x32x16_bf16 v[48:63], a[32:35], v[40:43], 0
    v_exp_f32 v69, v69
    v_exp_f32 v70, v70
    v_exp_f32 v71, v71
    v_exp_f32 v72, v72
    v_exp_f32 v73, v73
    v_smfmac_f32_32x32x32_bf16 v[80:95], a[120:123], v[64:71], v5
    buffer_load_dwordx4 a[208:211], v2, s[16:19], s61 offen offset:0 sc1
    v_exp_f32 v74, v74
    v_exp_f32 v75, v75
    v_exp_f32 v76, v76
    v_exp_f32 v77, v77
    v_exp_f32 v78, v78
    v_exp_f32 v79, v79
    v_exp_f32 v48, v48
    v_exp_f32 v49, v49
    v_smfmac_f32_32x32x32_bf16 v[80:95], a[124:127], v[72:79], v5
    v_exp_f32 v50, v50
    v_exp_f32 v51, v51
    v_exp_f32 v52, v52
    v_mfma_f32_32x32x16_bf16 v[64:79], a[36:39], v[40:43], 0
    v_exp_f32 v53, v53
    v_exp_f32 v54, v54
    v_exp_f32 v55, v55
    v_exp_f32 v56, v56
    v_exp_f32 v57, v57
    v_smfmac_f32_32x32x32_bf16 v[80:95], a[128:131], v[48:55], v5
    buffer_load_dwordx4 a[212:215], v2, s[16:19], s51 offen offset:1024 sc1
    v_exp_f32 v58, v58
    v_exp_f32 v59, v59
    v_exp_f32 v60, v60
    v_exp_f32 v61, v61
    v_exp_f32 v62, v62
    v_exp_f32 v63, v63
    v_exp_f32 v64, v64
    v_exp_f32 v65, v65
    v_smfmac_f32_32x32x32_bf16 v[80:95], a[132:135], v[56:63], v5
    buffer_load_dwordx4 a[216:219], v2, s[16:19], s60 offen offset:1024 sc1
    v_exp_f32 v66, v66
    v_exp_f32 v67, v67
    v_exp_f32 v68, v68
    v_mfma_f32_32x32x16_bf16 v[48:63], a[40:43], v[40:43], 0
    v_exp_f32 v69, v69
    v_exp_f32 v70, v70
    v_exp_f32 v71, v71
    v_exp_f32 v72, v72
    v_exp_f32 v73, v73
    v_smfmac_f32_32x32x32_bf16 v[80:95], a[136:139], v[64:71], v5
    buffer_load_dwordx4 a[220:223], v2, s[16:19], s61 offen offset:1024 sc1
    v_exp_f32 v74, v74
    v_exp_f32 v75, v75
    v_exp_f32 v76, v76
    v_exp_f32 v77, v77
    v_exp_f32 v78, v78
    v_exp_f32 v79, v79
    v_exp_f32 v48, v48
    v_exp_f32 v49, v49
    v_smfmac_f32_32x32x32_bf16 v[80:95], a[140:143], v[72:79], v5
    v_exp_f32 v50, v50
    v_exp_f32 v51, v51
    v_exp_f32 v52, v52
    v_mfma_f32_32x32x16_bf16 v[64:79], a[44:47], v[40:43], 0
    v_exp_f32 v53, v53
    v_exp_f32 v54, v54
    v_exp_f32 v55, v55
    v_exp_f32 v56, v56
    v_exp_f32 v57, v57
    v_smfmac_f32_32x32x32_bf16 v[80:95], a[144:147], v[48:55], v5
    buffer_load_dwordx4 a[224:227], v2, s[16:19], s51 offen offset:2048 sc1
    v_exp_f32 v58, v58
    v_exp_f32 v59, v59
    v_exp_f32 v60, v60
    v_exp_f32 v61, v61
    v_exp_f32 v62, v62
    v_exp_f32 v63, v63
    v_exp_f32 v64, v64
    v_exp_f32 v65, v65
    v_smfmac_f32_32x32x32_bf16 v[80:95], a[148:151], v[56:63], v5
    v_exp_f32 v66, v66
    v_exp_f32 v67, v67
    v_exp_f32 v68, v68
    v_mfma_f32_32x32x16_bf16 v[48:63], a[48:51], v[40:43], 0
    s_waitcnt vmcnt(12)
    v_exp_f32 v69, v69
    v_exp_f32 v70, v70
    v_exp_f32 v71, v71
    v_exp_f32 v72, v72
    v_exp_f32 v73, v73
    v_smfmac_f32_32x32x32_bf16 v[80:95], a[152:155], v[64:71], v5
    buffer_load_dwordx4 a[228:231], v2, s[16:19], s60 offen offset:2048 sc1
    v_exp_f32 v74, v74
    v_exp_f32 v75, v75
    v_exp_f32 v76, v76
    v_exp_f32 v77, v77
    v_exp_f32 v78, v78
    v_exp_f32 v79, v79
    v_exp_f32 v48, v48
    v_exp_f32 v49, v49
    v_smfmac_f32_32x32x32_bf16 v[80:95], a[156:159], v[72:79], v5
    v_exp_f32 v50, v50
    v_exp_f32 v51, v51
    v_exp_f32 v52, v52
    v_mfma_f32_32x32x16_bf16 v[64:79], a[52:55], v[40:43], 0
    v_exp_f32 v53, v53
    v_exp_f32 v54, v54
    v_exp_f32 v55, v55
    v_exp_f32 v56, v56
    v_exp_f32 v57, v57
    v_smfmac_f32_32x32x32_bf16 v[80:95], a[160:163], v[48:55], v5
    buffer_load_dwordx4 a[232:235], v2, s[16:19], s61 offen offset:2048 sc1
    v_exp_f32 v58, v58
    v_exp_f32 v59, v59
    v_exp_f32 v60, v60
    v_exp_f32 v61, v61
    v_exp_f32 v62, v62
    v_exp_f32 v63, v63
    v_exp_f32 v64, v64
    v_exp_f32 v65, v65
    v_smfmac_f32_32x32x32_bf16 v[80:95], a[164:167], v[56:63], v5
    v_exp_f32 v66, v66
    v_exp_f32 v67, v67
    v_exp_f32 v68, v68
    v_mfma_f32_32x32x16_bf16 v[48:63], a[56:59], v[40:43], 0
    v_lshlrev_b32 v0, 7, v1
    s_mul_i32 s48, s3, 6144
    s_mov_b32 exec_hi, 0xffff
    buffer_load_dword v8, v0, s[24:27], s48 offen sc1
    s_mov_b64 exec, -1
    v_exp_f32 v69, v69
    v_exp_f32 v70, v70
    v_exp_f32 v71, v71
    v_exp_f32 v72, v72
    v_exp_f32 v73, v73
    v_smfmac_f32_32x32x32_bf16 v[80:95], a[168:171], v[64:71], v5
    buffer_load_dwordx4 a[236:239], v2, s[16:19], s51 offen offset:3072 sc1
    v_exp_f32 v74, v74
    v_exp_f32 v75, v75
    v_exp_f32 v76, v76
    v_exp_f32 v77, v77
    v_exp_f32 v78, v78
    v_exp_f32 v79, v79
    v_exp_f32 v48, v48
    v_exp_f32 v49, v49
    v_smfmac_f32_32x32x32_bf16 v[80:95], a[172:175], v[72:79], v5
    buffer_load_dwordx4 a[240:243], v2, s[16:19], s60 offen offset:3072 sc1
    v_exp_f32 v50, v50
    v_exp_f32 v51, v51
    v_exp_f32 v52, v52
    v_mfma_f32_32x32x16_bf16 v[64:79], a[60:63], v[40:43], 0
    s_add_u32 s48, s38, 14221312
    s_mov_b64 exec, 0xff
    buffer_load_dword v8, v0, s[8:11], s48 offen sc1
    s_mov_b64 exec, -1
    v_exp_f32 v53, v53
    v_exp_f32 v54, v54
    v_exp_f32 v55, v55
    v_exp_f32 v56, v56
    v_exp_f32 v57, v57
    v_smfmac_f32_32x32x32_bf16 v[80:95], a[176:179], v[48:55], v5
    buffer_load_dwordx4 a[244:247], v2, s[16:19], s61 offen offset:3072 sc1
    v_exp_f32 v58, v58
    v_exp_f32 v59, v59
    v_exp_f32 v60, v60
    v_exp_f32 v61, v61
    v_exp_f32 v62, v62
    v_exp_f32 v63, v63
    v_exp_f32 v64, v64
    v_exp_f32 v65, v65
    v_smfmac_f32_32x32x32_bf16 v[80:95], a[180:183], v[56:63], v5
    v_exp_f32 v66, v66
    v_exp_f32 v67, v67
    v_exp_f32 v68, v68
    v_mfma_f32_32x32x16_bf16 v[48:63], a[0:3], v[44:47], 0
    s_add_u32 s48, s44, 6291456
    s_mov_b64 exec, 0xffff
    buffer_load_dword v8, v0, s[8:11], s48 offen sc1
    s_mov_b64 exec, -1
    v_exp_f32 v69, v69
    v_exp_f32 v70, v70
    v_exp_f32 v71, v71
    v_exp_f32 v72, v72
    v_exp_f32 v73, v73
    v_smfmac_f32_32x32x32_bf16 v[80:95], a[184:187], v[64:71], v5
    v_exp_f32 v74, v74
    v_exp_f32 v75, v75
    v_exp_f32 v76, v76
    v_exp_f32 v77, v77
    v_exp_f32 v78, v78
    v_exp_f32 v79, v79
    v_exp_f32 v48, v48
    v_exp_f32 v49, v49
    v_smfmac_f32_32x32x32_bf16 v[80:95], a[188:191], v[72:79], v5
    v_exp_f32 v50, v50
    v_exp_f32 v51, v51
    v_exp_f32 v52, v52
    v_mfma_f32_32x32x16_bf16 v[64:79], a[4:7], v[44:47], 0
    v_lshlrev_b32 v0, 13, v1
    s_mov_b64 exec, 0xf
    buffer_load_dword v8, v0, s[8:11], s57 offen sc1
    s_mov_b64 exec, -1
    v_exp_f32 v53, v53
    v_exp_f32 v54, v54
    v_exp_f32 v55, v55
    v_exp_f32 v56, v56
    v_exp_f32 v57, v57
    v_smfmac_f32_32x32x32_bf16 v[96:111], a[64:67], v[48:55], v5
    v_exp_f32 v58, v58
    v_exp_f32 v59, v59
    v_exp_f32 v60, v60
    v_exp_f32 v61, v61
    v_exp_f32 v62, v62
    v_exp_f32 v63, v63
    v_exp_f32 v64, v64
    v_exp_f32 v65, v65
    v_smfmac_f32_32x32x32_bf16 v[96:111], a[68:71], v[56:63], v5
    ds_write_b128 v3, v[80:83] offset:12288
    v_exp_f32 v66, v66
    v_exp_f32 v67, v67
    v_exp_f32 v68, v68
    v_mfma_f32_32x32x16_bf16 v[48:63], a[8:11], v[44:47], 0
    v_exp_f32 v69, v69
    v_exp_f32 v70, v70
    v_exp_f32 v71, v71
    v_exp_f32 v72, v72
    v_exp_f32 v73, v73
    v_smfmac_f32_32x32x32_bf16 v[96:111], a[72:75], v[64:71], v5
    v_exp_f32 v74, v74
    v_exp_f32 v75, v75
    v_exp_f32 v76, v76
    v_exp_f32 v77, v77
    v_exp_f32 v78, v78
    v_exp_f32 v79, v79
    v_exp_f32 v48, v48
    v_exp_f32 v49, v49
    v_smfmac_f32_32x32x32_bf16 v[96:111], a[76:79], v[72:79], v5
    s_add_u32 s50, s55, 0
    buffer_load_dwordx4 a[0:3], v2, s[20:23], s50 offen offset:0 sc1
    ds_write_b128 v3, v[84:87] offset:13312
    v_exp_f32 v50, v50
    v_exp_f32 v51, v51
    v_exp_f32 v52, v52
    v_mfma_f32_32x32x16_bf16 v[64:79], a[12:15], v[44:47], 0
    buffer_load_dwordx4 a[64:67], v2, s[20:23], s50 offen offset:1024 sc1
    v_exp_f32 v53, v53
    v_exp_f32 v54, v54
    v_exp_f32 v55, v55
    v_exp_f32 v56, v56
    v_exp_f32 v57, v57
    v_smfmac_f32_32x32x32_bf16 v[96:111], a[80:83], v[48:55], v5
    buffer_load_dwordx4 a[68:71], v2, s[20:23], s50 offen offset:2048 sc1
    v_exp_f32 v58, v58
    v_exp_f32 v59, v59
    v_exp_f32 v60, v60
    v_exp_f32 v61, v61
    v_exp_f32 v62, v62
    v_exp_f32 v63, v63
    v_exp_f32 v64, v64
    v_exp_f32 v65, v65
    v_smfmac_f32_32x32x32_bf16 v[96:111], a[84:87], v[56:63], v5
    buffer_load_dwordx4 a[4:7], v2, s[20:23], s50 offen offset:3072 sc1
    s_mov_b32 exec_hi, 0
    ds_write_b32 v11, v88 offset:768
    s_mov_b32 exec_hi, -1
    v_exp_f32 v66, v66
    v_exp_f32 v67, v67
    v_exp_f32 v68, v68
    v_mfma_f32_32x32x16_bf16 v[48:63], a[16:19], v[44:47], 0
    s_add_u32 s50, s55, 4096
    buffer_load_dwordx4 a[72:75], v2, s[20:23], s50 offen offset:0 sc1
    v_exp_f32 v69, v69
    v_exp_f32 v70, v70
    v_exp_f32 v71, v71
    v_exp_f32 v72, v72
    v_exp_f32 v73, v73
    v_smfmac_f32_32x32x32_bf16 v[96:111], a[88:91], v[64:71], v5
    buffer_load_dwordx4 a[76:79], v2, s[20:23], s50 offen offset:1024 sc1
    v_exp_f32 v74, v74
    v_exp_f32 v75, v75
    v_exp_f32 v76, v76
    v_exp_f32 v77, v77
    v_exp_f32 v78, v78
    v_exp_f32 v79, v79
    v_exp_f32 v48, v48
    v_exp_f32 v49, v49
    v_smfmac_f32_32x32x32_bf16 v[96:111], a[92:95], v[72:79], v5
    buffer_load_dwordx4 a[8:11], v2, s[20:23], s50 offen offset:2048 sc1
    v_exp_f32 v50, v50
    v_exp_f32 v51, v51
    v_exp_f32 v52, v52
    v_mfma_f32_32x32x16_bf16 v[64:79], a[20:23], v[44:47], 0
    buffer_load_dwordx4 a[80:83], v2, s[20:23], s50 offen offset:3072 sc1
    v_exp_f32 v53, v53
    v_exp_f32 v54, v54
    v_exp_f32 v55, v55
    v_exp_f32 v56, v56
    v_exp_f32 v57, v57
    v_smfmac_f32_32x32x32_bf16 v[96:111], a[96:99], v[48:55], v5
    s_add_u32 s50, s55, 8192
    buffer_load_dwordx4 a[84:87], v2, s[20:23], s50 offen offset:0 sc1
    v_exp_f32 v58, v58
    v_exp_f32 v59, v59
    v_exp_f32 v60, v60
    v_exp_f32 v61, v61
    v_exp_f32 v62, v62
    v_exp_f32 v63, v63
    v_exp_f32 v64, v64
    v_exp_f32 v65, v65
    v_smfmac_f32_32x32x32_bf16 v[96:111], a[100:103], v[56:63], v5
    buffer_load_dwordx4 a[12:15], v2, s[20:23], s50 offen offset:1024 sc1
    v_exp_f32 v66, v66
    v_exp_f32 v67, v67
    v_exp_f32 v68, v68
    v_mfma_f32_32x32x16_bf16 v[48:63], a[24:27], v[44:47], 0
    buffer_load_dwordx4 a[88:91], v2, s[20:23], s50 offen offset:2048 sc1
    v_exp_f32 v69, v69
    v_exp_f32 v70, v70
    v_exp_f32 v71, v71
    v_exp_f32 v72, v72
    v_exp_f32 v73, v73
    v_smfmac_f32_32x32x32_bf16 v[96:111], a[104:107], v[64:71], v5
    buffer_load_dwordx4 a[92:95], v2, s[20:23], s50 offen offset:3072 sc1
    v_exp_f32 v74, v74
    v_exp_f32 v75, v75
    v_exp_f32 v76, v76
    v_exp_f32 v77, v77
    v_exp_f32 v78, v78
    v_exp_f32 v79, v79
    v_exp_f32 v48, v48
    v_exp_f32 v49, v49
    v_smfmac_f32_32x32x32_bf16 v[96:111], a[108:111], v[72:79], v5
    s_add_u32 s50, s55, 12288
    buffer_load_dwordx4 a[16:19], v2, s[20:23], s50 offen offset:0 sc1
    v_exp_f32 v50, v50
    v_exp_f32 v51, v51
    v_exp_f32 v52, v52
    v_mfma_f32_32x32x16_bf16 v[64:79], a[28:31], v[44:47], 0
    buffer_load_dwordx4 a[96:99], v2, s[20:23], s50 offen offset:1024 sc1
    v_exp_f32 v53, v53
    v_exp_f32 v54, v54
    v_exp_f32 v55, v55
    v_exp_f32 v56, v56
    v_exp_f32 v57, v57
    v_smfmac_f32_32x32x32_bf16 v[96:111], a[112:115], v[48:55], v5
    buffer_load_dwordx4 a[100:103], v2, s[20:23], s50 offen offset:2048 sc1
    v_exp_f32 v58, v58
    v_exp_f32 v59, v59
    v_exp_f32 v60, v60
    v_exp_f32 v61, v61
    v_exp_f32 v62, v62
    v_exp_f32 v63, v63
    v_exp_f32 v64, v64
    v_exp_f32 v65, v65
    v_smfmac_f32_32x32x32_bf16 v[96:111], a[116:119], v[56:63], v5
    buffer_load_dwordx4 a[20:23], v2, s[20:23], s50 offen offset:3072 sc1
    v_exp_f32 v66, v66
    v_exp_f32 v67, v67
    v_exp_f32 v68, v68
    v_mfma_f32_32x32x16_bf16 v[48:63], a[32:35], v[44:47], 0
    s_add_u32 s50, s55, 16384
    buffer_load_dwordx4 a[104:107], v2, s[20:23], s50 offen offset:0 sc1
    v_exp_f32 v69, v69
    v_exp_f32 v70, v70
    v_exp_f32 v71, v71
    v_exp_f32 v72, v72
    v_exp_f32 v73, v73
    v_smfmac_f32_32x32x32_bf16 v[96:111], a[120:123], v[64:71], v5
    buffer_load_dwordx4 a[108:111], v2, s[20:23], s50 offen offset:1024 sc1
    v_exp_f32 v74, v74
    v_exp_f32 v75, v75
    v_exp_f32 v76, v76
    v_exp_f32 v77, v77
    v_exp_f32 v78, v78
    v_exp_f32 v79, v79
    v_exp_f32 v48, v48
    v_exp_f32 v49, v49
    v_smfmac_f32_32x32x32_bf16 v[96:111], a[124:127], v[72:79], v5
    buffer_load_dwordx4 a[24:27], v2, s[20:23], s50 offen offset:2048 sc1
    v_exp_f32 v50, v50
    v_exp_f32 v51, v51
    v_exp_f32 v52, v52
    v_mfma_f32_32x32x16_bf16 v[64:79], a[36:39], v[44:47], 0
    buffer_load_dwordx4 a[112:115], v2, s[20:23], s50 offen offset:3072 sc1
    v_exp_f32 v53, v53
    v_exp_f32 v54, v54
    v_exp_f32 v55, v55
    v_exp_f32 v56, v56
    v_exp_f32 v57, v57
    v_smfmac_f32_32x32x32_bf16 v[96:111], a[128:131], v[48:55], v5
    s_add_u32 s50, s55, 20480
    buffer_load_dwordx4 a[116:119], v2, s[20:23], s50 offen offset:0 sc1
    v_exp_f32 v58, v58
    v_exp_f32 v59, v59
    v_exp_f32 v60, v60
    v_exp_f32 v61, v61
    s_waitcnt vmcnt(21)
    v_exp_f32 v62, v62
    v_exp_f32 v63, v63
    v_exp_f32 v64, v64
    v_exp_f32 v65, v65
    v_smfmac_f32_32x32x32_bf16 v[96:111], a[132:135], v[56:63], v5
    buffer_load_dwordx4 a[28:31], v2, s[20:23], s50 offen offset:1024 sc1
    v_exp_f32 v66, v66
    v_exp_f32 v67, v67
    v_exp_f32 v68, v68
    v_mfma_f32_32x32x16_bf16 v[48:63], a[40:43], v[44:47], 0
    buffer_load_dwordx4 a[120:123], v2, s[20:23], s50 offen offset:2048 sc1
    v_exp_f32 v69, v69
    v_exp_f32 v70, v70
    v_exp_f32 v71, v71
    v_exp_f32 v72, v72
    v_exp_f32 v73, v73
    v_smfmac_f32_32x32x32_bf16 v[96:111], a[136:139], v[64:71], v5
    buffer_load_dwordx4 a[124:127], v2, s[20:23], s50 offen offset:3072 sc1
    v_exp_f32 v74, v74
    v_exp_f32 v75, v75
    v_exp_f32 v76, v76
    v_exp_f32 v77, v77
    v_exp_f32 v78, v78
    v_exp_f32 v79, v79
    v_exp_f32 v48, v48
    v_exp_f32 v49, v49
    v_smfmac_f32_32x32x32_bf16 v[96:111], a[140:143], v[72:79], v5
    s_add_u32 s50, s55, 24576
    buffer_load_dwordx4 a[32:35], v2, s[20:23], s50 offen offset:0 sc1
    v_exp_f32 v50, v50
    v_exp_f32 v51, v51
    v_exp_f32 v52, v52
    v_mfma_f32_32x32x16_bf16 v[64:79], a[44:47], v[44:47], 0
    buffer_load_dwordx4 a[128:131], v2, s[20:23], s50 offen offset:1024 sc1
    v_exp_f32 v53, v53
    v_exp_f32 v54, v54
    v_exp_f32 v55, v55
    v_exp_f32 v56, v56
    v_exp_f32 v57, v57
    v_smfmac_f32_32x32x32_bf16 v[96:111], a[144:147], v[48:55], v5
    buffer_load_dwordx4 a[132:135], v2, s[20:23], s50 offen offset:2048 sc1
    v_exp_f32 v58, v58
    v_exp_f32 v59, v59
    v_exp_f32 v60, v60
    v_exp_f32 v61, v61
    v_exp_f32 v62, v62
    v_exp_f32 v63, v63
    v_exp_f32 v64, v64
    v_exp_f32 v65, v65
    v_smfmac_f32_32x32x32_bf16 v[96:111], a[148:151], v[56:63], v5
    buffer_load_dwordx4 a[36:39], v2, s[20:23], s50 offen offset:3072 sc1
    v_exp_f32 v66, v66
    v_exp_f32 v67, v67
    v_exp_f32 v68, v68
    v_mfma_f32_32x32x16_bf16 v[48:63], a[48:51], v[44:47], 0
    s_add_u32 s50, s55, 28672
    buffer_load_dwordx4 a[136:139], v2, s[20:23], s50 offen offset:0 sc1
    v_exp_f32 v69, v69
    v_exp_f32 v70, v70
    v_exp_f32 v71, v71
    v_exp_f32 v72, v72
    v_exp_f32 v73, v73
    v_smfmac_f32_32x32x32_bf16 v[96:111], a[152:155], v[64:71], v5
    buffer_load_dwordx4 a[140:143], v2, s[20:23], s50 offen offset:1024 sc1
    v_exp_f32 v74, v74
    v_exp_f32 v75, v75
    v_exp_f32 v76, v76
    v_exp_f32 v77, v77
    v_exp_f32 v78, v78
    v_exp_f32 v79, v79
    v_exp_f32 v48, v48
    v_exp_f32 v49, v49
    v_smfmac_f32_32x32x32_bf16 v[96:111], a[156:159], v[72:79], v5
    buffer_load_dwordx4 a[40:43], v2, s[20:23], s50 offen offset:2048 sc1
    v_exp_f32 v50, v50
    v_exp_f32 v51, v51
    v_exp_f32 v52, v52
    v_mfma_f32_32x32x16_bf16 v[64:79], a[52:55], v[44:47], 0
    buffer_load_dwordx4 a[144:147], v2, s[20:23], s50 offen offset:3072 sc1
    v_exp_f32 v53, v53
    v_exp_f32 v54, v54
    v_exp_f32 v55, v55
    v_exp_f32 v56, v56
    v_exp_f32 v57, v57
    v_smfmac_f32_32x32x32_bf16 v[96:111], a[160:163], v[48:55], v5
    s_add_u32 s50, s55, 32768
    buffer_load_dwordx4 a[148:151], v2, s[20:23], s50 offen offset:0 sc1
    v_exp_f32 v58, v58
    v_exp_f32 v59, v59
    v_exp_f32 v60, v60
    v_exp_f32 v61, v61
    v_exp_f32 v62, v62
    v_exp_f32 v63, v63
    v_exp_f32 v64, v64
    v_exp_f32 v65, v65
    v_smfmac_f32_32x32x32_bf16 v[96:111], a[164:167], v[56:63], v5
    buffer_load_dwordx4 a[44:47], v2, s[20:23], s50 offen offset:1024 sc1
    v_exp_f32 v66, v66
    v_exp_f32 v67, v67
    v_exp_f32 v68, v68
    v_mfma_f32_32x32x16_bf16 v[48:63], a[56:59], v[44:47], 0
    buffer_load_dwordx4 a[152:155], v2, s[20:23], s50 offen offset:2048 sc1
    v_exp_f32 v69, v69
    v_exp_f32 v70, v70
    v_exp_f32 v71, v71
    v_exp_f32 v72, v72
    v_exp_f32 v73, v73
    v_smfmac_f32_32x32x32_bf16 v[96:111], a[168:171], v[64:71], v5
    buffer_load_dwordx4 a[156:159], v2, s[20:23], s50 offen offset:3072 sc1
    v_exp_f32 v74, v74
    v_exp_f32 v75, v75
    v_exp_f32 v76, v76
    v_exp_f32 v77, v77
    v_exp_f32 v78, v78
    v_exp_f32 v79, v79
    v_exp_f32 v48, v48
    v_exp_f32 v49, v49
    v_smfmac_f32_32x32x32_bf16 v[96:111], a[172:175], v[72:79], v5
    s_add_u32 s50, s55, 36864
    buffer_load_dwordx4 a[48:51], v2, s[20:23], s50 offen offset:0 sc1
    v_exp_f32 v50, v50
    v_exp_f32 v51, v51
    v_exp_f32 v52, v52
    v_mfma_f32_32x32x16_bf16 v[64:79], a[60:63], v[44:47], 0
    buffer_load_dwordx4 a[160:163], v2, s[20:23], s50 offen offset:1024 sc1
    v_exp_f32 v53, v53
    v_exp_f32 v54, v54
    v_exp_f32 v55, v55
    v_exp_f32 v56, v56
    v_exp_f32 v57, v57
    v_smfmac_f32_32x32x32_bf16 v[96:111], a[176:179], v[48:55], v5
    buffer_load_dwordx4 a[164:167], v2, s[20:23], s50 offen offset:2048 sc1
    v_exp_f32 v58, v58
    v_exp_f32 v59, v59
    v_exp_f32 v60, v60
    v_exp_f32 v61, v61
    v_exp_f32 v62, v62
    v_exp_f32 v63, v63
    v_exp_f32 v64, v64
    v_exp_f32 v65, v65
    v_smfmac_f32_32x32x32_bf16 v[96:111], a[180:183], v[56:63], v5
    buffer_load_dwordx4 a[52:55], v2, s[20:23], s50 offen offset:3072 sc1
    v_exp_f32 v66, v66
    v_exp_f32 v67, v67
    v_exp_f32 v68, v68
    s_add_u32 s50, s55, 40960
    buffer_load_dwordx4 a[168:171], v2, s[20:23], s50 offen offset:0 sc1
    v_exp_f32 v69, v69
    v_exp_f32 v70, v70
    v_exp_f32 v71, v71
    v_exp_f32 v72, v72
    v_exp_f32 v73, v73
    v_smfmac_f32_32x32x32_bf16 v[96:111], a[184:187], v[64:71], v5
    buffer_load_dwordx4 a[172:175], v2, s[20:23], s50 offen offset:1024 sc1
    v_exp_f32 v74, v74
    v_exp_f32 v75, v75
    v_exp_f32 v76, v76
    v_exp_f32 v77, v77
    v_exp_f32 v78, v78
    v_exp_f32 v79, v79
    s_nop 1
    v_smfmac_f32_32x32x32_bf16 v[96:111], a[188:191], v[72:79], v5
    v_lshrrev_b32 v0, 4, v1
    v_lshlrev_b32 v0, 8, v0
    v_and_b32 v48, 15, v1
    v_lshl_add_u32 v0, v48, 2, v0
    v_add_u32 v0, s40, v0
    s_nop 6
    ds_write_b128 v3, v[96:99] offset:14336
    ds_write_b128 v3, v[100:103] offset:15360
    s_mov_b32 exec_hi, 0
    ds_write_b32 v11, v104 offset:896
    s_mov_b32 exec_hi, -1
    s_waitcnt lgkmcnt(0)
    s_barrier
    ds_read_b32 v88, v0 offset:0
    ds_read_b32 v89, v0 offset:1024
    ds_read_b32 v90, v0 offset:2048
    ds_read_b32 v91, v0 offset:3072
    ds_read_b128 v[16:19], v4 offset:0
    ds_read_b128 v[20:23], v4 offset:512
    ds_read_b128 v[24:27], v4 offset:1024
    ds_read_b128 v[28:31], v4 offset:1536
    ds_read_b128 v[32:35], v4 offset:16384
    ds_read_b128 v[36:39], v4 offset:16896
    ds_read_b128 v[40:43], v4 offset:17408
    ds_read_b128 v[44:47], v4 offset:17920
    ds_read_b128 v[48:51], v4 offset:32768
    ds_read_b128 v[52:55], v4 offset:33280
    ds_read_b128 v[56:59], v4 offset:33792
    ds_read_b128 v[60:63], v4 offset:34304
    ds_read_b128 v[64:67], v4 offset:49152
    ds_read_b128 v[68:71], v4 offset:49664
    ds_read_b128 v[72:75], v4 offset:50176
    ds_read_b128 v[76:79], v4 offset:50688
    s_waitcnt lgkmcnt(8)
    v_add_f32 v88, v88, v89
    v_add_f32 v90, v90, v91
    v_pk_add_f32 v[16:17], v[16:17], v[32:33]
    v_pk_add_f32 v[18:19], v[18:19], v[34:35]
    v_pk_add_f32 v[20:21], v[20:21], v[36:37]
    v_pk_add_f32 v[22:23], v[22:23], v[38:39]
    v_pk_add_f32 v[24:25], v[24:25], v[40:41]
    v_pk_add_f32 v[26:27], v[26:27], v[42:43]
    v_pk_add_f32 v[28:29], v[28:29], v[44:45]
    v_pk_add_f32 v[30:31], v[30:31], v[46:47]
    v_add_f32 v88, v88, v90
    v_rcp_f32 v90, v88
    v_subrev_u32 v8, s52, v88
    s_waitcnt lgkmcnt(0)
    v_pk_add_f32 v[48:49], v[48:49], v[64:65]
    v_pk_add_f32 v[50:51], v[50:51], v[66:67]
    v_pk_add_f32 v[52:53], v[52:53], v[68:69]
    v_pk_add_f32 v[54:55], v[54:55], v[70:71]
    v_pk_add_f32 v[56:57], v[56:57], v[72:73]
    v_pk_add_f32 v[58:59], v[58:59], v[74:75]
    v_pk_add_f32 v[60:61], v[60:61], v[76:77]
    v_pk_add_f32 v[62:63], v[62:63], v[78:79]
    v_pk_add_f32 v[16:17], v[16:17], v[48:49]
    v_pk_add_f32 v[18:19], v[18:19], v[50:51]
    v_pk_add_f32 v[20:21], v[20:21], v[52:53]
    v_pk_add_f32 v[22:23], v[22:23], v[54:55]
    v_pk_add_f32 v[24:25], v[24:25], v[56:57]
    v_pk_add_f32 v[26:27], v[26:27], v[58:59]
    v_pk_add_f32 v[28:29], v[28:29], v[60:61]
    v_pk_add_f32 v[30:31], v[30:31], v[62:63]
    v_pk_mul_f32 v[16:17], v[16:17], v[90:91] op_sel_hi:[1,0]
    v_pk_mul_f32 v[18:19], v[18:19], v[90:91] op_sel_hi:[1,0]
    v_pk_mul_f32 v[20:21], v[20:21], v[90:91] op_sel_hi:[1,0]
    v_pk_mul_f32 v[22:23], v[22:23], v[90:91] op_sel_hi:[1,0]
    v_pk_mul_f32 v[24:25], v[24:25], v[90:91] op_sel_hi:[1,0]
    v_pk_mul_f32 v[26:27], v[26:27], v[90:91] op_sel_hi:[1,0]
    v_pk_mul_f32 v[28:29], v[28:29], v[90:91] op_sel_hi:[1,0]
    v_pk_mul_f32 v[30:31], v[30:31], v[90:91] op_sel_hi:[1,0]
    v_cvt_pk_bf16_f32 v80, v16, v17
    v_cvt_pk_bf16_f32 v81, v18, v19
    v_cvt_pk_bf16_f32 v82, v20, v21
    v_cvt_pk_bf16_f32 v83, v22, v23
    v_cvt_pk_bf16_f32 v84, v24, v25
    v_cvt_pk_bf16_f32 v85, v26, v27
    v_cvt_pk_bf16_f32 v86, v28, v29
    v_cvt_pk_bf16_f32 v87, v30, v31
    s_lshl_b32 s48, s3, 10
    buffer_store_dwordx4 v[80:83], v2, s[24:27], s48 offen
    s_add_u32 s48, s48, 4096
    buffer_store_dwordx4 v[84:87], v2, s[24:27], s48 offen
    s_add_u32 s48, s48, 4096
    v_mov_b32 v3, 159744
    v_cmp_lt_u32 vcc, s54, v8
    s_nop 4
    s_cbranch_vccz L_noflag_50
    ds_write_b32 v3, v12 offset:0
L_noflag_50:
    s_waitcnt lgkmcnt(0)
    s_barrier
    ds_read_b32 v0, v3 offset:0
    s_waitcnt lgkmcnt(0)
    v_readfirstlane_b32 s48, v0
    s_cmp_lg_u32 s48, 0
    s_cbranch_scc1 L_slow_51
L_back_52:
    v_mov_b32 v28, 0x3f803f80
    v_mov_b32 v29, 0x3f803f80
    v_mov_b32 v30, 0x3f803f80
    v_mov_b32 v31, 0x3f803f80
    v_lshlrev_b32 v96, 16, v112
    v_and_b32 v97, 0xffff0000, v112
    v_lshlrev_b32 v98, 16, v113
    v_and_b32 v99, 0xffff0000, v113
    v_lshlrev_b32 v100, 16, v114
    v_and_b32 v101, 0xffff0000, v114
    v_lshlrev_b32 v102, 16, v115
    v_and_b32 v103, 0xffff0000, v115
    v_lshlrev_b32 v104, 16, v116
    v_and_b32 v105, 0xffff0000, v116
    v_lshlrev_b32 v106, 16, v117
    v_and_b32 v107, 0xffff0000, v117
    v_lshlrev_b32 v108, 16, v118
    v_and_b32 v109, 0xffff0000, v118
    v_lshlrev_b32 v110, 16, v119
    v_and_b32 v111, 0xffff0000, v119
    v_mfma_f32_16x16x32_bf16 v[16:19], v[120:123], v[28:31], 0
    v_mfma_f32_16x16x32_bf16 v[20:23], v[124:127], v[28:31], 0
    v_mfma_f32_16x16x32_bf16 v[24:27], v[128:131], v[28:31], 0
    v_mfma_f32_16x16x32_bf16 v[16:19], v[132:135], v[28:31], v[16:19]
    v_mfma_f32_16x16x32_bf16 v[20:23], v[136:139], v[28:31], v[20:23]
    v_mfma_f32_16x16x32_bf16 v[24:27], v[140:143], v[28:31], v[24:27]
    s_add_u32 s48, s70, 0
    s_waitcnt vmcnt(0)
    s_cmp_eq_u32 s56, 0
    s_cbranch_scc1 L_pf_53
    buffer_wbl2 sc1
    s_waitcnt vmcnt(0)
    s_mov_b64 exec, 1
    buffer_store_dwordx2 v[12:13], v6, s[8:11], s48 offen sc1
    s_branch L_pd_54
L_pf_53:
    s_mov_b64 exec, 1
    buffer_store_dwordx2 v[12:13], v6, s[8:11], s48 offen
L_pd_54:
    s_mov_b64 exec, -1
    ds_read_b128 v[64:67], v14 offset:0
    ds_read_b128 v[68:71], v14 offset:1024
    ds_read_b128 v[72:75], v14 offset:2048
    ds_read_b128 v[76:79], v14 offset:3072
    ds_read_b128 v[80:83], v14 offset:4096
    ds_read_b128 v[84:87], v14 offset:5120
    ds_read_b128 v[88:91], v14 offset:6144
    ds_read_b128 v[92:95], v14 offset:7168
    v_mfma_f32_16x16x32_bf16 v[16:19], v[144:147], v[28:31], v[16:19]
    v_mfma_f32_16x16x32_bf16 v[20:23], v[148:151], v[28:31], v[20:23]
    v_mfma_f32_16x16x32_bf16 v[24:27], v[152:155], v[28:31], v[24:27]
    v_mfma_f32_16x16x32_bf16 v[16:19], v[156:159], v[28:31], v[16:19]
    v_mfma_f32_16x16x32_bf16 v[20:23], v[160:163], v[28:31], v[20:23]
    v_mfma_f32_16x16x32_bf16 v[24:27], v[164:167], v[28:31], v[24:27]
    v_mfma_f32_16x16x32_bf16 v[16:19], v[168:171], v[28:31], v[16:19]
    v_mfma_f32_16x16x32_bf16 v[20:23], v[172:175], v[28:31], v[20:23]
    v_mfma_f32_16x16x32_bf16 v[24:27], v[176:179], v[28:31], v[24:27]
    v_mfma_f32_16x16x32_bf16 v[16:19], v[180:183], v[28:31], v[16:19]
    v_mfma_f32_16x16x32_bf16 v[20:23], v[184:187], v[28:31], v[20:23]
    v_mfma_f32_16x16x32_bf16 v[24:27], v[188:191], v[28:31], v[24:27]
    v_mfma_f32_16x16x32_bf16 v[16:19], v[192:195], v[28:31], v[16:19]
    v_mfma_f32_16x16x32_bf16 v[20:23], v[196:199], v[28:31], v[20:23]
    v_mfma_f32_16x16x32_bf16 v[24:27], v[200:203], v[28:31], v[24:27]
    v_mfma_f32_16x16x32_bf16 v[16:19], v[204:207], v[28:31], v[16:19]
    v_mfma_f32_16x16x32_bf16 v[20:23], v[208:211], v[28:31], v[20:23]
    v_mfma_f32_16x16x32_bf16 v[24:27], v[212:215], v[28:31], v[24:27]
    s_add_u32 s48, s57, 0
    s_mov_b32 s43, 0
    s_mov_b64 exec, 0xff
L_poll_55:
    buffer_load_dwordx2 v[48:49], v15, s[8:11], s48 offen sc1
L_pchk_57:
    s_add_u32 s43, s43, 1
    s_waitcnt vmcnt(0)
    v_cmp_ne_u64 vcc, s[64:65], v[48:49]
    s_cmp_ge_u32 s43, 100000
    s_cbranch_scc1 L_polled_56
    s_nop 1
    s_cbranch_vccnz L_poll_55
L_polled_56:
    s_mov_b64 exec, -1
    s_cmp_eq_u32 s56, 0
    s_cbranch_scc1 L_noacq_58
    buffer_inv sc1
    s_waitcnt vmcnt(0)
L_noacq_58:
    s_lshl_b32 s42, s3, 10
    s_add_u32 s48, s42, 0
    buffer_load_dwordx4 v[32:35], v2, s[28:31], s48 offen sc1
    s_add_u32 s48, s42, 4096
    buffer_load_dwordx4 v[36:39], v2, s[28:31], s48 offen sc1
    s_add_u32 s48, s42, 24576
    buffer_load_dwordx4 v[40:43], v2, s[28:31], s48 offen sc1
    v_mfma_f32_16x16x32_bf16 v[16:19], v[216:219], v[28:31], v[16:19]
    v_mfma_f32_16x16x32_bf16 v[20:23], v[220:223], v[28:31], v[20:23]
    s_add_u32 s48, s42, 28672
    buffer_load_dwordx4 v[44:47], v2, s[28:31], s48 offen sc1
    v_mfma_f32_16x16x32_bf16 v[24:27], v[224:227], v[28:31], v[24:27]
    v_mfma_f32_16x16x32_bf16 v[16:19], v[228:231], v[28:31], v[16:19]
    s_add_u32 s48, s42, 45056
    buffer_load_dwordx4 v[48:51], v2, s[28:31], s48 offen sc1
    v_mfma_f32_16x16x32_bf16 v[20:23], v[232:235], v[28:31], v[20:23]
    v_mfma_f32_16x16x32_bf16 v[24:27], v[236:239], v[28:31], v[24:27]
    s_add_u32 s48, s42, 49152
    buffer_load_dwordx4 v[52:55], v2, s[28:31], s48 offen sc1
    v_mfma_f32_16x16x32_bf16 v[16:19], v[240:243], v[28:31], v[16:19]
    v_mfma_f32_16x16x32_bf16 v[20:23], v[244:247], v[28:31], v[20:23]
    s_add_u32 s48, s42, 69632
    buffer_load_dwordx4 v[56:59], v2, s[28:31], s48 offen sc1
    v_mfma_f32_16x16x32_bf16 v[24:27], v[248:251], v[28:31], v[24:27]
    v_mfma_f32_16x16x32_bf16 v[16:19], v[252:255], v[28:31], v[16:19]
    s_add_u32 s48, s42, 73728
    buffer_load_dwordx4 v[60:63], v2, s[28:31], s48 offen sc1
    v_mfma_f32_16x16x32_bf16 v[20:23], a[192:195], v[28:31], v[20:23]
    v_mfma_f32_16x16x32_bf16 v[24:27], a[196:199], v[28:31], v[24:27]
    s_waitcnt vmcnt(7)
    s_waitcnt lgkmcnt(7)
    v_mfma_f32_16x16x32_bf16 v[96:99], v[64:67], v[32:35], v[96:99]
    ds_read_b128 v[64:67], v14 offset:8192
    s_waitcnt lgkmcnt(7)
    v_mfma_f32_16x16x32_bf16 v[100:103], v[68:71], v[32:35], v[100:103]
    ds_read_b128 v[68:71], v14 offset:9216
    s_add_u32 s48, s42, 90112
    buffer_load_dwordx4 a[56:59], v2, s[28:31], s48 offen sc1
    s_waitcnt lgkmcnt(7)
    v_mfma_f32_16x16x32_bf16 v[104:107], v[72:75], v[32:35], v[104:107]
    ds_read_b128 v[72:75], v14 offset:10240
    s_waitcnt lgkmcnt(7)
    v_mfma_f32_16x16x32_bf16 v[108:111], v[76:79], v[32:35], v[108:111]
    ds_read_b128 v[76:79], v14 offset:11264
    s_waitcnt vmcnt(7)
    s_waitcnt lgkmcnt(7)
    v_mfma_f32_16x16x32_bf16 v[96:99], v[80:83], v[36:39], v[96:99]
    ds_read_b128 v[80:83], v14 offset:12288
    s_waitcnt lgkmcnt(7)
    v_mfma_f32_16x16x32_bf16 v[100:103], v[84:87], v[36:39], v[100:103]
    ds_read_b128 v[84:87], v14 offset:13312
    s_add_u32 s48, s42, 94208
    buffer_load_dwordx4 a[176:179], v2, s[28:31], s48 offen sc1
    s_waitcnt lgkmcnt(7)
    v_mfma_f32_16x16x32_bf16 v[104:107], v[88:91], v[36:39], v[104:107]
    ds_read_b128 v[88:91], v14 offset:14336
    s_waitcnt lgkmcnt(7)
    v_mfma_f32_16x16x32_bf16 v[108:111], v[92:95], v[36:39], v[108:111]
    ds_read_b128 v[92:95], v14 offset:15360
    s_waitcnt vmcnt(7)
    s_waitcnt lgkmcnt(7)
    v_mfma_f32_16x16x32_bf16 v[96:99], v[64:67], v[40:43], v[96:99]
    ds_read_b128 v[64:67], v14 offset:16384
    s_waitcnt lgkmcnt(7)
    v_mfma_f32_16x16x32_bf16 v[100:103], v[68:71], v[40:43], v[100:103]
    ds_read_b128 v[68:71], v14 offset:17408
    s_add_u32 s48, s42, 114688
    buffer_load_dwordx4 a[180:183], v2, s[28:31], s48 offen sc1
    s_waitcnt lgkmcnt(7)
    v_mfma_f32_16x16x32_bf16 v[104:107], v[72:75], v[40:43], v[104:107]
    ds_read_b128 v[72:75], v14 offset:18432
    s_waitcnt lgkmcnt(7)
    v_mfma_f32_16x16x32_bf16 v[108:111], v[76:79], v[40:43], v[108:111]
    ds_read_b128 v[76:79], v14 offset:19456
    s_waitcnt vmcnt(7)
    s_waitcnt lgkmcnt(7)
    v_mfma_f32_16x16x32_bf16 v[96:99], v[80:83], v[44:47], v[96:99]
    ds_read_b128 v[80:83], v14 offset:20480
    s_waitcnt lgkmcnt(7)
    v_mfma_f32_16x16x32_bf16 v[100:103], v[84:87], v[44:47], v[100:103]
    ds_read_b128 v[84:87], v14 offset:21504
    s_add_u32 s48, s42, 118784
    buffer_load_dwordx4 a[60:63], v2, s[28:31], s48 offen sc1
    s_waitcnt lgkmcnt(7)
    v_mfma_f32_16x16x32_bf16 v[104:107], v[88:91], v[44:47], v[104:107]
    ds_read_b128 v[88:91], v14 offset:22528
    s_waitcnt lgkmcnt(7)
    v_mfma_f32_16x16x32_bf16 v[108:111], v[92:95], v[44:47], v[108:111]
    ds_read_b128 v[92:95], v14 offset:23552
    s_waitcnt vmcnt(7)
    s_waitcnt lgkmcnt(7)
    v_mfma_f32_16x16x32_bf16 v[96:99], v[64:67], v[48:51], v[96:99]
    ds_read_b128 v[64:67], v14 offset:24576
    s_waitcnt lgkmcnt(7)
    v_mfma_f32_16x16x32_bf16 v[100:103], v[68:71], v[48:51], v[100:103]
    ds_read_b128 v[68:71], v14 offset:25600
    s_add_u32 s48, s42, 135168
    buffer_load_dwordx4 a[184:187], v2, s[28:31], s48 offen sc1
    s_waitcnt lgkmcnt(7)
    v_mfma_f32_16x16x32_bf16 v[104:107], v[72:75], v[48:51], v[104:107]
    ds_read_b128 v[72:75], v14 offset:26624
    s_waitcnt lgkmcnt(7)
    v_mfma_f32_16x16x32_bf16 v[108:111], v[76:79], v[48:51], v[108:111]
    ds_read_b128 v[76:79], v14 offset:27648
    s_waitcnt vmcnt(7)
    s_waitcnt lgkmcnt(7)
    v_mfma_f32_16x16x32_bf16 v[96:99], v[80:83], v[52:55], v[96:99]
    ds_read_b128 v[80:83], v14 offset:28672
    s_waitcnt lgkmcnt(7)
    v_mfma_f32_16x16x32_bf16 v[100:103], v[84:87], v[52:55], v[100:103]
    ds_read_b128 v[84:87], v14 offset:29696
    s_add_u32 s48, s42, 139264
    buffer_load_dwordx4 a[188:191], v2, s[28:31], s48 offen sc1
    s_waitcnt lgkmcnt(7)
    v_mfma_f32_16x16x32_bf16 v[104:107], v[88:91], v[52:55], v[104:107]
    ds_read_b128 v[88:91], v14 offset:30720
    s_waitcnt lgkmcnt(7)
    v_mfma_f32_16x16x32_bf16 v[108:111], v[92:95], v[52:55], v[108:111]
    ds_read_b128 v[92:95], v14 offset:31744
    s_waitcnt vmcnt(7)
    s_waitcnt lgkmcnt(7)
    v_mfma_f32_16x16x32_bf16 v[96:99], v[64:67], v[56:59], v[96:99]
    ds_read_b128 v[64:67], v14 offset:32768
    s_waitcnt lgkmcnt(7)
    v_mfma_f32_16x16x32_bf16 v[100:103], v[68:71], v[56:59], v[100:103]
    ds_read_b128 v[68:71], v14 offset:33792
    s_add_u32 s48, s42, 155648
    buffer_load_dwordx4 a[248:251], v2, s[28:31], s48 offen sc1
    s_waitcnt lgkmcnt(7)
    v_mfma_f32_16x16x32_bf16 v[104:107], v[72:75], v[56:59], v[104:107]
    ds_read_b128 v[72:75], v14 offset:34816
    s_waitcnt lgkmcnt(7)
    v_mfma_f32_16x16x32_bf16 v[108:111], v[76:79], v[56:59], v[108:111]
    ds_read_b128 v[76:79], v14 offset:35840
    s_waitcnt vmcnt(7)
    s_waitcnt lgkmcnt(7)
    v_mfma_f32_16x16x32_bf16 v[96:99], v[80:83], v[60:63], v[96:99]
    ds_read_b128 v[80:83], v14 offset:36864
    s_waitcnt lgkmcnt(7)
    v_mfma_f32_16x16x32_bf16 v[100:103], v[84:87], v[60:63], v[100:103]
    ds_read_b128 v[84:87], v14 offset:37888
    s_add_u32 s48, s42, 159744
    buffer_load_dwordx4 a[252:255], v2, s[28:31], s48 offen sc1
    s_waitcnt lgkmcnt(7)
    v_mfma_f32_16x16x32_bf16 v[104:107], v[88:91], v[60:63], v[104:107]
    ds_read_b128 v[88:91], v14 offset:38912
    s_waitcnt lgkmcnt(7)
    v_mfma_f32_16x16x32_bf16 v[108:111], v[92:95], v[60:63], v[108:111]
    ds_read_b128 v[92:95], v14 offset:39936
    s_waitcnt vmcnt(7)
    s_waitcnt lgkmcnt(7)
    v_mfma_f32_16x16x32_bf16 v[96:99], v[64:67], a[56:59], v[96:99]
    ds_read_b128 v[64:67], v14 offset:40960
    s_waitcnt lgkmcnt(7)
    v_mfma_f32_16x16x32_bf16 v[100:103], v[68:71], a[56:59], v[100:103]
    ds_read_b128 v[68:71], v14 offset:41984
    s_waitcnt lgkmcnt(7)
    v_mfma_f32_16x16x32_bf16 v[104:107], v[72:75], a[56:59], v[104:107]
    ds_read_b128 v[72:75], v14 offset:43008
    s_waitcnt lgkmcnt(7)
    v_mfma_f32_16x16x32_bf16 v[108:111], v[76:79], a[56:59], v[108:111]
    ds_read_b128 v[76:79], v14 offset:44032
    s_waitcnt vmcnt(6)
    s_waitcnt lgkmcnt(7)
    v_mfma_f32_16x16x32_bf16 v[96:99], v[80:83], a[176:179], v[96:99]
    ds_read_b128 v[80:83], v14 offset:45056
    s_waitcnt lgkmcnt(7)
    v_mfma_f32_16x16x32_bf16 v[100:103], v[84:87], a[176:179], v[100:103]
    ds_read_b128 v[84:87], v14 offset:46080
    s_waitcnt lgkmcnt(7)
    v_mfma_f32_16x16x32_bf16 v[104:107], v[88:91], a[176:179], v[104:107]
    ds_read_b128 v[88:91], v14 offset:47104
    s_waitcnt lgkmcnt(7)
    v_mfma_f32_16x16x32_bf16 v[108:111], v[92:95], a[176:179], v[108:111]
    ds_read_b128 v[92:95], v14 offset:48128
    s_waitcnt vmcnt(5)
    s_waitcnt lgkmcnt(7)
    v_mfma_f32_16x16x32_bf16 v[96:99], v[64:67], a[180:183], v[96:99]
    ds_read_b128 v[64:67], v14 offset:49152
    s_waitcnt lgkmcnt(7)
    v_mfma_f32_16x16x32_bf16 v[100:103], v[68:71], a[180:183], v[100:103]
    ds_read_b128 v[68:71], v14 offset:50176
    s_waitcnt lgkmcnt(7)
    v_mfma_f32_16x16x32_bf16 v[104:107], v[72:75], a[180:183], v[104:107]
    ds_read_b128 v[72:75], v14 offset:51200
    s_waitcnt lgkmcnt(7)
    v_mfma_f32_16x16x32_bf16 v[108:111], v[76:79], a[180:183], v[108:111]
    ds_read_b128 v[76:79], v14 offset:52224
    s_waitcnt vmcnt(4)
    s_waitcnt lgkmcnt(7)
    v_mfma_f32_16x16x32_bf16 v[96:99], v[80:83], a[60:63], v[96:99]
    ds_read_b128 v[80:83], v14 offset:53248
    s_waitcnt lgkmcnt(7)
    v_mfma_f32_16x16x32_bf16 v[100:103], v[84:87], a[60:63], v[100:103]
    ds_read_b128 v[84:87], v14 offset:54272
    s_waitcnt lgkmcnt(7)
    v_mfma_f32_16x16x32_bf16 v[104:107], v[88:91], a[60:63], v[104:107]
    ds_read_b128 v[88:91], v14 offset:55296
    s_waitcnt lgkmcnt(7)
    v_mfma_f32_16x16x32_bf16 v[108:111], v[92:95], a[60:63], v[108:111]
    ds_read_b128 v[92:95], v14 offset:56320
    s_waitcnt vmcnt(3)
    s_waitcnt lgkmcnt(7)
    v_mfma_f32_16x16x32_bf16 v[96:99], v[64:67], a[184:187], v[96:99]
    ds_read_b128 v[64:67], v14 offset:57344
    s_waitcnt lgkmcnt(7)
    v_mfma_f32_16x16x32_bf16 v[100:103], v[68:71], a[184:187], v[100:103]
    ds_read_b128 v[68:71], v14 offset:58368
    s_waitcnt lgkmcnt(7)
    v_mfma_f32_16x16x32_bf16 v[104:107], v[72:75], a[184:187], v[104:107]
    ds_read_b128 v[72:75], v14 offset:59392
    s_waitcnt lgkmcnt(7)
    v_mfma_f32_16x16x32_bf16 v[108:111], v[76:79], a[184:187], v[108:111]
    ds_read_b128 v[76:79], v14 offset:60416
    s_waitcnt vmcnt(2)
    s_waitcnt lgkmcnt(7)
    v_mfma_f32_16x16x32_bf16 v[96:99], v[80:83], a[188:191], v[96:99]
    ds_read_b128 v[80:83], v14 offset:61440
    s_waitcnt lgkmcnt(7)
    v_mfma_f32_16x16x32_bf16 v[100:103], v[84:87], a[188:191], v[100:103]
    ds_read_b128 v[84:87], v14 offset:62464
    s_waitcnt lgkmcnt(7)
    v_mfma_f32_16x16x32_bf16 v[104:107], v[88:91], a[188:191], v[104:107]
    ds_read_b128 v[88:91], v14 offset:63488
    s_waitcnt lgkmcnt(7)
    v_mfma_f32_16x16x32_bf16 v[108:111], v[92:95], a[188:191], v[108:111]
    ds_read_b128 v[92:95], v14 offset:64512
    s_waitcnt vmcnt(1)
    s_waitcnt lgkmcnt(7)
    v_mfma_f32_16x16x32_bf16 v[96:99], v[64:67], a[248:251], v[96:99]
    s_waitcnt lgkmcnt(6)
    v_mfma_f32_16x16x32_bf16 v[100:103], v[68:71], a[248:251], v[100:103]
    s_waitcnt lgkmcnt(5)
    v_mfma_f32_16x16x32_bf16 v[104:107], v[72:75], a[248:251], v[104:107]
    s_waitcnt lgkmcnt(4)
    v_mfma_f32_16x16x32_bf16 v[108:111], v[76:79], a[248:251], v[108:111]
    s_waitcnt vmcnt(0)
    s_waitcnt lgkmcnt(3)
    v_mfma_f32_16x16x32_bf16 v[96:99], v[80:83], a[252:255], v[96:99]
    s_waitcnt lgkmcnt(2)
    v_mfma_f32_16x16x32_bf16 v[100:103], v[84:87], a[252:255], v[100:103]
    s_waitcnt lgkmcnt(1)
    v_mfma_f32_16x16x32_bf16 v[104:107], v[88:91], a[252:255], v[104:107]
    s_waitcnt lgkmcnt(0)
    v_mfma_f32_16x16x32_bf16 v[108:111], v[92:95], a[252:255], v[108:111]
    s_add_u32 s42, s3, 0
    s_and_b32 s42, s42, 3
    s_lshl_b32 s48, s42, 14
    v_add_u32 v4, s48, v2
    s_add_u32 s42, s3, 1
    s_and_b32 s42, s42, 3
    s_lshl_b32 s48, s42, 14
    v_add_u32 v5, s48, v2
    s_add_u32 s42, s3, 2
    s_and_b32 s42, s42, 3
    s_lshl_b32 s48, s42, 14
    v_add_u32 v9, s48, v2
    s_add_u32 s42, s3, 3
    s_and_b32 s42, s42, 3
    s_lshl_b32 s48, s42, 14
    v_add_u32 v10, s48, v2
    v_cvt_pk_bf16_f32 v112, v96, v97
    v_cvt_pk_bf16_f32 v113, v98, v99
    v_cvt_pk_bf16_f32 v114, v100, v101
    v_cvt_pk_bf16_f32 v115, v102, v103
    v_cvt_pk_bf16_f32 v116, v104, v105
    v_cvt_pk_bf16_f32 v117, v106, v107
    v_cvt_pk_bf16_f32 v118, v108, v109
    v_cvt_pk_bf16_f32 v119, v110, v111
    s_add_u32 s48, s44, 6291456
    buffer_store_dwordx4 v[112:115], v2, s[8:11], s48 offen offset:0
    buffer_store_dwordx4 v[116:119], v2, s[8:11], s48 offen offset:1024
    v_pk_add_f32 v[32:33], v[96:97], v[104:105]
    v_pk_add_f32 v[34:35], v[98:99], v[106:107]
    v_pk_add_f32 v[36:37], v[100:101], v[108:109]
    v_pk_add_f32 v[38:39], v[102:103], v[110:111]
    v_pk_mul_f32 v[40:41], v[96:97], v[96:97]
    v_pk_add_f32 v[32:33], v[32:33], v[36:37]
    v_pk_add_f32 v[34:35], v[34:35], v[38:39]
    v_pk_fma_f32 v[40:41], v[98:99], v[98:99], v[40:41]
    v_pk_fma_f32 v[40:41], v[100:101], v[100:101], v[40:41]
    v_pk_fma_f32 v[40:41], v[102:103], v[102:103], v[40:41]
    v_pk_fma_f32 v[40:41], v[104:105], v[104:105], v[40:41]
    v_pk_fma_f32 v[40:41], v[106:107], v[106:107], v[40:41]
    v_pk_fma_f32 v[40:41], v[108:109], v[108:109], v[40:41]
    v_pk_fma_f32 v[40:41], v[110:111], v[110:111], v[40:41]
    v_pk_add_f32 v[32:33], v[32:33], v[34:35]
    v_add_f32 v40, v40, v41
    v_add_f32 v32, v32, v33
    v_and_b32 v34, 15, v1
    v_lshlrev_b32 v34, 4, v34
    v_permlane32_swap_b32 v32, v40
    v_lshrrev_b32 v35, 5, v1
    v_add_f32 v32, v32, v40
    v_mov_b32 v40, v32
    v_lshl_add_u32 v34, v35, 2, v34
    s_add_u32 s48, s38, 14221312
    v_permlane16_swap_b32 v32, v40
    s_add_u32 s48, s48, s37
    v_add_f32 v32, v32, v40
    s_mov_b32 exec_lo, 0xffff
    s_mov_b32 exec_hi, 0xffff
    buffer_store_dword v32, v34, s[8:11], s48 offen
    s_mov_b64 exec, -1
    s_add_u32 s48, s70, 8192
    s_waitcnt vmcnt(0)
    s_cmp_eq_u32 s56, 0
    s_cbranch_scc1 L_pf_59
    buffer_wbl2 sc1
    s_waitcnt vmcnt(0)
    s_mov_b64 exec, 1
    buffer_store_dwordx2 v[12:13], v6, s[8:11], s48 offen sc1
    s_branch L_pd_60
L_pf_59:
    s_mov_b64 exec, 1
    buffer_store_dwordx2 v[12:13], v6, s[8:11], s48 offen
L_pd_60:
    s_mov_b64 exec, -1
    v_mfma_f32_16x16x32_bf16 v[16:19], a[200:203], v[28:31], v[16:19]
    v_mfma_f32_16x16x32_bf16 v[20:23], a[204:207], v[28:31], v[20:23]
    v_mfma_f32_16x16x32_bf16 v[24:27], a[208:211], v[28:31], v[24:27]
    v_mfma_f32_16x16x32_bf16 v[16:19], a[212:215], v[28:31], v[16:19]
    v_mfma_f32_16x16x32_bf16 v[20:23], a[216:219], v[28:31], v[20:23]
    v_mfma_f32_16x16x32_bf16 v[24:27], a[220:223], v[28:31], v[24:27]
    v_mfma_f32_16x16x32_bf16 v[16:19], a[224:227], v[28:31], v[16:19]
    v_mfma_f32_16x16x32_bf16 v[20:23], a[228:231], v[28:31], v[20:23]
    v_mfma_f32_16x16x32_bf16 v[24:27], a[232:235], v[28:31], v[24:27]
    v_mfma_f32_16x16x32_bf16 v[16:19], a[236:239], v[28:31], v[16:19]
    v_mfma_f32_16x16x32_bf16 v[20:23], a[240:243], v[28:31], v[20:23]
    v_mfma_f32_16x16x32_bf16 v[24:27], a[244:247], v[28:31], v[24:27]
    s_lshl_b32 s60, s3, 12
    s_lshr_b32 s61, s3, 1
    s_lshl_b32 s61, s61, 12
    s_and_b32 s42, s3, 1
    s_lshl_b32 s42, s42, 3
    s_add_u32 s61, s61, s42
    s_add_u32 s61, s61, 16384
    v_and_b32 v11, 15, v1
    v_lshlrev_b32 v11, 3, v11
    v_add_u32 v11, 159808, v11
    s_add_u32 s42, s3, 0
    s_and_b32 s42, s42, 3
    s_lshl_b32 s42, s42, 10
    v_add_u32 v104, s42, v2
    s_add_u32 s42, s3, 1
    s_and_b32 s42, s42, 3
    s_lshl_b32 s42, s42, 10
    v_add_u32 v105, s42, v2
    s_add_u32 s42, s3, 2
    s_and_b32 s42, s42, 3
    s_lshl_b32 s42, s42, 10
    v_add_u32 v106, s42, v2
    s_add_u32 s42, s3, 3
    s_and_b32 s42, s42, 3
    s_lshl_b32 s42, s42, 10
    v_add_u32 v107, s42, v2
    s_lshl_b32 s42, s3, 14
    s_add_u32 s48, s57, 8192
    s_mov_b32 s43, 0
    s_mov_b64 exec, 0xff
L_poll_61:
    buffer_load_dwordx2 v[48:49], v15, s[8:11], s48 offen sc1
L_pchk_63:
    s_add_u32 s43, s43, 1
    s_waitcnt vmcnt(0)
    v_cmp_ne_u64 vcc, s[64:65], v[48:49]
    s_cmp_ge_u32 s43, 100000
    s_cbranch_scc1 L_polled_62
    s_nop 1
    s_cbranch_vccnz L_poll_61
L_polled_62:
    s_mov_b64 exec, -1
    s_cmp_eq_u32 s56, 0
    s_cbranch_scc1 L_noacq_64
    buffer_inv sc1
    s_waitcnt vmcnt(0)
L_noacq_64:
    s_add_u32 m0, s42, 0
    s_mov_b32 s40, 0
    s_add_u32 s40, s40, s39
    s_add_u32 s40, s40, 6291456
    buffer_load_dwordx4 v2, s[8:11], s40 offen offset:0 sc1 lds
    buffer_load_dwordx4 v2, s[8:11], s40 offen offset:1024 sc1 lds
    buffer_load_dwordx4 v2, s[8:11], s40 offen offset:2048 sc1 lds
    buffer_load_dwordx4 v2, s[8:11], s40 offen offset:3072 sc1 lds
    s_add_u32 m0, s42, 4096
    s_mov_b32 s40, 4096
    s_add_u32 s40, s40, s39
    s_add_u32 s40, s40, 6291456
    buffer_load_dwordx4 v2, s[8:11], s40 offen offset:0 sc1 lds
    buffer_load_dwordx4 v2, s[8:11], s40 offen offset:1024 sc1 lds
    s_add_u32 s48, s38, 14221312
    buffer_load_dwordx4 v[80:83], v2, s[8:11], s48 offen sc1
    buffer_load_dwordx4 v2, s[8:11], s40 offen offset:2048 sc1 lds
    buffer_load_dwordx4 v2, s[8:11], s40 offen offset:3072 sc1 lds
    s_waitcnt vmcnt(8)
    ds_read_b128 v[56:59], v4 offset:0
    s_waitcnt vmcnt(7)
    ds_read_b128 v[60:63], v4 offset:1024
    s_waitcnt lgkmcnt(1)
    v_mfma_f32_16x16x32_bf16 v[32:35], v[120:123], v[56:59], 0
    s_waitcnt vmcnt(6)
    ds_read_b128 v[64:67], v4 offset:2048
    v_mfma_f32_16x16x32_bf16 v[36:39], v[124:127], v[56:59], 0
    s_add_u32 m0, s42, 8192
    s_mov_b32 s40, 8192
    s_add_u32 s40, s40, s39
    s_add_u32 s40, s40, 6291456
    buffer_load_dwordx4 v2, s[8:11], s40 offen offset:0 sc1 lds
    v_mfma_f32_16x16x32_bf16 v[40:43], v[128:131], v[56:59], 0
    s_waitcnt lgkmcnt(1)
    v_mfma_f32_16x16x32_bf16 v[32:35], v[132:135], v[60:63], v[32:35]
    s_waitcnt vmcnt(6)
    ds_read_b128 v[68:71], v4 offset:3072
    v_mfma_f32_16x16x32_bf16 v[36:39], v[136:139], v[60:63], v[36:39]
    buffer_load_dwordx4 v2, s[8:11], s40 offen offset:1024 sc1 lds
    v_mfma_f32_16x16x32_bf16 v[40:43], v[140:143], v[60:63], v[40:43]
    s_waitcnt lgkmcnt(1)
    v_mfma_f32_16x16x32_bf16 v[32:35], v[144:147], v[64:67], v[32:35]
    s_waitcnt vmcnt(6)
    ds_read_b128 v[72:75], v4 offset:4096
    v_mfma_f32_16x16x32_bf16 v[36:39], v[148:151], v[64:67], v[36:39]
    buffer_load_dwordx4 v2, s[8:11], s40 offen offset:2048 sc1 lds
    v_mfma_f32_16x16x32_bf16 v[40:43], v[152:155], v[64:67], v[40:43]
    s_waitcnt lgkmcnt(1)
    v_mfma_f32_16x16x32_bf16 v[32:35], v[156:159], v[68:71], v[32:35]
    s_waitcnt vmcnt(6)
    ds_read_b128 v[76:79], v4 offset:5120
    v_mfma_f32_16x16x32_bf16 v[36:39], v[160:163], v[68:71], v[36:39]
    buffer_load_dwordx4 v2, s[8:11], s40 offen offset:3072 sc1 lds
    v_mfma_f32_16x16x32_bf16 v[40:43], v[164:167], v[68:71], v[40:43]
    s_waitcnt lgkmcnt(1)
    v_mfma_f32_16x16x32_bf16 v[32:35], v[168:171], v[72:75], v[32:35]
    s_waitcnt vmcnt(5)
    ds_read_b128 v[56:59], v4 offset:6144
    v_mfma_f32_16x16x32_bf16 v[36:39], v[172:175], v[72:75], v[36:39]
    s_add_u32 m0, s42, 12288
    s_mov_b32 s40, 12288
    s_add_u32 s40, s40, s39
    s_add_u32 s40, s40, 6291456
    buffer_load_dwordx4 v2, s[8:11], s40 offen offset:0 sc1 lds
    v_mfma_f32_16x16x32_bf16 v[40:43], v[176:179], v[72:75], v[40:43]
    s_waitcnt lgkmcnt(1)
    v_mfma_f32_16x16x32_bf16 v[32:35], v[180:183], v[76:79], v[32:35]
    s_waitcnt vmcnt(5)
    ds_read_b128 v[60:63], v4 offset:7168
    v_add_f32 v80, v80, v82
    v_add_f32 v81, v81, v83
    v_mfma_f32_16x16x32_bf16 v[36:39], v[184:187], v[76:79], v[36:39]
    buffer_load_dwordx4 v2, s[8:11], s40 offen offset:1024 sc1 lds
    v_mov_b32 v82, v80
    v_mov_b32 v83, v81
    v_mfma_f32_16x16x32_bf16 v[40:43], v[188:191], v[76:79], v[40:43]
    s_waitcnt lgkmcnt(1)
    s_nop 0
    v_permlane32_swap_b32 v80, v82
    v_mfma_f32_16x16x32_bf16 v[32:35], v[192:195], v[56:59], v[32:35]
    s_waitcnt vmcnt(5)
    ds_read_b128 v[64:67], v4 offset:8192
    v_permlane32_swap_b32 v81, v83
    v_add_f32 v80, v80, v82
    v_mfma_f32_16x16x32_bf16 v[36:39], v[196:199], v[56:59], v[36:39]
    buffer_load_dwordx4 v2, s[8:11], s40 offen offset:2048 sc1 lds
    v_add_f32 v81, v81, v83
    v_mov_b32 v82, v80
    v_mfma_f32_16x16x32_bf16 v[40:43], v[200:203], v[56:59], v[40:43]
    s_waitcnt lgkmcnt(1)
    v_mov_b32 v83, v81
    s_nop 0
    v_mfma_f32_16x16x32_bf16 v[32:35], v[204:207], v[60:63], v[32:35]
    s_waitcnt vmcnt(5)
    ds_read_b128 v[68:71], v4 offset:9216
    v_permlane16_swap_b32 v80, v82
    v_permlane16_swap_b32 v81, v83
    v_mfma_f32_16x16x32_bf16 v[36:39], v[208:211], v[60:63], v[36:39]
    buffer_load_dwordx4 v2, s[8:11], s40 offen offset:3072 sc1 lds
    v_add_f32 v80, v80, v82
    v_add_f32 v81, v81, v83
    v_mfma_f32_16x16x32_bf16 v[40:43], v[212:215], v[60:63], v[40:43]
    s_waitcnt lgkmcnt(1)
    v_mul_f32 v80, 0xbb000000, v80
    v_mul_f32 v81, 0x3b000000, v81
    v_mfma_f32_16x16x32_bf16 v[32:35], v[216:219], v[64:67], v[32:35]
    s_waitcnt vmcnt(5)
    ds_read_b128 v[72:75], v4 offset:10240
    v_fma_f32 v81, -v80, v80, v81
    v_max_f32 v81, 0, v81
    v_mfma_f32_16x16x32_bf16 v[36:39], v[220:223], v[64:67], v[36:39]
    v_add_f32 v81, 0x3727c5ac, v81
    v_rsq_f32 v81, v81
    v_mfma_f32_16x16x32_bf16 v[40:43], v[224:227], v[64:67], v[40:43]
    s_waitcnt lgkmcnt(1)
    s_nop 0
    v_mov_b32 v8, v81
    v_mfma_f32_16x16x32_bf16 v[32:35], v[228:231], v[68:71], v[32:35]
    s_waitcnt vmcnt(4)
    ds_read_b128 v[76:79], v4 offset:11264
    v_mov_b32 v108, v80
    v_mul_f32 v109, 0xbfb8aa3b, v81
    v_mfma_f32_16x16x32_bf16 v[36:39], v[232:235], v[68:71], v[36:39]
    v_lshrrev_b32 v82, 10, v104
    v_lshl_add_u32 v82, v82, 7, v11
    v_mfma_f32_16x16x32_bf16 v[40:43], v[236:239], v[68:71], v[40:43]
    s_waitcnt lgkmcnt(1)
    ds_write_b64 v82, v[108:109]
    v_lshrrev_b32 v83, 10, v105
    v_mfma_f32_16x16x32_bf16 v[32:35], v[240:243], v[72:75], v[32:35]
    s_waitcnt vmcnt(3)
    ds_read_b128 v[56:59], v4 offset:12288
    v_lshl_add_u32 v83, v83, 7, v11
    v_lshrrev_b32 v84, 10, v106
    v_mfma_f32_16x16x32_bf16 v[36:39], v[244:247], v[72:75], v[36:39]
    v_lshl_add_u32 v84, v84, 7, v11
    v_lshrrev_b32 v85, 10, v107
    v_mfma_f32_16x16x32_bf16 v[40:43], v[248:251], v[72:75], v[40:43]
    s_waitcnt lgkmcnt(2)
    v_lshl_add_u32 v85, v85, 7, v11
    v_mfma_f32_16x16x32_bf16 v[32:35], v[252:255], v[76:79], v[32:35]
    s_waitcnt vmcnt(2)
    ds_read_b128 v[60:63], v4 offset:13312
    v_mfma_f32_16x16x32_bf16 v[36:39], a[192:195], v[76:79], v[36:39]
    v_mfma_f32_16x16x32_bf16 v[40:43], a[196:199], v[76:79], v[40:43]
    s_waitcnt lgkmcnt(1)
    v_mfma_f32_16x16x32_bf16 v[32:35], a[200:203], v[56:59], v[32:35]
    s_waitcnt vmcnt(1)
    ds_read_b128 v[64:67], v4 offset:14336
    v_mfma_f32_16x16x32_bf16 v[36:39], a[204:207], v[56:59], v[36:39]
    v_mfma_f32_16x16x32_bf16 v[40:43], a[208:211], v[56:59], v[40:43]
    s_waitcnt lgkmcnt(1)
    v_mfma_f32_16x16x32_bf16 v[32:35], a[212:215], v[60:63], v[32:35]
    s_waitcnt vmcnt(0)
    ds_read_b128 v[68:71], v4 offset:15360
    v_mfma_f32_16x16x32_bf16 v[36:39], a[216:219], v[60:63], v[36:39]
    v_mfma_f32_16x16x32_bf16 v[40:43], a[220:223], v[60:63], v[40:43]
    s_waitcnt lgkmcnt(1)
    s_barrier
    ds_read_b64 v[110:111], v83
    ds_read_b64 v[28:29], v84
    ds_read_b64 v[30:31], v85
    v_mfma_f32_16x16x32_bf16 v[32:35], a[224:227], v[64:67], v[32:35]
    ds_read_b128 v[72:75], v5 offset:0
    v_mfma_f32_16x16x32_bf16 v[36:39], a[228:231], v[64:67], v[36:39]
    ds_read_b128 v[76:79], v5 offset:1024
    v_mfma_f32_16x16x32_bf16 v[40:43], a[232:235], v[64:67], v[40:43]
    s_waitcnt lgkmcnt(5)
    v_mfma_f32_16x16x32_bf16 v[32:35], a[236:239], v[68:71], v[32:35]
    ds_read_b128 v[56:59], v5 offset:2048
    v_mfma_f32_16x16x32_bf16 v[36:39], a[240:243], v[68:71], v[36:39]
    ds_read_b128 v[60:63], v5 offset:3072
    v_mfma_f32_16x16x32_bf16 v[40:43], a[244:247], v[68:71], v[40:43]
    s_waitcnt lgkmcnt(3)
    v_mfma_f32_16x16x32_bf16 v[44:47], v[120:123], v[72:75], 0
    ds_read_b128 v[64:67], v5 offset:4096
    v_mfma_f32_16x16x32_bf16 v[48:51], v[124:127], v[72:75], 0
    s_add_u32 s50, s55, 40960
    buffer_load_dwordx4 a[56:59], v2, s[20:23], s50 offen offset:2048 sc1
    v_mfma_f32_16x16x32_bf16 v[52:55], v[128:131], v[72:75], 0
    s_waitcnt lgkmcnt(3)
    v_mfma_f32_16x16x32_bf16 v[44:47], v[132:135], v[76:79], v[44:47]
    ds_read_b128 v[68:71], v5 offset:5120
    v_mfma_f32_16x16x32_bf16 v[48:51], v[136:139], v[76:79], v[48:51]
    ds_read_b128 v[72:75], v5 offset:6144
    v_fmac_f32 v32, v108, v16
    v_fmac_f32 v33, v108, v17
    v_fmac_f32 v34, v108, v18
    v_mfma_f32_16x16x32_bf16 v[52:55], v[140:143], v[76:79], v[52:55]
    s_waitcnt lgkmcnt(4)
    v_fmac_f32 v35, v108, v19
    v_fmac_f32 v36, v108, v20
    v_fmac_f32 v37, v108, v21
    v_mfma_f32_16x16x32_bf16 v[44:47], v[144:147], v[56:59], v[44:47]
    ds_read_b128 v[76:79], v5 offset:7168
    v_fmac_f32 v38, v108, v22
    v_fmac_f32 v39, v108, v23
    v_fmac_f32 v40, v108, v24
    v_mfma_f32_16x16x32_bf16 v[48:51], v[148:151], v[56:59], v[48:51]
    s_add_u32 s50, s55, 40960
    buffer_load_dwordx4 a[176:179], v2, s[20:23], s50 offen offset:3072 sc1
    v_fmac_f32 v41, v108, v25
    v_fmac_f32 v42, v108, v26
    v_fmac_f32 v43, v108, v27
    v_mfma_f32_16x16x32_bf16 v[52:55], v[152:155], v[56:59], v[52:55]
    s_waitcnt lgkmcnt(4)
    v_mul_f32 v80, v109, v32
    v_mul_f32 v81, v109, v33
    v_mul_f32 v82, v109, v34
    v_mfma_f32_16x16x32_bf16 v[44:47], v[156:159], v[60:63], v[44:47]
    ds_read_b128 v[56:59], v5 offset:8192
    v_mul_f32 v83, v109, v35
    v_mul_f32 v84, v109, v36
    v_mul_f32 v85, v109, v37
    v_mfma_f32_16x16x32_bf16 v[48:51], v[160:163], v[60:63], v[48:51]
    v_mul_f32 v86, v109, v38
    v_mul_f32 v87, v109, v39
    v_mul_f32 v88, v109, v40
    v_mfma_f32_16x16x32_bf16 v[52:55], v[164:167], v[60:63], v[52:55]
    s_waitcnt lgkmcnt(4)
    v_mul_f32 v89, v109, v41
    v_mul_f32 v90, v109, v42
    v_mul_f32 v91, v109, v43
    v_mfma_f32_16x16x32_bf16 v[44:47], v[168:171], v[64:67], v[44:47]
    ds_read_b128 v[60:63], v5 offset:9216
    v_exp_f32 v80, v80
    v_exp_f32 v81, v81
    v_mfma_f32_16x16x32_bf16 v[48:51], v[172:175], v[64:67], v[48:51]
    s_mov_b32 s49, 0
    s_add_u32 m0, s45, s49
    s_add_u32 s49, s36, s49
    buffer_load_dwordx4 v2, s[12:15], s49 offen offset:0 sc1 lds
    v_exp_f32 v82, v82
    v_exp_f32 v83, v83
    v_mfma_f32_16x16x32_bf16 v[52:55], v[176:179], v[64:67], v[52:55]
    s_waitcnt lgkmcnt(4)
    v_exp_f32 v84, v84
    v_exp_f32 v85, v85
    v_mfma_f32_16x16x32_bf16 v[44:47], v[180:183], v[68:71], v[44:47]
    ds_read_b128 v[64:67], v5 offset:10240
    v_exp_f32 v86, v86
    v_mfma_f32_16x16x32_bf16 v[48:51], v[184:187], v[68:71], v[48:51]
    v_exp_f32 v87, v87
    v_mfma_f32_16x16x32_bf16 v[52:55], v[188:191], v[68:71], v[52:55]
    s_waitcnt lgkmcnt(4)
    v_exp_f32 v88, v88
    v_mfma_f32_16x16x32_bf16 v[44:47], v[192:195], v[72:75], v[44:47]
    ds_read_b128 v[68:71], v5 offset:11264
    v_exp_f32 v89, v89
    v_mfma_f32_16x16x32_bf16 v[48:51], v[196:199], v[72:75], v[48:51]
    buffer_load_dwordx4 v2, s[12:15], s49 offen offset:1024 sc1 lds
    v_exp_f32 v90, v90
    v_mfma_f32_16x16x32_bf16 v[52:55], v[200:203], v[72:75], v[52:55]
    s_waitcnt lgkmcnt(4)
    v_exp_f32 v91, v91
    v_mfma_f32_16x16x32_bf16 v[44:47], v[204:207], v[76:79], v[44:47]
    ds_read_b128 v[72:75], v5 offset:12288
    v_add_f32 v80, 1.0, v80
    v_add_f32 v81, 1.0, v81
    v_mfma_f32_16x16x32_bf16 v[48:51], v[208:211], v[76:79], v[48:51]
    v_add_f32 v82, 1.0, v82
    v_add_f32 v83, 1.0, v83
    v_mfma_f32_16x16x32_bf16 v[52:55], v[212:215], v[76:79], v[52:55]
    s_waitcnt lgkmcnt(4)
    v_add_f32 v84, 1.0, v84
    v_add_f32 v85, 1.0, v85
    v_mfma_f32_16x16x32_bf16 v[44:47], v[216:219], v[56:59], v[44:47]
    ds_read_b128 v[76:79], v5 offset:13312
    v_add_f32 v86, 1.0, v86
    v_add_f32 v87, 1.0, v87
    v_mfma_f32_16x16x32_bf16 v[48:51], v[220:223], v[56:59], v[48:51]
    buffer_load_dwordx4 v2, s[12:15], s49 offen offset:2048 sc1 lds
    v_add_f32 v88, 1.0, v88
    v_add_f32 v89, 1.0, v89
    v_mfma_f32_16x16x32_bf16 v[52:55], v[224:227], v[56:59], v[52:55]
    s_waitcnt lgkmcnt(4)
    v_add_f32 v90, 1.0, v90
    v_add_f32 v91, 1.0, v91
    v_mfma_f32_16x16x32_bf16 v[44:47], v[228:231], v[60:63], v[44:47]
    ds_read_b128 v[56:59], v5 offset:14336
    v_rcp_f32 v80, v80
    v_mfma_f32_16x16x32_bf16 v[48:51], v[232:235], v[60:63], v[48:51]
    v_rcp_f32 v81, v81
    v_mfma_f32_16x16x32_bf16 v[52:55], v[236:239], v[60:63], v[52:55]
    s_waitcnt lgkmcnt(4)
    v_rcp_f32 v82, v82
    v_mfma_f32_16x16x32_bf16 v[44:47], v[240:243], v[64:67], v[44:47]
    ds_read_b128 v[60:63], v5 offset:15360
    v_rcp_f32 v83, v83
    v_mfma_f32_16x16x32_bf16 v[48:51], v[244:247], v[64:67], v[48:51]
    buffer_load_dwordx4 v2, s[12:15], s49 offen offset:3072 sc1 lds
    v_rcp_f32 v84, v84
    v_mfma_f32_16x16x32_bf16 v[52:55], v[248:251], v[64:67], v[52:55]
    s_waitcnt lgkmcnt(4)
    v_rcp_f32 v85, v85
    v_mfma_f32_16x16x32_bf16 v[44:47], v[252:255], v[68:71], v[44:47]
    ds_read_b128 v[64:67], v9 offset:0
    v_rcp_f32 v86, v86
    v_mfma_f32_16x16x32_bf16 v[48:51], a[192:195], v[68:71], v[48:51]
    v_rcp_f32 v87, v87
    v_mfma_f32_16x16x32_bf16 v[52:55], a[196:199], v[68:71], v[52:55]
    s_waitcnt lgkmcnt(4)
    v_rcp_f32 v88, v88
    v_mfma_f32_16x16x32_bf16 v[44:47], a[200:203], v[72:75], v[44:47]
    ds_read_b128 v[68:71], v9 offset:1024
    v_rcp_f32 v89, v89
    v_mfma_f32_16x16x32_bf16 v[48:51], a[204:207], v[72:75], v[48:51]
    s_mov_b32 s49, 4096
    s_add_u32 m0, s45, s49
    s_add_u32 s49, s36, s49
    buffer_load_dwordx4 v2, s[12:15], s49 offen offset:0 sc1 lds
    v_rcp_f32 v90, v90
    v_mfma_f32_16x16x32_bf16 v[52:55], a[208:211], v[72:75], v[52:55]
    s_waitcnt lgkmcnt(4)
    v_rcp_f32 v91, v91
    v_mfma_f32_16x16x32_bf16 v[44:47], a[212:215], v[76:79], v[44:47]
    ds_read_b128 v[72:75], v9 offset:2048
    v_mul_f32 v80, v32, v80
    v_mul_f32 v81, v33, v81
    v_mfma_f32_16x16x32_bf16 v[48:51], a[216:219], v[76:79], v[48:51]
    v_mul_f32 v82, v34, v82
    v_mul_f32 v83, v35, v83
    v_mfma_f32_16x16x32_bf16 v[52:55], a[220:223], v[76:79], v[52:55]
    s_waitcnt lgkmcnt(4)
    v_mul_f32 v84, v36, v84
    v_mul_f32 v85, v37, v85
    v_mfma_f32_16x16x32_bf16 v[44:47], a[224:227], v[56:59], v[44:47]
    ds_read_b128 v[76:79], v9 offset:3072
    v_mul_f32 v86, v38, v86
    v_mul_f32 v87, v39, v87
    v_mfma_f32_16x16x32_bf16 v[48:51], a[228:231], v[56:59], v[48:51]
    buffer_load_dwordx4 v2, s[12:15], s49 offen offset:1024 sc1 lds
    v_mul_f32 v88, v40, v88
    v_mul_f32 v89, v41, v89
    v_mfma_f32_16x16x32_bf16 v[52:55], a[232:235], v[56:59], v[52:55]
    s_waitcnt lgkmcnt(4)
    v_mul_f32 v90, v42, v90
    v_mul_f32 v91, v43, v91
    v_mfma_f32_16x16x32_bf16 v[44:47], a[236:239], v[60:63], v[44:47]
    ds_read_b128 v[56:59], v9 offset:4096
    v_cvt_pk_bf16_f32 v92, v80, v81
    v_cvt_pk_bf16_f32 v93, v82, v83
    v_mfma_f32_16x16x32_bf16 v[48:51], a[240:243], v[60:63], v[48:51]
    v_cvt_pk_bf16_f32 v94, v84, v85
    v_cvt_pk_bf16_f32 v95, v86, v87
    v_mfma_f32_16x16x32_bf16 v[52:55], a[244:247], v[60:63], v[52:55]
    s_waitcnt lgkmcnt(4)
    v_cvt_pk_bf16_f32 v96, v88, v89
    v_cvt_pk_bf16_f32 v97, v90, v91
    v_mfma_f32_16x16x32_bf16 v[32:35], v[120:123], v[64:67], 0
    ds_read_b128 v[60:63], v9 offset:5120
    v_mfma_f32_16x16x32_bf16 v[36:39], v[124:127], v[64:67], 0
    buffer_store_dwordx4 v[92:95], v104, s[24:27], s60 offen
    v_mfma_f32_16x16x32_bf16 v[40:43], v[128:131], v[64:67], 0
    s_waitcnt lgkmcnt(4)
    v_mfma_f32_16x16x32_bf16 v[32:35], v[132:135], v[68:71], v[32:35]
    ds_read_b128 v[64:67], v9 offset:6144
    v_mfma_f32_16x16x32_bf16 v[36:39], v[136:139], v[68:71], v[36:39]
    buffer_store_dwordx2 v[96:97], v104, s[24:27], s61 offen
    v_fmac_f32 v44, v110, v16
    v_fmac_f32 v45, v110, v17
    v_fmac_f32 v46, v110, v18
    v_mfma_f32_16x16x32_bf16 v[40:43], v[140:143], v[68:71], v[40:43]
    s_waitcnt lgkmcnt(4)
    v_fmac_f32 v47, v110, v19
    v_fmac_f32 v48, v110, v20
    v_fmac_f32 v49, v110, v21
    v_mfma_f32_16x16x32_bf16 v[32:35], v[144:147], v[72:75], v[32:35]
    ds_read_b128 v[68:71], v9 offset:7168
    v_fmac_f32 v50, v110, v22
    v_fmac_f32 v51, v110, v23
    v_fmac_f32 v52, v110, v24
    v_mfma_f32_16x16x32_bf16 v[36:39], v[148:151], v[72:75], v[36:39]
    buffer_load_dwordx4 v2, s[12:15], s49 offen offset:2048 sc1 lds
    v_fmac_f32 v53, v110, v25
    v_fmac_f32 v54, v110, v26
    v_fmac_f32 v55, v110, v27
    v_mfma_f32_16x16x32_bf16 v[40:43], v[152:155], v[72:75], v[40:43]
    s_waitcnt lgkmcnt(4)
    v_mul_f32 v80, v111, v44
    v_mul_f32 v81, v111, v45
    v_mul_f32 v82, v111, v46
    v_mfma_f32_16x16x32_bf16 v[32:35], v[156:159], v[76:79], v[32:35]
    ds_read_b128 v[72:75], v9 offset:8192
    v_mul_f32 v83, v111, v47
    v_mul_f32 v84, v111, v48
    v_mul_f32 v85, v111, v49
    v_mfma_f32_16x16x32_bf16 v[36:39], v[160:163], v[76:79], v[36:39]
    v_mul_f32 v86, v111, v50
    v_mul_f32 v87, v111, v51
    v_mul_f32 v88, v111, v52
    v_mfma_f32_16x16x32_bf16 v[40:43], v[164:167], v[76:79], v[40:43]
    s_waitcnt lgkmcnt(4)
    v_mul_f32 v89, v111, v53
    v_mul_f32 v90, v111, v54
    v_mul_f32 v91, v111, v55
    v_mfma_f32_16x16x32_bf16 v[32:35], v[168:171], v[56:59], v[32:35]
    ds_read_b128 v[76:79], v9 offset:9216
    v_exp_f32 v80, v80
    v_exp_f32 v81, v81
    v_mfma_f32_16x16x32_bf16 v[36:39], v[172:175], v[56:59], v[36:39]
    buffer_load_dwordx4 v2, s[12:15], s49 offen offset:3072 sc1 lds
    v_exp_f32 v82, v82
    v_exp_f32 v83, v83
    v_mfma_f32_16x16x32_bf16 v[40:43], v[176:179], v[56:59], v[40:43]
    s_waitcnt lgkmcnt(4)
    v_exp_f32 v84, v84
    v_exp_f32 v85, v85
    v_mfma_f32_16x16x32_bf16 v[32:35], v[180:183], v[60:63], v[32:35]
    ds_read_b128 v[56:59], v9 offset:10240
    v_exp_f32 v86, v86
    v_mfma_f32_16x16x32_bf16 v[36:39], v[184:187], v[60:63], v[36:39]
    v_exp_f32 v87, v87
    v_mfma_f32_16x16x32_bf16 v[40:43], v[188:191], v[60:63], v[40:43]
    s_waitcnt lgkmcnt(4)
    v_exp_f32 v88, v88
    v_mfma_f32_16x16x32_bf16 v[32:35], v[192:195], v[64:67], v[32:35]
    ds_read_b128 v[60:63], v9 offset:11264
    v_exp_f32 v89, v89
    v_mfma_f32_16x16x32_bf16 v[36:39], v[196:199], v[64:67], v[36:39]
    s_mov_b32 s49, 8192
    s_add_u32 m0, s45, s49
    s_add_u32 s49, s36, s49
    buffer_load_dwordx4 v2, s[12:15], s49 offen offset:0 sc1 lds
    v_exp_f32 v90, v90
    v_mfma_f32_16x16x32_bf16 v[40:43], v[200:203], v[64:67], v[40:43]
    s_waitcnt lgkmcnt(4)
    v_exp_f32 v91, v91
    v_mfma_f32_16x16x32_bf16 v[32:35], v[204:207], v[68:71], v[32:35]
    ds_read_b128 v[64:67], v9 offset:12288
    v_add_f32 v80, 1.0, v80
    v_add_f32 v81, 1.0, v81
    v_mfma_f32_16x16x32_bf16 v[36:39], v[208:211], v[68:71], v[36:39]
    v_add_f32 v82, 1.0, v82
    v_add_f32 v83, 1.0, v83
    v_mfma_f32_16x16x32_bf16 v[40:43], v[212:215], v[68:71], v[40:43]
    s_waitcnt lgkmcnt(4)
    v_add_f32 v84, 1.0, v84
    v_add_f32 v85, 1.0, v85
    v_mfma_f32_16x16x32_bf16 v[32:35], v[216:219], v[72:75], v[32:35]
    ds_read_b128 v[68:71], v9 offset:13312
    v_add_f32 v86, 1.0, v86
    v_add_f32 v87, 1.0, v87
    v_mfma_f32_16x16x32_bf16 v[36:39], v[220:223], v[72:75], v[36:39]
    buffer_load_dwordx4 v2, s[12:15], s49 offen offset:1024 sc1 lds
    v_add_f32 v88, 1.0, v88
    v_add_f32 v89, 1.0, v89
    v_mfma_f32_16x16x32_bf16 v[40:43], v[224:227], v[72:75], v[40:43]
    s_waitcnt lgkmcnt(4)
    v_add_f32 v90, 1.0, v90
    v_add_f32 v91, 1.0, v91
    v_mfma_f32_16x16x32_bf16 v[32:35], v[228:231], v[76:79], v[32:35]
    ds_read_b128 v[72:75], v9 offset:14336
    v_rcp_f32 v80, v80
    v_mfma_f32_16x16x32_bf16 v[36:39], v[232:235], v[76:79], v[36:39]
    v_rcp_f32 v81, v81
    v_mfma_f32_16x16x32_bf16 v[40:43], v[236:239], v[76:79], v[40:43]
    s_waitcnt lgkmcnt(4)
    v_rcp_f32 v82, v82
    v_mfma_f32_16x16x32_bf16 v[32:35], v[240:243], v[56:59], v[32:35]
    ds_read_b128 v[76:79], v9 offset:15360
    v_rcp_f32 v83, v83
    v_mfma_f32_16x16x32_bf16 v[36:39], v[244:247], v[56:59], v[36:39]
    buffer_load_dwordx4 v2, s[12:15], s49 offen offset:2048 sc1 lds
    v_rcp_f32 v84, v84
    v_mfma_f32_16x16x32_bf16 v[40:43], v[248:251], v[56:59], v[40:43]
    s_waitcnt lgkmcnt(4)
    v_rcp_f32 v85, v85
    v_mfma_f32_16x16x32_bf16 v[32:35], v[252:255], v[60:63], v[32:35]
    ds_read_b128 v[56:59], v10 offset:0
    v_rcp_f32 v86, v86
    v_mfma_f32_16x16x32_bf16 v[36:39], a[192:195], v[60:63], v[36:39]
    v_rcp_f32 v87, v87
    v_mfma_f32_16x16x32_bf16 v[40:43], a[196:199], v[60:63], v[40:43]
    s_waitcnt lgkmcnt(4)
    v_rcp_f32 v88, v88
    v_mfma_f32_16x16x32_bf16 v[32:35], a[200:203], v[64:67], v[32:35]
    ds_read_b128 v[60:63], v10 offset:1024
    v_rcp_f32 v89, v89
    v_mfma_f32_16x16x32_bf16 v[36:39], a[204:207], v[64:67], v[36:39]
    buffer_load_dwordx4 v2, s[12:15], s49 offen offset:3072 sc1 lds
    v_rcp_f32 v90, v90
    v_mfma_f32_16x16x32_bf16 v[40:43], a[208:211], v[64:67], v[40:43]
    s_waitcnt lgkmcnt(4)
    v_rcp_f32 v91, v91
    v_mfma_f32_16x16x32_bf16 v[32:35], a[212:215], v[68:71], v[32:35]
    ds_read_b128 v[64:67], v10 offset:2048
    v_mul_f32 v80, v44, v80
    v_mul_f32 v81, v45, v81
    v_mfma_f32_16x16x32_bf16 v[36:39], a[216:219], v[68:71], v[36:39]
    v_mul_f32 v82, v46, v82
    v_mul_f32 v83, v47, v83
    v_mfma_f32_16x16x32_bf16 v[40:43], a[220:223], v[68:71], v[40:43]
    s_waitcnt lgkmcnt(4)
    v_mul_f32 v84, v48, v84
    v_mul_f32 v85, v49, v85
    v_mfma_f32_16x16x32_bf16 v[32:35], a[224:227], v[72:75], v[32:35]
    ds_read_b128 v[68:71], v10 offset:3072
    v_mul_f32 v86, v50, v86
    v_mul_f32 v87, v51, v87
    v_mfma_f32_16x16x32_bf16 v[36:39], a[228:231], v[72:75], v[36:39]
    s_mov_b32 s49, 12288
    s_add_u32 m0, s45, s49
    s_add_u32 s49, s36, s49
    buffer_load_dwordx4 v2, s[12:15], s49 offen offset:0 sc1 lds
    v_mul_f32 v88, v52, v88
    v_mul_f32 v89, v53, v89
    v_mfma_f32_16x16x32_bf16 v[40:43], a[232:235], v[72:75], v[40:43]
    s_waitcnt lgkmcnt(4)
    v_mul_f32 v90, v54, v90
    v_mul_f32 v91, v55, v91
    v_mfma_f32_16x16x32_bf16 v[32:35], a[236:239], v[76:79], v[32:35]
    ds_read_b128 v[72:75], v10 offset:4096
    v_cvt_pk_bf16_f32 v98, v80, v81
    v_cvt_pk_bf16_f32 v99, v82, v83
    v_mfma_f32_16x16x32_bf16 v[36:39], a[240:243], v[76:79], v[36:39]
    v_cvt_pk_bf16_f32 v100, v84, v85
    v_cvt_pk_bf16_f32 v101, v86, v87
    v_mfma_f32_16x16x32_bf16 v[40:43], a[244:247], v[76:79], v[40:43]
    s_waitcnt lgkmcnt(4)
    v_cvt_pk_bf16_f32 v102, v88, v89
    v_cvt_pk_bf16_f32 v103, v90, v91
    v_mfma_f32_16x16x32_bf16 v[44:47], v[120:123], v[56:59], 0
    ds_read_b128 v[76:79], v10 offset:5120
    v_mfma_f32_16x16x32_bf16 v[48:51], v[124:127], v[56:59], 0
    buffer_store_dwordx4 v[98:101], v105, s[24:27], s60 offen
    v_mfma_f32_16x16x32_bf16 v[52:55], v[128:131], v[56:59], 0
    s_waitcnt lgkmcnt(4)
    v_mfma_f32_16x16x32_bf16 v[44:47], v[132:135], v[60:63], v[44:47]
    ds_read_b128 v[56:59], v10 offset:6144
    v_mfma_f32_16x16x32_bf16 v[48:51], v[136:139], v[60:63], v[48:51]
    buffer_store_dwordx2 v[102:103], v105, s[24:27], s61 offen
    v_fmac_f32 v32, v28, v16
    v_fmac_f32 v33, v28, v17
    v_fmac_f32 v34, v28, v18
    v_mfma_f32_16x16x32_bf16 v[52:55], v[140:143], v[60:63], v[52:55]
    s_waitcnt lgkmcnt(4)
    v_fmac_f32 v35, v28, v19
    v_fmac_f32 v36, v28, v20
    v_fmac_f32 v37, v28, v21
    v_mfma_f32_16x16x32_bf16 v[44:47], v[144:147], v[64:67], v[44:47]
    ds_read_b128 v[60:63], v10 offset:7168
    v_fmac_f32 v38, v28, v22
    v_fmac_f32 v39, v28, v23
    v_fmac_f32 v40, v28, v24
    v_mfma_f32_16x16x32_bf16 v[48:51], v[148:151], v[64:67], v[48:51]
    buffer_load_dwordx4 v2, s[12:15], s49 offen offset:1024 sc1 lds
    v_fmac_f32 v41, v28, v25
    v_fmac_f32 v42, v28, v26
    v_fmac_f32 v43, v28, v27
    v_mfma_f32_16x16x32_bf16 v[52:55], v[152:155], v[64:67], v[52:55]
    s_waitcnt lgkmcnt(4)
    v_mul_f32 v80, v29, v32
    v_mul_f32 v81, v29, v33
    v_mul_f32 v82, v29, v34
    v_mfma_f32_16x16x32_bf16 v[44:47], v[156:159], v[68:71], v[44:47]
    ds_read_b128 v[64:67], v10 offset:8192
    v_mul_f32 v83, v29, v35
    v_mul_f32 v84, v29, v36
    v_mul_f32 v85, v29, v37
    v_mfma_f32_16x16x32_bf16 v[48:51], v[160:163], v[68:71], v[48:51]
    v_mul_f32 v86, v29, v38
    v_mul_f32 v87, v29, v39
    v_mul_f32 v88, v29, v40
    v_mfma_f32_16x16x32_bf16 v[52:55], v[164:167], v[68:71], v[52:55]
    s_waitcnt lgkmcnt(4)
    v_mul_f32 v89, v29, v41
    v_mul_f32 v90, v29, v42
    v_mul_f32 v91, v29, v43
    v_mfma_f32_16x16x32_bf16 v[44:47], v[168:171], v[72:75], v[44:47]
    ds_read_b128 v[68:71], v10 offset:9216
    v_exp_f32 v80, v80
    v_exp_f32 v81, v81
    v_mfma_f32_16x16x32_bf16 v[48:51], v[172:175], v[72:75], v[48:51]
    buffer_load_dwordx4 v2, s[12:15], s49 offen offset:2048 sc1 lds
    v_exp_f32 v82, v82
    v_exp_f32 v83, v83
    v_mfma_f32_16x16x32_bf16 v[52:55], v[176:179], v[72:75], v[52:55]
    s_waitcnt lgkmcnt(4)
    v_exp_f32 v84, v84
    v_exp_f32 v85, v85
    v_mfma_f32_16x16x32_bf16 v[44:47], v[180:183], v[76:79], v[44:47]
    ds_read_b128 v[72:75], v10 offset:10240
    v_exp_f32 v86, v86
    v_mfma_f32_16x16x32_bf16 v[48:51], v[184:187], v[76:79], v[48:51]
    v_exp_f32 v87, v87
    v_mfma_f32_16x16x32_bf16 v[52:55], v[188:191], v[76:79], v[52:55]
    s_waitcnt lgkmcnt(4)
    v_exp_f32 v88, v88
    v_mfma_f32_16x16x32_bf16 v[44:47], v[192:195], v[56:59], v[44:47]
    ds_read_b128 v[76:79], v10 offset:11264
    v_exp_f32 v89, v89
    v_mfma_f32_16x16x32_bf16 v[48:51], v[196:199], v[56:59], v[48:51]
    buffer_load_dwordx4 v2, s[12:15], s49 offen offset:3072 sc1 lds
    v_exp_f32 v90, v90
    v_mfma_f32_16x16x32_bf16 v[52:55], v[200:203], v[56:59], v[52:55]
    s_waitcnt lgkmcnt(4)
    v_exp_f32 v91, v91
    v_mfma_f32_16x16x32_bf16 v[44:47], v[204:207], v[60:63], v[44:47]
    ds_read_b128 v[56:59], v10 offset:12288
    v_add_f32 v80, 1.0, v80
    v_add_f32 v81, 1.0, v81
    v_mfma_f32_16x16x32_bf16 v[48:51], v[208:211], v[60:63], v[48:51]
    v_add_f32 v82, 1.0, v82
    v_add_f32 v83, 1.0, v83
    v_mfma_f32_16x16x32_bf16 v[52:55], v[212:215], v[60:63], v[52:55]
    s_waitcnt lgkmcnt(4)
    v_add_f32 v84, 1.0, v84
    v_add_f32 v85, 1.0, v85
    v_mfma_f32_16x16x32_bf16 v[44:47], v[216:219], v[64:67], v[44:47]
    ds_read_b128 v[60:63], v10 offset:13312
    v_add_f32 v86, 1.0, v86
    v_add_f32 v87, 1.0, v87
    v_mfma_f32_16x16x32_bf16 v[48:51], v[220:223], v[64:67], v[48:51]
    v_add_f32 v88, 1.0, v88
    v_add_f32 v89, 1.0, v89
    v_mfma_f32_16x16x32_bf16 v[52:55], v[224:227], v[64:67], v[52:55]
    s_waitcnt lgkmcnt(4)
    v_add_f32 v90, 1.0, v90
    v_add_f32 v91, 1.0, v91
    v_mfma_f32_16x16x32_bf16 v[44:47], v[228:231], v[68:71], v[44:47]
    ds_read_b128 v[64:67], v10 offset:14336
    v_rcp_f32 v80, v80
    v_mfma_f32_16x16x32_bf16 v[48:51], v[232:235], v[68:71], v[48:51]
    v_rcp_f32 v81, v81
    v_mfma_f32_16x16x32_bf16 v[52:55], v[236:239], v[68:71], v[52:55]
    s_waitcnt lgkmcnt(4)
    v_rcp_f32 v82, v82
    v_mfma_f32_16x16x32_bf16 v[44:47], v[240:243], v[72:75], v[44:47]
    ds_read_b128 v[68:71], v10 offset:15360
    v_rcp_f32 v83, v83
    v_mfma_f32_16x16x32_bf16 v[48:51], v[244:247], v[72:75], v[48:51]
    v_rcp_f32 v84, v84
    v_mfma_f32_16x16x32_bf16 v[52:55], v[248:251], v[72:75], v[52:55]
    s_waitcnt lgkmcnt(4)
    v_rcp_f32 v85, v85
    v_mfma_f32_16x16x32_bf16 v[44:47], v[252:255], v[76:79], v[44:47]
    v_rcp_f32 v86, v86
    v_mfma_f32_16x16x32_bf16 v[48:51], a[192:195], v[76:79], v[48:51]
    v_rcp_f32 v87, v87
    v_mfma_f32_16x16x32_bf16 v[52:55], a[196:199], v[76:79], v[52:55]
    s_waitcnt lgkmcnt(3)
    v_rcp_f32 v88, v88
    v_mfma_f32_16x16x32_bf16 v[44:47], a[200:203], v[56:59], v[44:47]
    v_rcp_f32 v89, v89
    v_mfma_f32_16x16x32_bf16 v[48:51], a[204:207], v[56:59], v[48:51]
    v_rcp_f32 v90, v90
    v_mfma_f32_16x16x32_bf16 v[52:55], a[208:211], v[56:59], v[52:55]
    s_waitcnt lgkmcnt(2)
    v_rcp_f32 v91, v91
    v_mfma_f32_16x16x32_bf16 v[44:47], a[212:215], v[60:63], v[44:47]
    v_mul_f32 v80, v32, v80
    v_mul_f32 v81, v33, v81
    v_mfma_f32_16x16x32_bf16 v[48:51], a[216:219], v[60:63], v[48:51]
    v_mul_f32 v82, v34, v82
    v_mul_f32 v83, v35, v83
    v_mfma_f32_16x16x32_bf16 v[52:55], a[220:223], v[60:63], v[52:55]
    s_waitcnt lgkmcnt(1)
    v_mul_f32 v84, v36, v84
    v_mul_f32 v85, v37, v85
    v_mfma_f32_16x16x32_bf16 v[44:47], a[224:227], v[64:67], v[44:47]
    v_mul_f32 v86, v38, v86
    v_mul_f32 v87, v39, v87
    v_mfma_f32_16x16x32_bf16 v[48:51], a[228:231], v[64:67], v[48:51]
    v_mul_f32 v88, v40, v88
    v_mul_f32 v89, v41, v89
    v_mfma_f32_16x16x32_bf16 v[52:55], a[232:235], v[64:67], v[52:55]
    s_waitcnt lgkmcnt(0)
    v_mul_f32 v90, v42, v90
    v_mul_f32 v91, v43, v91
    v_mfma_f32_16x16x32_bf16 v[44:47], a[236:239], v[68:71], v[44:47]
    v_cvt_pk_bf16_f32 v92, v80, v81
    v_cvt_pk_bf16_f32 v93, v82, v83
    v_mfma_f32_16x16x32_bf16 v[48:51], a[240:243], v[68:71], v[48:51]
    v_cvt_pk_bf16_f32 v94, v84, v85
    v_cvt_pk_bf16_f32 v95, v86, v87
    v_mfma_f32_16x16x32_bf16 v[52:55], a[244:247], v[68:71], v[52:55]
    v_cvt_pk_bf16_f32 v96, v88, v89
    v_cvt_pk_bf16_f32 v97, v90, v91
    buffer_store_dwordx4 v[92:95], v106, s[24:27], s60 offen
    buffer_store_dwordx2 v[96:97], v106, s[24:27], s61 offen
    s_nop 5
    v_fmac_f32 v44, v30, v16
    v_fmac_f32 v45, v30, v17
    v_fmac_f32 v46, v30, v18
    v_fmac_f32 v47, v30, v19
    v_fmac_f32 v48, v30, v20
    v_fmac_f32 v49, v30, v21
    v_fmac_f32 v50, v30, v22
    v_fmac_f32 v51, v30, v23
    v_fmac_f32 v52, v30, v24
    v_fmac_f32 v53, v30, v25
    v_fmac_f32 v54, v30, v26
    v_fmac_f32 v55, v30, v27
    v_mul_f32 v80, v31, v44
    v_mul_f32 v81, v31, v45
    v_mul_f32 v82, v31, v46
    v_mul_f32 v83, v31, v47
    v_mul_f32 v84, v31, v48
    v_mul_f32 v85, v31, v49
    v_mul_f32 v86, v31, v50
    v_mul_f32 v87, v31, v51
    v_mul_f32 v88, v31, v52
    v_mul_f32 v89, v31, v53
    v_mul_f32 v90, v31, v54
    v_mul_f32 v91, v31, v55
    v_exp_f32 v80, v80
    v_exp_f32 v81, v81
    v_exp_f32 v82, v82
    v_exp_f32 v83, v83
    v_exp_f32 v84, v84
    v_exp_f32 v85, v85
    v_exp_f32 v86, v86
    v_exp_f32 v87, v87
    v_exp_f32 v88, v88
    v_exp_f32 v89, v89
    v_exp_f32 v90, v90
    v_exp_f32 v91, v91
    v_add_f32 v80, 1.0, v80
    v_add_f32 v81, 1.0, v81
    v_add_f32 v82, 1.0, v82
    v_add_f32 v83, 1.0, v83
    v_add_f32 v84, 1.0, v84
    v_add_f32 v85, 1.0, v85
    v_add_f32 v86, 1.0, v86
    v_add_f32 v87, 1.0, v87
    v_add_f32 v88, 1.0, v88
    v_add_f32 v89, 1.0, v89
    v_add_f32 v90, 1.0, v90
    v_add_f32 v91, 1.0, v91
    v_rcp_f32 v80, v80
    v_rcp_f32 v81, v81
    v_rcp_f32 v82, v82
    v_rcp_f32 v83, v83
    v_rcp_f32 v84, v84
    v_rcp_f32 v85, v85
    v_rcp_f32 v86, v86
    v_rcp_f32 v87, v87
    v_rcp_f32 v88, v88
    v_rcp_f32 v89, v89
    v_rcp_f32 v90, v90
    v_rcp_f32 v91, v91
    v_mul_f32 v80, v44, v80
    v_mul_f32 v81, v45, v81
    v_mul_f32 v82, v46, v82
    v_mul_f32 v83, v47, v83
    v_mul_f32 v84, v48, v84
    v_mul_f32 v85, v49, v85
    v_mul_f32 v86, v50, v86
    v_mul_f32 v87, v51, v87
    v_mul_f32 v88, v52, v88
    v_mul_f32 v89, v53, v89
    v_mul_f32 v90, v54, v90
    v_mul_f32 v91, v55, v91
    v_cvt_pk_bf16_f32 v98, v80, v81
    v_cvt_pk_bf16_f32 v99, v82, v83
    v_cvt_pk_bf16_f32 v100, v84, v85
    v_cvt_pk_bf16_f32 v101, v86, v87
    v_cvt_pk_bf16_f32 v102, v88, v89
    v_cvt_pk_bf16_f32 v103, v90, v91
    buffer_store_dwordx4 v[98:101], v107, s[24:27], s60 offen
    buffer_store_dwordx2 v[102:103], v107, s[24:27], s61 offen
    s_add_u32 s48, s59, 16384
    s_waitcnt vmcnt(0)
    s_cmp_eq_u32 s56, 0
    s_cbranch_scc1 L_pf_65
    buffer_wbl2 sc1
    s_waitcnt vmcnt(0)
    s_mov_b64 exec, 1
    buffer_store_dwordx2 v[12:13], v6, s[8:11], s48 offen sc1
    s_branch L_pd_66
L_pf_65:
    s_mov_b64 exec, 1
    buffer_store_dwordx2 v[12:13], v6, s[8:11], s48 offen
L_pd_66:
    s_mov_b64 exec, -1
    s_barrier
    s_mul_i32 s42, s3, 12288
    v_add_u32 v4, s42, v2
    s_add_u32 s42, s3, 3
    s_and_b32 s42, s42, 3
    s_mul_i32 s42, s42, 12288
    v_add_u32 v5, s42, v2
    s_add_u32 s42, s3, 2
    s_and_b32 s42, s42, 3
    s_mul_i32 s42, s42, 12288
    v_add_u32 v9, s42, v2
    s_add_u32 s42, s3, 1
    s_and_b32 s42, s42, 3
    s_mul_i32 s42, s42, 12288
    v_add_u32 v10, s42, v2
    v_lshlrev_b32 v16, 16, v112
    v_and_b32 v17, 0xffff0000, v112
    v_lshlrev_b32 v18, 16, v113
    v_and_b32 v19, 0xffff0000, v113
    v_lshlrev_b32 v20, 16, v114
    v_and_b32 v21, 0xffff0000, v114
    v_lshlrev_b32 v22, 16, v115
    v_and_b32 v23, 0xffff0000, v115
    v_lshlrev_b32 v24, 16, v116
    v_and_b32 v25, 0xffff0000, v116
    v_lshlrev_b32 v26, 16, v117
    v_and_b32 v27, 0xffff0000, v117
    v_lshlrev_b32 v28, 16, v118
    v_and_b32 v29, 0xffff0000, v118
    v_lshlrev_b32 v30, 16, v119
    v_and_b32 v31, 0xffff0000, v119
    s_and_b32 s42, s6, 1
    s_add_u32 s42, s42, 1
    s_lshr_b32 s48, s6, 1
    s_cmp_eq_u32 s48, s3
    s_cselect_b32 s60, s42, 0
    s_cmp_eq_u32 s7, 1
    s_cselect_b32 s60, 0, s60
    s_add_u32 s48, s57, 16384
    s_mov_b32 s43, 0
    s_mov_b64 exec, 0xff
L_poll_67:
    buffer_load_dwordx2 v[48:49], v15, s[8:11], s48 offen sc1
L_pchk_69:
    s_add_u32 s43, s43, 1
    s_waitcnt vmcnt(0)
    v_cmp_ne_u64 vcc, s[64:65], v[48:49]
    s_cmp_ge_u32 s43, 100000
    s_cbranch_scc1 L_polled_68
    s_nop 1
    s_cbranch_vccnz L_poll_67
L_polled_68:
    s_mov_b64 exec, -1
    s_cmp_eq_u32 s56, 0
    s_cbranch_scc1 L_noacq_70
    buffer_inv sc1
    s_waitcnt vmcnt(0)
L_noacq_70:
    s_add_u32 s51, s55, 0
    buffer_load_dwordx4 v[120:123], v105, s[28:31], s51 offen sc1
    s_add_u32 s51, s55, 4096
    buffer_load_dwordx4 v[124:127], v105, s[28:31], s51 offen sc1
    s_add_u32 s51, s55, 8192
    buffer_load_dwordx4 v[128:131], v105, s[28:31], s51 offen sc1
    s_add_u32 s51, s55, 12288
    buffer_load_dwordx4 v[132:135], v105, s[28:31], s51 offen sc1
    s_add_u32 s51, s55, 16384
    buffer_load_dwordx4 v[136:139], v105, s[28:31], s51 offen sc1
    s_add_u32 s51, s55, 20480
    buffer_load_dwordx4 v[140:143], v105, s[28:31], s51 offen sc1
    s_add_u32 s51, s55, 24576
    buffer_load_dwordx4 v[144:147], v105, s[28:31], s51 offen sc1
    s_add_u32 s51, s55, 28672
    buffer_load_dwordx4 v[148:151], v105, s[28:31], s51 offen sc1
    s_waitcnt vmcnt(7)
    v_mfma_f32_16x16x32_bf16 v[48:51], a[0:3], v[120:123], 0
    s_add_u32 s51, s55, 32768
    buffer_load_dwordx4 v[152:155], v105, s[28:31], s51 offen sc1
    v_mfma_f32_16x16x32_bf16 v[52:55], a[64:67], v[120:123], 0
    v_mfma_f32_16x16x32_bf16 v[56:59], a[68:71], v[120:123], 0
    v_mfma_f32_16x16x32_bf16 v[60:63], a[4:7], v[120:123], 0
    s_waitcnt vmcnt(7)
    v_mfma_f32_16x16x32_bf16 v[48:51], a[72:75], v[124:127], v[48:51]
    s_add_u32 s51, s55, 36864
    buffer_load_dwordx4 v[156:159], v105, s[28:31], s51 offen sc1
    v_mfma_f32_16x16x32_bf16 v[52:55], a[76:79], v[124:127], v[52:55]
    v_mfma_f32_16x16x32_bf16 v[56:59], a[8:11], v[124:127], v[56:59]
    v_mfma_f32_16x16x32_bf16 v[60:63], a[80:83], v[124:127], v[60:63]
    s_waitcnt vmcnt(7)
    v_mfma_f32_16x16x32_bf16 v[48:51], a[84:87], v[128:131], v[48:51]
    s_add_u32 s51, s55, 40960
    buffer_load_dwordx4 v[160:163], v105, s[28:31], s51 offen sc1
    v_mfma_f32_16x16x32_bf16 v[52:55], a[12:15], v[128:131], v[52:55]
    v_mfma_f32_16x16x32_bf16 v[56:59], a[88:91], v[128:131], v[56:59]
    v_mfma_f32_16x16x32_bf16 v[60:63], a[92:95], v[128:131], v[60:63]
    s_waitcnt vmcnt(7)
    v_mfma_f32_16x16x32_bf16 v[48:51], a[16:19], v[132:135], v[48:51]
    s_add_u32 s51, s55, 0
    buffer_load_dwordx4 v[164:167], v106, s[28:31], s51 offen sc1
    v_mfma_f32_16x16x32_bf16 v[52:55], a[96:99], v[132:135], v[52:55]
    v_mfma_f32_16x16x32_bf16 v[56:59], a[100:103], v[132:135], v[56:59]
    v_mfma_f32_16x16x32_bf16 v[60:63], a[20:23], v[132:135], v[60:63]
    s_waitcnt vmcnt(7)
    v_mfma_f32_16x16x32_bf16 v[48:51], a[104:107], v[136:139], v[48:51]
    s_add_u32 s51, s55, 4096
    buffer_load_dwordx4 v[168:171], v106, s[28:31], s51 offen sc1
    v_mfma_f32_16x16x32_bf16 v[52:55], a[108:111], v[136:139], v[52:55]
    v_mfma_f32_16x16x32_bf16 v[56:59], a[24:27], v[136:139], v[56:59]
    v_mfma_f32_16x16x32_bf16 v[60:63], a[112:115], v[136:139], v[60:63]
    s_waitcnt vmcnt(7)
    v_mfma_f32_16x16x32_bf16 v[48:51], a[116:119], v[140:143], v[48:51]
    s_add_u32 s51, s55, 8192
    buffer_load_dwordx4 v[172:175], v106, s[28:31], s51 offen sc1
    v_mfma_f32_16x16x32_bf16 v[52:55], a[28:31], v[140:143], v[52:55]
    v_mfma_f32_16x16x32_bf16 v[56:59], a[120:123], v[140:143], v[56:59]
    v_mfma_f32_16x16x32_bf16 v[60:63], a[124:127], v[140:143], v[60:63]
    s_waitcnt vmcnt(7)
    v_mfma_f32_16x16x32_bf16 v[48:51], a[32:35], v[144:147], v[48:51]
    s_add_u32 s51, s55, 12288
    buffer_load_dwordx4 v[176:179], v106, s[28:31], s51 offen sc1
    v_mfma_f32_16x16x32_bf16 v[52:55], a[128:131], v[144:147], v[52:55]
    v_mfma_f32_16x16x32_bf16 v[56:59], a[132:135], v[144:147], v[56:59]
    v_mfma_f32_16x16x32_bf16 v[60:63], a[36:39], v[144:147], v[60:63]
    s_waitcnt vmcnt(7)
    v_mfma_f32_16x16x32_bf16 v[48:51], a[136:139], v[148:151], v[48:51]
    s_add_u32 s51, s55, 16384
    buffer_load_dwordx4 v[180:183], v106, s[28:31], s51 offen sc1
    v_mfma_f32_16x16x32_bf16 v[52:55], a[140:143], v[148:151], v[52:55]
    v_mfma_f32_16x16x32_bf16 v[56:59], a[40:43], v[148:151], v[56:59]
    v_mfma_f32_16x16x32_bf16 v[60:63], a[144:147], v[148:151], v[60:63]
    s_waitcnt vmcnt(7)
    v_mfma_f32_16x16x32_bf16 v[48:51], a[148:151], v[152:155], v[48:51]
    s_add_u32 s51, s55, 20480
    buffer_load_dwordx4 v[184:187], v106, s[28:31], s51 offen sc1
    v_mfma_f32_16x16x32_bf16 v[52:55], a[44:47], v[152:155], v[52:55]
    v_mfma_f32_16x16x32_bf16 v[56:59], a[152:155], v[152:155], v[56:59]
    v_mfma_f32_16x16x32_bf16 v[60:63], a[156:159], v[152:155], v[60:63]
    s_waitcnt vmcnt(7)
    v_mfma_f32_16x16x32_bf16 v[48:51], a[48:51], v[156:159], v[48:51]
    s_add_u32 s51, s55, 24576
    buffer_load_dwordx4 v[188:191], v106, s[28:31], s51 offen sc1
    v_mfma_f32_16x16x32_bf16 v[52:55], a[160:163], v[156:159], v[52:55]
    v_mfma_f32_16x16x32_bf16 v[56:59], a[164:167], v[156:159], v[56:59]
    v_mfma_f32_16x16x32_bf16 v[60:63], a[52:55], v[156:159], v[60:63]
    s_waitcnt vmcnt(7)
    v_mfma_f32_16x16x32_bf16 v[48:51], a[168:171], v[160:163], v[48:51]
    s_add_u32 s51, s55, 28672
    buffer_load_dwordx4 v[192:195], v106, s[28:31], s51 offen sc1
    v_mfma_f32_16x16x32_bf16 v[52:55], a[172:175], v[160:163], v[52:55]
    v_mfma_f32_16x16x32_bf16 v[56:59], a[56:59], v[160:163], v[56:59]
    v_mfma_f32_16x16x32_bf16 v[60:63], a[176:179], v[160:163], v[60:63]
    s_waitcnt vmcnt(7)
    v_mfma_f32_16x16x32_bf16 v[64:67], a[0:3], v[164:167], 0
    s_add_u32 s51, s55, 32768
    buffer_load_dwordx4 v[196:199], v106, s[28:31], s51 offen sc1
    v_mfma_f32_16x16x32_bf16 v[68:71], a[64:67], v[164:167], 0
    v_mfma_f32_16x16x32_bf16 v[72:75], a[68:71], v[164:167], 0
    v_mfma_f32_16x16x32_bf16 v[76:79], a[4:7], v[164:167], 0
    s_waitcnt vmcnt(7)
    v_mfma_f32_16x16x32_bf16 v[64:67], a[72:75], v[168:171], v[64:67]
    s_add_u32 s51, s55, 36864
    buffer_load_dwordx4 v[200:203], v106, s[28:31], s51 offen sc1
    v_mfma_f32_16x16x32_bf16 v[68:71], a[76:79], v[168:171], v[68:71]
    v_mfma_f32_16x16x32_bf16 v[72:75], a[8:11], v[168:171], v[72:75]
    v_mfma_f32_16x16x32_bf16 v[76:79], a[80:83], v[168:171], v[76:79]
    s_waitcnt vmcnt(7)
    v_mfma_f32_16x16x32_bf16 v[64:67], a[84:87], v[172:175], v[64:67]
    s_add_u32 s51, s55, 40960
    buffer_load_dwordx4 v[204:207], v106, s[28:31], s51 offen sc1
    ds_write_b128 v4, v[48:51] offset:0
    v_mfma_f32_16x16x32_bf16 v[68:71], a[12:15], v[172:175], v[68:71]
    ds_write_b128 v4, v[52:55] offset:1024
    v_mfma_f32_16x16x32_bf16 v[72:75], a[88:91], v[172:175], v[72:75]
    ds_write_b128 v4, v[56:59] offset:2048
    v_mfma_f32_16x16x32_bf16 v[76:79], a[92:95], v[172:175], v[76:79]
    s_waitcnt vmcnt(7)
    ds_write_b128 v4, v[60:63] offset:3072
    v_mfma_f32_16x16x32_bf16 v[64:67], a[16:19], v[176:179], v[64:67]
    s_add_u32 s51, s55, 0
    buffer_load_dwordx4 v[208:211], v107, s[28:31], s51 offen sc1
    v_mfma_f32_16x16x32_bf16 v[68:71], a[96:99], v[176:179], v[68:71]
    v_mfma_f32_16x16x32_bf16 v[72:75], a[100:103], v[176:179], v[72:75]
    v_mfma_f32_16x16x32_bf16 v[76:79], a[20:23], v[176:179], v[76:79]
    s_waitcnt vmcnt(7)
    v_mfma_f32_16x16x32_bf16 v[64:67], a[104:107], v[180:183], v[64:67]
    s_add_u32 s51, s55, 4096
    buffer_load_dwordx4 v[212:215], v107, s[28:31], s51 offen sc1
    v_mfma_f32_16x16x32_bf16 v[68:71], a[108:111], v[180:183], v[68:71]
    v_mfma_f32_16x16x32_bf16 v[72:75], a[24:27], v[180:183], v[72:75]
    v_mfma_f32_16x16x32_bf16 v[76:79], a[112:115], v[180:183], v[76:79]
    s_waitcnt vmcnt(7)
    v_mfma_f32_16x16x32_bf16 v[64:67], a[116:119], v[184:187], v[64:67]
    s_add_u32 s51, s55, 8192
    buffer_load_dwordx4 v[216:219], v107, s[28:31], s51 offen sc1
    v_mfma_f32_16x16x32_bf16 v[68:71], a[28:31], v[184:187], v[68:71]
    v_mfma_f32_16x16x32_bf16 v[72:75], a[120:123], v[184:187], v[72:75]
    v_mfma_f32_16x16x32_bf16 v[76:79], a[124:127], v[184:187], v[76:79]
    s_waitcnt vmcnt(7)
    v_mfma_f32_16x16x32_bf16 v[64:67], a[32:35], v[188:191], v[64:67]
    s_add_u32 s51, s55, 12288
    buffer_load_dwordx4 v[220:223], v107, s[28:31], s51 offen sc1
    v_mfma_f32_16x16x32_bf16 v[68:71], a[128:131], v[188:191], v[68:71]
    v_mfma_f32_16x16x32_bf16 v[72:75], a[132:135], v[188:191], v[72:75]
    v_mfma_f32_16x16x32_bf16 v[76:79], a[36:39], v[188:191], v[76:79]
    s_waitcnt vmcnt(7)
    v_mfma_f32_16x16x32_bf16 v[64:67], a[136:139], v[192:195], v[64:67]
    s_add_u32 s51, s55, 16384
    buffer_load_dwordx4 v[224:227], v107, s[28:31], s51 offen sc1
    v_mfma_f32_16x16x32_bf16 v[68:71], a[140:143], v[192:195], v[68:71]
    v_mfma_f32_16x16x32_bf16 v[72:75], a[40:43], v[192:195], v[72:75]
    v_mfma_f32_16x16x32_bf16 v[76:79], a[144:147], v[192:195], v[76:79]
    s_waitcnt vmcnt(7)
    v_mfma_f32_16x16x32_bf16 v[64:67], a[148:151], v[196:199], v[64:67]
    s_add_u32 s51, s55, 20480
    buffer_load_dwordx4 v[228:231], v107, s[28:31], s51 offen sc1
    v_mfma_f32_16x16x32_bf16 v[68:71], a[44:47], v[196:199], v[68:71]
    v_mfma_f32_16x16x32_bf16 v[72:75], a[152:155], v[196:199], v[72:75]
    v_mfma_f32_16x16x32_bf16 v[76:79], a[156:159], v[196:199], v[76:79]
    s_waitcnt vmcnt(7)
    v_mfma_f32_16x16x32_bf16 v[64:67], a[48:51], v[200:203], v[64:67]
    s_add_u32 s51, s55, 24576
    buffer_load_dwordx4 v[232:235], v107, s[28:31], s51 offen sc1
    v_mfma_f32_16x16x32_bf16 v[68:71], a[160:163], v[200:203], v[68:71]
    v_mfma_f32_16x16x32_bf16 v[72:75], a[164:167], v[200:203], v[72:75]
    v_mfma_f32_16x16x32_bf16 v[76:79], a[52:55], v[200:203], v[76:79]
    s_waitcnt vmcnt(7)
    v_mfma_f32_16x16x32_bf16 v[64:67], a[168:171], v[204:207], v[64:67]
    s_add_u32 s51, s55, 28672
    buffer_load_dwordx4 v[236:239], v107, s[28:31], s51 offen sc1
    v_mfma_f32_16x16x32_bf16 v[68:71], a[172:175], v[204:207], v[68:71]
    v_mfma_f32_16x16x32_bf16 v[72:75], a[56:59], v[204:207], v[72:75]
    v_mfma_f32_16x16x32_bf16 v[76:79], a[176:179], v[204:207], v[76:79]
    s_waitcnt vmcnt(7)
    v_mfma_f32_16x16x32_bf16 v[80:83], a[0:3], v[208:211], 0
    s_add_u32 s51, s55, 32768
    buffer_load_dwordx4 v[240:243], v107, s[28:31], s51 offen sc1
    v_mfma_f32_16x16x32_bf16 v[84:87], a[64:67], v[208:211], 0
    v_mfma_f32_16x16x32_bf16 v[88:91], a[68:71], v[208:211], 0
    v_mfma_f32_16x16x32_bf16 v[92:95], a[4:7], v[208:211], 0
    s_waitcnt vmcnt(7)
    v_mfma_f32_16x16x32_bf16 v[80:83], a[72:75], v[212:215], v[80:83]
    s_add_u32 s51, s55, 36864
    buffer_load_dwordx4 v[244:247], v107, s[28:31], s51 offen sc1
    v_mfma_f32_16x16x32_bf16 v[84:87], a[76:79], v[212:215], v[84:87]
    v_mfma_f32_16x16x32_bf16 v[88:91], a[8:11], v[212:215], v[88:91]
    v_mfma_f32_16x16x32_bf16 v[92:95], a[80:83], v[212:215], v[92:95]
    s_waitcnt vmcnt(7)
    v_mfma_f32_16x16x32_bf16 v[80:83], a[84:87], v[216:219], v[80:83]
    s_add_u32 s51, s55, 40960
    buffer_load_dwordx4 v[248:251], v107, s[28:31], s51 offen sc1
    ds_write_b128 v4, v[64:67] offset:4096
    v_mfma_f32_16x16x32_bf16 v[84:87], a[12:15], v[216:219], v[84:87]
    ds_write_b128 v4, v[68:71] offset:5120
    v_mfma_f32_16x16x32_bf16 v[88:91], a[88:91], v[216:219], v[88:91]
    ds_write_b128 v4, v[72:75] offset:6144
    v_mfma_f32_16x16x32_bf16 v[92:95], a[92:95], v[216:219], v[92:95]
    s_waitcnt vmcnt(7)
    ds_write_b128 v4, v[76:79] offset:7168
    v_mfma_f32_16x16x32_bf16 v[80:83], a[16:19], v[220:223], v[80:83]
    s_add_u32 s51, s55, 0
    buffer_load_dwordx4 v[252:255], v104, s[28:31], s51 offen sc1
    v_mfma_f32_16x16x32_bf16 v[84:87], a[96:99], v[220:223], v[84:87]
    v_mfma_f32_16x16x32_bf16 v[88:91], a[100:103], v[220:223], v[88:91]
    v_mfma_f32_16x16x32_bf16 v[92:95], a[20:23], v[220:223], v[92:95]
    s_waitcnt vmcnt(7)
    v_mfma_f32_16x16x32_bf16 v[80:83], a[104:107], v[224:227], v[80:83]
    s_add_u32 s51, s55, 4096
    buffer_load_dwordx4 a[192:195], v104, s[28:31], s51 offen sc1
    v_mfma_f32_16x16x32_bf16 v[84:87], a[108:111], v[224:227], v[84:87]
    v_mfma_f32_16x16x32_bf16 v[88:91], a[24:27], v[224:227], v[88:91]
    v_mfma_f32_16x16x32_bf16 v[92:95], a[112:115], v[224:227], v[92:95]
    s_waitcnt vmcnt(7)
    s_cmp_eq_u32 s60, 0
    s_cbranch_scc1 L_nokw_71
    v_lshrrev_b32 v0, 4, v1
    v_lshlrev_b32 v0, 9, v0
    v_and_b32 v120, 15, v1
    v_lshl_add_u32 v0, v120, 3, v0
    v_add_u32 v0, 143360, v0
    ds_read_b64_tr_b16 v[120:121], v0 offset:0
    ds_read_b64_tr_b16 v[122:123], v0 offset:128
    ds_read_b64_tr_b16 v[124:125], v0 offset:256
    ds_read_b64_tr_b16 v[126:127], v0 offset:384
    ds_read_b64_tr_b16 v[128:129], v0 offset:2048
    ds_read_b64_tr_b16 v[130:131], v0 offset:2176
    ds_read_b64_tr_b16 v[132:133], v0 offset:2304
    ds_read_b64_tr_b16 v[134:135], v0 offset:2432
    ds_read_b64_tr_b16 v[136:137], v0 offset:4096
    ds_read_b64_tr_b16 v[138:139], v0 offset:4224
    ds_read_b64_tr_b16 v[140:141], v0 offset:4352
    ds_read_b64_tr_b16 v[142:143], v0 offset:4480
    ds_read_b64_tr_b16 v[144:145], v0 offset:6144
    ds_read_b64_tr_b16 v[146:147], v0 offset:6272
    ds_read_b64_tr_b16 v[148:149], v0 offset:6400
    ds_read_b64_tr_b16 v[150:151], v0 offset:6528
    ds_read_b64_tr_b16 v[152:153], v0 offset:8192
    ds_read_b64_tr_b16 v[154:155], v0 offset:8320
    ds_read_b64_tr_b16 v[156:157], v0 offset:8448
    ds_read_b64_tr_b16 v[158:159], v0 offset:8576
    ds_read_b64_tr_b16 v[160:161], v0 offset:10240
    ds_read_b64_tr_b16 v[162:163], v0 offset:10368
    ds_read_b64_tr_b16 v[164:165], v0 offset:10496
    ds_read_b64_tr_b16 v[166:167], v0 offset:10624
    ds_read_b64_tr_b16 v[168:169], v0 offset:12288
    ds_read_b64_tr_b16 v[170:171], v0 offset:12416
    ds_read_b64_tr_b16 v[172:173], v0 offset:12544
    ds_read_b64_tr_b16 v[174:175], v0 offset:12672
    ds_read_b64_tr_b16 v[176:177], v0 offset:14336
    ds_read_b64_tr_b16 v[178:179], v0 offset:14464
    ds_read_b64_tr_b16 v[180:181], v0 offset:14592
    ds_read_b64_tr_b16 v[182:183], v0 offset:14720
    v_add_u32 v0, 160768, v2
    ds_read_b128 v[200:203], v0
L_nokw_71:
    v_mfma_f32_16x16x32_bf16 v[80:83], a[116:119], v[228:231], v[80:83]
    s_add_u32 s51, s55, 8192
    buffer_load_dwordx4 a[196:199], v104, s[28:31], s51 offen sc1
    v_mfma_f32_16x16x32_bf16 v[84:87], a[28:31], v[228:231], v[84:87]
    v_mfma_f32_16x16x32_bf16 v[88:91], a[120:123], v[228:231], v[88:91]
    v_mfma_f32_16x16x32_bf16 v[92:95], a[124:127], v[228:231], v[92:95]
    s_waitcnt vmcnt(7)
    v_mfma_f32_16x16x32_bf16 v[80:83], a[32:35], v[232:235], v[80:83]
    s_add_u32 s51, s55, 12288
    buffer_load_dwordx4 a[200:203], v104, s[28:31], s51 offen sc1
    v_mfma_f32_16x16x32_bf16 v[84:87], a[128:131], v[232:235], v[84:87]
    v_mfma_f32_16x16x32_bf16 v[88:91], a[132:135], v[232:235], v[88:91]
    v_mfma_f32_16x16x32_bf16 v[92:95], a[36:39], v[232:235], v[92:95]
    s_waitcnt vmcnt(7)
    v_mfma_f32_16x16x32_bf16 v[80:83], a[136:139], v[236:239], v[80:83]
    s_add_u32 s51, s55, 16384
    buffer_load_dwordx4 a[204:207], v104, s[28:31], s51 offen sc1
    v_mfma_f32_16x16x32_bf16 v[84:87], a[140:143], v[236:239], v[84:87]
    v_mfma_f32_16x16x32_bf16 v[88:91], a[40:43], v[236:239], v[88:91]
    v_mfma_f32_16x16x32_bf16 v[92:95], a[144:147], v[236:239], v[92:95]
    s_waitcnt vmcnt(7)
    v_mfma_f32_16x16x32_bf16 v[80:83], a[148:151], v[240:243], v[80:83]
    s_add_u32 s51, s55, 20480
    buffer_load_dwordx4 a[208:211], v104, s[28:31], s51 offen sc1
    v_mfma_f32_16x16x32_bf16 v[84:87], a[44:47], v[240:243], v[84:87]
    v_mfma_f32_16x16x32_bf16 v[88:91], a[152:155], v[240:243], v[88:91]
    v_mfma_f32_16x16x32_bf16 v[92:95], a[156:159], v[240:243], v[92:95]
    s_waitcnt vmcnt(7)
    v_mfma_f32_16x16x32_bf16 v[80:83], a[48:51], v[244:247], v[80:83]
    s_add_u32 s51, s55, 24576
    buffer_load_dwordx4 a[212:215], v104, s[28:31], s51 offen sc1
    v_mfma_f32_16x16x32_bf16 v[84:87], a[160:163], v[244:247], v[84:87]
    v_mfma_f32_16x16x32_bf16 v[88:91], a[164:167], v[244:247], v[88:91]
    v_mfma_f32_16x16x32_bf16 v[92:95], a[52:55], v[244:247], v[92:95]
    s_waitcnt vmcnt(7)
    v_mfma_f32_16x16x32_bf16 v[80:83], a[168:171], v[248:251], v[80:83]
    s_add_u32 s51, s55, 28672
    buffer_load_dwordx4 a[216:219], v104, s[28:31], s51 offen sc1
    v_mfma_f32_16x16x32_bf16 v[84:87], a[172:175], v[248:251], v[84:87]
    v_mfma_f32_16x16x32_bf16 v[88:91], a[56:59], v[248:251], v[88:91]
    v_mfma_f32_16x16x32_bf16 v[92:95], a[176:179], v[248:251], v[92:95]
    s_waitcnt vmcnt(7)
    v_mfma_f32_16x16x32_bf16 v[32:35], a[0:3], v[252:255], 0
    s_add_u32 s51, s55, 32768
    buffer_load_dwordx4 a[220:223], v104, s[28:31], s51 offen sc1
    v_mfma_f32_16x16x32_bf16 v[36:39], a[64:67], v[252:255], 0
    v_mfma_f32_16x16x32_bf16 v[40:43], a[68:71], v[252:255], 0
    v_mfma_f32_16x16x32_bf16 v[44:47], a[4:7], v[252:255], 0
    s_waitcnt vmcnt(7)
    v_mfma_f32_16x16x32_bf16 v[32:35], a[72:75], a[192:195], v[32:35]
    s_add_u32 s51, s55, 36864
    buffer_load_dwordx4 a[224:227], v104, s[28:31], s51 offen sc1
    v_mfma_f32_16x16x32_bf16 v[36:39], a[76:79], a[192:195], v[36:39]
    v_mfma_f32_16x16x32_bf16 v[40:43], a[8:11], a[192:195], v[40:43]
    v_mfma_f32_16x16x32_bf16 v[44:47], a[80:83], a[192:195], v[44:47]
    s_waitcnt vmcnt(7)
    v_mfma_f32_16x16x32_bf16 v[32:35], a[84:87], a[196:199], v[32:35]
    s_add_u32 s51, s55, 40960
    buffer_load_dwordx4 a[228:231], v104, s[28:31], s51 offen sc1
    ds_write_b128 v4, v[80:83] offset:8192
    v_mfma_f32_16x16x32_bf16 v[36:39], a[12:15], a[196:199], v[36:39]
    ds_write_b128 v4, v[84:87] offset:9216
    v_mfma_f32_16x16x32_bf16 v[40:43], a[88:91], a[196:199], v[40:43]
    ds_write_b128 v4, v[88:91] offset:10240
    v_mfma_f32_16x16x32_bf16 v[44:47], a[92:95], a[196:199], v[44:47]
    s_waitcnt vmcnt(7)
    ds_write_b128 v4, v[92:95] offset:11264
    v_mfma_f32_16x16x32_bf16 v[32:35], a[16:19], a[200:203], v[32:35]
    v_mfma_f32_16x16x32_bf16 v[36:39], a[96:99], a[200:203], v[36:39]
    v_mfma_f32_16x16x32_bf16 v[40:43], a[100:103], a[200:203], v[40:43]
    v_mfma_f32_16x16x32_bf16 v[44:47], a[20:23], a[200:203], v[44:47]
    s_waitcnt vmcnt(6)
    s_waitcnt lgkmcnt(0)
    s_barrier
    v_mfma_f32_16x16x32_bf16 v[32:35], a[104:107], a[204:207], v[32:35]
    ds_read_b128 v[48:51], v5 offset:0
    v_mfma_f32_16x16x32_bf16 v[36:39], a[108:111], a[204:207], v[36:39]
    ds_read_b128 v[52:55], v5 offset:1024
    v_mfma_f32_16x16x32_bf16 v[40:43], a[24:27], a[204:207], v[40:43]
    ds_read_b128 v[56:59], v5 offset:2048
    v_mfma_f32_16x16x32_bf16 v[44:47], a[112:115], a[204:207], v[44:47]
    s_waitcnt vmcnt(5)
    ds_read_b128 v[60:63], v5 offset:3072
    v_mfma_f32_16x16x32_bf16 v[32:35], a[116:119], a[208:211], v[32:35]
    ds_read_b128 v[64:67], v9 offset:4096
    v_mfma_f32_16x16x32_bf16 v[36:39], a[28:31], a[208:211], v[36:39]
    ds_read_b128 v[68:71], v9 offset:5120
    v_mfma_f32_16x16x32_bf16 v[40:43], a[120:123], a[208:211], v[40:43]
    ds_read_b128 v[72:75], v9 offset:6144
    v_mfma_f32_16x16x32_bf16 v[44:47], a[124:127], a[208:211], v[44:47]
    s_waitcnt vmcnt(4)
    ds_read_b128 v[76:79], v9 offset:7168
    v_mfma_f32_16x16x32_bf16 v[32:35], a[32:35], a[212:215], v[32:35]
    ds_read_b128 v[80:83], v10 offset:8192
    v_mfma_f32_16x16x32_bf16 v[36:39], a[128:131], a[212:215], v[36:39]
    ds_read_b128 v[84:87], v10 offset:9216
    v_mfma_f32_16x16x32_bf16 v[40:43], a[132:135], a[212:215], v[40:43]
    ds_read_b128 v[88:91], v10 offset:10240
    v_mfma_f32_16x16x32_bf16 v[44:47], a[36:39], a[212:215], v[44:47]
    s_waitcnt vmcnt(3)
    ds_read_b128 v[92:95], v10 offset:11264
    v_mfma_f32_16x16x32_bf16 v[32:35], a[136:139], a[216:219], v[32:35]
    s_waitcnt lgkmcnt(4)
    v_add_f32 v48, v48, v64
    v_add_f32 v49, v49, v65
    v_mfma_f32_16x16x32_bf16 v[36:39], a[140:143], a[216:219], v[36:39]
    v_add_f32 v50, v50, v66
    v_add_f32 v51, v51, v67
    v_mfma_f32_16x16x32_bf16 v[40:43], a[40:43], a[216:219], v[40:43]
    v_add_f32 v52, v52, v68
    v_add_f32 v53, v53, v69
    v_mfma_f32_16x16x32_bf16 v[44:47], a[144:147], a[216:219], v[44:47]
    s_waitcnt vmcnt(2)
    v_add_f32 v54, v54, v70
    v_add_f32 v55, v55, v71
    v_mfma_f32_16x16x32_bf16 v[32:35], a[148:151], a[220:223], v[32:35]
    v_add_f32 v56, v56, v72
    v_add_f32 v57, v57, v73
    v_mfma_f32_16x16x32_bf16 v[36:39], a[44:47], a[220:223], v[36:39]
    v_add_f32 v58, v58, v74
    v_add_f32 v59, v59, v75
    v_mfma_f32_16x16x32_bf16 v[40:43], a[152:155], a[220:223], v[40:43]
    v_add_f32 v60, v60, v76
    v_add_f32 v61, v61, v77
    v_mfma_f32_16x16x32_bf16 v[44:47], a[156:159], a[220:223], v[44:47]
    s_waitcnt vmcnt(1)
    v_add_f32 v62, v62, v78
    v_add_f32 v63, v63, v79
    v_mfma_f32_16x16x32_bf16 v[32:35], a[48:51], a[224:227], v[32:35]
    s_waitcnt lgkmcnt(0)
    v_add_f32 v48, v48, v80
    v_add_f32 v49, v49, v81
    v_mfma_f32_16x16x32_bf16 v[36:39], a[160:163], a[224:227], v[36:39]
    v_add_f32 v50, v50, v82
    v_add_f32 v51, v51, v83
    v_mfma_f32_16x16x32_bf16 v[40:43], a[164:167], a[224:227], v[40:43]
    v_add_f32 v52, v52, v84
    v_add_f32 v53, v53, v85
    v_mfma_f32_16x16x32_bf16 v[44:47], a[52:55], a[224:227], v[44:47]
    s_waitcnt vmcnt(0)
    v_add_f32 v54, v54, v86
    v_add_f32 v55, v55, v87
    v_mfma_f32_16x16x32_bf16 v[32:35], a[168:171], a[228:231], v[32:35]
    v_add_f32 v56, v56, v88
    v_add_f32 v57, v57, v89
    v_mfma_f32_16x16x32_bf16 v[36:39], a[172:175], a[228:231], v[36:39]
    v_add_f32 v58, v58, v90
    v_add_f32 v59, v59, v91
    v_mfma_f32_16x16x32_bf16 v[40:43], a[56:59], a[228:231], v[40:43]
    v_add_f32 v60, v60, v92
    v_add_f32 v61, v61, v93
    v_mfma_f32_16x16x32_bf16 v[44:47], a[176:179], a[228:231], v[44:47]
    v_add_f32 v62, v62, v94
    v_add_f32 v63, v63, v95
    v_fmac_f32 v16, v8, v48
    v_fmac_f32 v17, v8, v49
    v_fmac_f32 v18, v8, v50
    v_fmac_f32 v19, v8, v51
    v_fmac_f32 v20, v8, v52
    v_fmac_f32 v21, v8, v53
    v_fmac_f32 v22, v8, v54
    v_fmac_f32 v23, v8, v55
    v_fmac_f32 v24, v8, v56
    v_fmac_f32 v25, v8, v57
    v_fmac_f32 v26, v8, v58
    v_fmac_f32 v27, v8, v59
    v_fmac_f32 v28, v8, v60
    v_fmac_f32 v29, v8, v61
    v_fmac_f32 v30, v8, v62
    v_fmac_f32 v31, v8, v63
    v_pk_fma_f32 v[16:17], v[32:33], v[8:9], v[16:17] op_sel_hi:[1,0,1]
    v_pk_fma_f32 v[18:19], v[34:35], v[8:9], v[18:19] op_sel_hi:[1,0,1]
    v_pk_fma_f32 v[20:21], v[36:37], v[8:9], v[20:21] op_sel_hi:[1,0,1]
    v_pk_fma_f32 v[22:23], v[38:39], v[8:9], v[22:23] op_sel_hi:[1,0,1]
    v_pk_fma_f32 v[24:25], v[40:41], v[8:9], v[24:25] op_sel_hi:[1,0,1]
    v_pk_fma_f32 v[26:27], v[42:43], v[8:9], v[26:27] op_sel_hi:[1,0,1]
    v_pk_fma_f32 v[28:29], v[44:45], v[8:9], v[28:29] op_sel_hi:[1,0,1]
    v_pk_fma_f32 v[30:31], v[46:47], v[8:9], v[30:31] op_sel_hi:[1,0,1]
    v_cvt_pk_bf16_f32 v112, v16, v17
    v_cvt_pk_bf16_f32 v113, v18, v19
    v_cvt_pk_bf16_f32 v114, v20, v21
    v_cvt_pk_bf16_f32 v115, v22, v23
    v_cvt_pk_bf16_f32 v116, v24, v25
    v_cvt_pk_bf16_f32 v117, v26, v27
    v_cvt_pk_bf16_f32 v118, v28, v29
    v_cvt_pk_bf16_f32 v119, v30, v31
    s_cmp_eq_u32 s7, 1
    s_cbranch_scc1 L_last_72
    s_add_u32 s48, s44, 6291456
    buffer_store_dwordx4 v[112:115], v2, s[8:11], s48 offen offset:0
    buffer_store_dwordx4 v[116:119], v2, s[8:11], s48 offen offset:1024
    v_pk_add_f32 v[32:33], v[16:17], v[24:25]
    v_pk_add_f32 v[34:35], v[18:19], v[26:27]
    v_pk_add_f32 v[36:37], v[20:21], v[28:29]
    v_pk_add_f32 v[38:39], v[22:23], v[30:31]
    v_pk_mul_f32 v[40:41], v[16:17], v[16:17]
    v_pk_add_f32 v[32:33], v[32:33], v[36:37]
    v_pk_add_f32 v[34:35], v[34:35], v[38:39]
    v_pk_fma_f32 v[40:41], v[18:19], v[18:19], v[40:41]
    v_pk_fma_f32 v[40:41], v[20:21], v[20:21], v[40:41]
    v_pk_fma_f32 v[40:41], v[22:23], v[22:23], v[40:41]
    v_pk_fma_f32 v[40:41], v[24:25], v[24:25], v[40:41]
    v_pk_fma_f32 v[40:41], v[26:27], v[26:27], v[40:41]
    v_pk_fma_f32 v[40:41], v[28:29], v[28:29], v[40:41]
    v_pk_fma_f32 v[40:41], v[30:31], v[30:31], v[40:41]
    v_pk_add_f32 v[32:33], v[32:33], v[34:35]
    v_add_f32 v40, v40, v41
    v_add_f32 v32, v32, v33
    v_and_b32 v34, 15, v1
    v_lshlrev_b32 v34, 4, v34
    v_permlane32_swap_b32 v32, v40
    v_lshrrev_b32 v35, 5, v1
    v_add_f32 v32, v32, v40
    v_mov_b32 v40, v32
    v_lshl_add_u32 v34, v35, 2, v34
    s_add_u32 s48, s38, 14221312
    v_permlane16_swap_b32 v32, v40
    s_add_u32 s48, s48, s37
    v_add_f32 v32, v32, v40
    s_mov_b32 exec_lo, 0xffff
    s_mov_b32 exec_hi, 0xffff
    buffer_store_dword v32, v34, s[8:11], s48 offen
    s_mov_b64 exec, -1
    v_lshrrev_b32 v0, 4, v1
    v_lshlrev_b32 v0, 6, v0
    v_add_u32 v0, 160512, v0
    ds_read_b128 v[184:187], v0 offset:0
    ds_read_b128 v[188:191], v0 offset:16
    ds_read_b128 v[192:195], v0 offset:32
    ds_read_b128 v[196:199], v0 offset:48
    v_and_b32 v9, 15, v1
    v_lshlrev_b32 v9, 4, v9
    v_bfe_u32 v10, v1, 4, 1
    v_lshl_add_u32 v9, v10, 3, v9
    s_cmp_eq_u32 s60, 2
    s_cbranch_scc1 L_isv_73
    v_lshrrev_b32 v10, 5, v1
    v_lshl_add_u32 v9, v10, 9, v9
    s_lshr_b32 s61, s38, 11
    s_lshl_b32 s61, s61, 10
    s_bfe_u32 s42, s38, 0x1000a
    s_lshl_b32 s42, s42, 8
    s_add_u32 s61, s61, s42
    s_branch L_kvd_74
L_isv_73:
    v_and_b32 v4, 15, v1
    v_lshlrev_b32 v4, 3, v4
    v_add_u32 v4, 160320, v4
    v_lshrrev_b32 v5, 4, v1
    v_lshlrev_b32 v5, 5, v5
    v_add_u32 v5, 160320, v5
    v_lshrrev_b32 v10, 5, v1
    v_mul_u32_u24 v10, 272, v10
    v_add_u32 v9, v9, v10
    s_lshr_b32 s61, s38, 9
    s_mul_i32 s61, s61, 272
    s_add_u32 s61, s61, 65536
L_kvd_74:
    s_add_u32 s61, s61, s58
    s_add_u32 s48, s70, 24576
    s_waitcnt vmcnt(0)
    s_cmp_eq_u32 s56, 0
    s_cbranch_scc1 L_pf_75
    buffer_wbl2 sc1
    s_waitcnt vmcnt(0)
    s_mov_b64 exec, 1
    buffer_store_dwordx2 v[12:13], v6, s[8:11], s48 offen sc1
    s_branch L_pd_76
L_pf_75:
    s_mov_b64 exec, 1
    buffer_store_dwordx2 v[12:13], v6, s[8:11], s48 offen
L_pd_76:
    s_mov_b64 exec, -1
    s_cmp_lg_u32 s60, 0
    s_cbranch_scc1 L_kv2_77
    ds_read_b128 v[64:67], v14 offset:0
    ds_read_b128 v[68:71], v14 offset:1024
    ds_read_b128 v[72:75], v14 offset:2048
    ds_read_b128 v[76:79], v14 offset:3072
    ds_read_b128 v[80:83], v14 offset:4096
    ds_read_b128 v[84:87], v14 offset:5120
    ds_read_b128 v[88:91], v14 offset:6144
    ds_read_b128 v[92:95], v14 offset:7168
    s_add_u32 s48, s57, 24576
    s_mov_b32 s43, 0
    s_mov_b64 exec, 0xff
L_poll_79:
    buffer_load_dwordx2 v[48:49], v15, s[8:11], s48 offen sc1
L_pchk_81:
    s_add_u32 s43, s43, 1
    s_waitcnt vmcnt(0)
    v_cmp_ne_u64 vcc, s[64:65], v[48:49]
    s_cmp_ge_u32 s43, 100000
    s_cbranch_scc1 L_polled_80
    s_nop 1
    s_cbranch_vccnz L_poll_79
L_polled_80:
    s_mov_b64 exec, -1
    s_cmp_eq_u32 s56, 0
    s_cbranch_scc1 L_noacq_82
    buffer_inv sc1
    s_waitcnt vmcnt(0)
L_noacq_82:
    s_add_u32 s48, s39, 6291456
    buffer_load_dwordx4 v[16:19], v2, s[8:11], s48 offen offset:0 sc1
    buffer_load_dwordx4 v[20:23], v2, s[8:11], s48 offen offset:1024 sc1
    buffer_load_dwordx4 v[24:27], v2, s[8:11], s48 offen offset:2048 sc1
    buffer_load_dwordx4 v[28:31], v2, s[8:11], s48 offen offset:3072 sc1
    s_add_u32 s48, s39, 6295552
    buffer_load_dwordx4 v[32:35], v2, s[8:11], s48 offen offset:0 sc1
    buffer_load_dwordx4 v[36:39], v2, s[8:11], s48 offen offset:1024 sc1
    buffer_load_dwordx4 v[40:43], v2, s[8:11], s48 offen offset:2048 sc1
    buffer_load_dwordx4 v[44:47], v2, s[8:11], s48 offen offset:3072 sc1
    s_waitcnt vmcnt(7)
    s_waitcnt lgkmcnt(7)
    v_mfma_f32_16x16x32_bf16 v[96:99], v[64:67], v[16:19], 0
    ds_read_b128 v[64:67], v14 offset:8192
    s_waitcnt lgkmcnt(7)
    v_mfma_f32_16x16x32_bf16 v[100:103], v[68:71], v[16:19], 0
    ds_read_b128 v[68:71], v14 offset:9216
    s_add_u32 s48, s39, 6299648
    buffer_load_dwordx4 v[52:55], v2, s[8:11], s48 offen offset:0 sc1
    s_waitcnt lgkmcnt(7)
    v_mfma_f32_16x16x32_bf16 v[104:107], v[72:75], v[16:19], 0
    ds_read_b128 v[72:75], v14 offset:10240
    s_waitcnt lgkmcnt(7)
    v_mfma_f32_16x16x32_bf16 v[108:111], v[76:79], v[16:19], 0
    ds_read_b128 v[76:79], v14 offset:11264
    s_waitcnt vmcnt(7)
    s_waitcnt lgkmcnt(7)
    v_mfma_f32_16x16x32_bf16 v[96:99], v[80:83], v[20:23], v[96:99]
    ds_read_b128 v[80:83], v14 offset:12288
    s_waitcnt lgkmcnt(7)
    v_mfma_f32_16x16x32_bf16 v[100:103], v[84:87], v[20:23], v[100:103]
    ds_read_b128 v[84:87], v14 offset:13312
    buffer_load_dwordx4 v[56:59], v2, s[8:11], s48 offen offset:1024 sc1
    s_waitcnt lgkmcnt(7)
    v_mfma_f32_16x16x32_bf16 v[104:107], v[88:91], v[20:23], v[104:107]
    ds_read_b128 v[88:91], v14 offset:14336
    s_waitcnt lgkmcnt(7)
    v_mfma_f32_16x16x32_bf16 v[108:111], v[92:95], v[20:23], v[108:111]
    ds_read_b128 v[92:95], v14 offset:15360
    s_waitcnt vmcnt(7)
    s_waitcnt lgkmcnt(7)
    v_mfma_f32_16x16x32_bf16 v[96:99], v[64:67], v[24:27], v[96:99]
    ds_read_b128 v[64:67], v14 offset:16384
    s_waitcnt lgkmcnt(7)
    v_mfma_f32_16x16x32_bf16 v[100:103], v[68:71], v[24:27], v[100:103]
    ds_read_b128 v[68:71], v14 offset:17408
    buffer_load_dwordx4 v[60:63], v2, s[8:11], s48 offen offset:2048 sc1
    s_waitcnt lgkmcnt(7)
    v_mfma_f32_16x16x32_bf16 v[104:107], v[72:75], v[24:27], v[104:107]
    ds_read_b128 v[72:75], v14 offset:18432
    s_waitcnt lgkmcnt(7)
    v_mfma_f32_16x16x32_bf16 v[108:111], v[76:79], v[24:27], v[108:111]
    ds_read_b128 v[76:79], v14 offset:19456
    s_waitcnt vmcnt(7)
    s_waitcnt lgkmcnt(7)
    v_mfma_f32_16x16x32_bf16 v[96:99], v[80:83], v[28:31], v[96:99]
    ds_read_b128 v[80:83], v14 offset:20480
    s_waitcnt lgkmcnt(7)
    v_mfma_f32_16x16x32_bf16 v[100:103], v[84:87], v[28:31], v[100:103]
    ds_read_b128 v[84:87], v14 offset:21504
    buffer_load_dwordx4 a[192:195], v2, s[8:11], s48 offen offset:3072 sc1
    s_waitcnt lgkmcnt(7)
    v_mfma_f32_16x16x32_bf16 v[104:107], v[88:91], v[28:31], v[104:107]
    ds_read_b128 v[88:91], v14 offset:22528
    s_waitcnt lgkmcnt(7)
    v_mfma_f32_16x16x32_bf16 v[108:111], v[92:95], v[28:31], v[108:111]
    ds_read_b128 v[92:95], v14 offset:23552
    s_waitcnt vmcnt(7)
    s_waitcnt lgkmcnt(7)
    v_mfma_f32_16x16x32_bf16 v[96:99], v[64:67], v[32:35], v[96:99]
    ds_read_b128 v[64:67], v14 offset:24576
    s_waitcnt lgkmcnt(7)
    v_mfma_f32_16x16x32_bf16 v[100:103], v[68:71], v[32:35], v[100:103]
    ds_read_b128 v[68:71], v14 offset:25600
    s_add_u32 s48, s39, 6303744
    buffer_load_dwordx4 a[196:199], v2, s[8:11], s48 offen offset:0 sc1
    s_waitcnt lgkmcnt(7)
    v_mfma_f32_16x16x32_bf16 v[104:107], v[72:75], v[32:35], v[104:107]
    ds_read_b128 v[72:75], v14 offset:26624
    s_waitcnt lgkmcnt(7)
    v_mfma_f32_16x16x32_bf16 v[108:111], v[76:79], v[32:35], v[108:111]
    ds_read_b128 v[76:79], v14 offset:27648
    s_waitcnt vmcnt(7)
    s_waitcnt lgkmcnt(7)
    v_mfma_f32_16x16x32_bf16 v[96:99], v[80:83], v[36:39], v[96:99]
    ds_read_b128 v[80:83], v14 offset:28672
    s_waitcnt lgkmcnt(7)
    v_mfma_f32_16x16x32_bf16 v[100:103], v[84:87], v[36:39], v[100:103]
    ds_read_b128 v[84:87], v14 offset:29696
    buffer_load_dwordx4 a[200:203], v2, s[8:11], s48 offen offset:1024 sc1
    s_waitcnt lgkmcnt(7)
    v_mfma_f32_16x16x32_bf16 v[104:107], v[88:91], v[36:39], v[104:107]
    ds_read_b128 v[88:91], v14 offset:30720
    s_waitcnt lgkmcnt(7)
    v_mfma_f32_16x16x32_bf16 v[108:111], v[92:95], v[36:39], v[108:111]
    ds_read_b128 v[92:95], v14 offset:31744
    s_waitcnt vmcnt(7)
    s_waitcnt lgkmcnt(7)
    v_mfma_f32_16x16x32_bf16 v[96:99], v[64:67], v[40:43], v[96:99]
    ds_read_b128 v[64:67], v14 offset:32768
    s_waitcnt lgkmcnt(7)
    v_mfma_f32_16x16x32_bf16 v[100:103], v[68:71], v[40:43], v[100:103]
    ds_read_b128 v[68:71], v14 offset:33792
    buffer_load_dwordx4 a[204:207], v2, s[8:11], s48 offen offset:2048 sc1
    s_waitcnt lgkmcnt(7)
    v_mfma_f32_16x16x32_bf16 v[104:107], v[72:75], v[40:43], v[104:107]
    ds_read_b128 v[72:75], v14 offset:34816
    s_waitcnt lgkmcnt(7)
    v_mfma_f32_16x16x32_bf16 v[108:111], v[76:79], v[40:43], v[108:111]
    ds_read_b128 v[76:79], v14 offset:35840
    s_waitcnt vmcnt(7)
    s_waitcnt lgkmcnt(7)
    v_mfma_f32_16x16x32_bf16 v[96:99], v[80:83], v[44:47], v[96:99]
    ds_read_b128 v[80:83], v14 offset:36864
    s_waitcnt lgkmcnt(7)
    v_mfma_f32_16x16x32_bf16 v[100:103], v[84:87], v[44:47], v[100:103]
    ds_read_b128 v[84:87], v14 offset:37888
    buffer_load_dwordx4 a[208:211], v2, s[8:11], s48 offen offset:3072 sc1
    s_add_u32 s48, s38, 14221312
    buffer_load_dwordx4 v[216:219], v2, s[8:11], s48 offen sc1
    s_waitcnt lgkmcnt(7)
    v_mfma_f32_16x16x32_bf16 v[104:107], v[88:91], v[44:47], v[104:107]
    ds_read_b128 v[88:91], v14 offset:38912
    s_waitcnt lgkmcnt(7)
    v_mfma_f32_16x16x32_bf16 v[108:111], v[92:95], v[44:47], v[108:111]
    ds_read_b128 v[92:95], v14 offset:39936
    s_waitcnt vmcnt(8)
    s_waitcnt lgkmcnt(7)
    v_mfma_f32_16x16x32_bf16 v[96:99], v[64:67], v[52:55], v[96:99]
    ds_read_b128 v[64:67], v14 offset:40960
    s_waitcnt lgkmcnt(7)
    v_mfma_f32_16x16x32_bf16 v[100:103], v[68:71], v[52:55], v[100:103]
    ds_read_b128 v[68:71], v14 offset:41984
    s_waitcnt lgkmcnt(7)
    v_mfma_f32_16x16x32_bf16 v[104:107], v[72:75], v[52:55], v[104:107]
    ds_read_b128 v[72:75], v14 offset:43008
    s_waitcnt lgkmcnt(7)
    v_mfma_f32_16x16x32_bf16 v[108:111], v[76:79], v[52:55], v[108:111]
    ds_read_b128 v[76:79], v14 offset:44032
    s_waitcnt vmcnt(7)
    s_waitcnt lgkmcnt(7)
    v_mfma_f32_16x16x32_bf16 v[96:99], v[80:83], v[56:59], v[96:99]
    ds_read_b128 v[80:83], v14 offset:45056
    s_waitcnt lgkmcnt(7)
    v_mfma_f32_16x16x32_bf16 v[100:103], v[84:87], v[56:59], v[100:103]
    ds_read_b128 v[84:87], v14 offset:46080
    s_waitcnt lgkmcnt(7)
    v_mfma_f32_16x16x32_bf16 v[104:107], v[88:91], v[56:59], v[104:107]
    ds_read_b128 v[88:91], v14 offset:47104
    s_waitcnt lgkmcnt(7)
    v_mfma_f32_16x16x32_bf16 v[108:111], v[92:95], v[56:59], v[108:111]
    ds_read_b128 v[92:95], v14 offset:48128
    s_waitcnt vmcnt(6)
    s_waitcnt lgkmcnt(7)
    v_mfma_f32_16x16x32_bf16 v[96:99], v[64:67], v[60:63], v[96:99]
    ds_read_b128 v[64:67], v14 offset:49152
    s_waitcnt lgkmcnt(7)
    v_mfma_f32_16x16x32_bf16 v[100:103], v[68:71], v[60:63], v[100:103]
    ds_read_b128 v[68:71], v14 offset:50176
    s_waitcnt lgkmcnt(7)
    v_mfma_f32_16x16x32_bf16 v[104:107], v[72:75], v[60:63], v[104:107]
    ds_read_b128 v[72:75], v14 offset:51200
    s_waitcnt lgkmcnt(7)
    v_mfma_f32_16x16x32_bf16 v[108:111], v[76:79], v[60:63], v[108:111]
    ds_read_b128 v[76:79], v14 offset:52224
    s_waitcnt vmcnt(5)
    s_waitcnt lgkmcnt(7)
    v_mfma_f32_16x16x32_bf16 v[96:99], v[80:83], a[192:195], v[96:99]
    ds_read_b128 v[80:83], v14 offset:53248
    s_waitcnt lgkmcnt(7)
    v_mfma_f32_16x16x32_bf16 v[100:103], v[84:87], a[192:195], v[100:103]
    ds_read_b128 v[84:87], v14 offset:54272
    s_waitcnt lgkmcnt(7)
    v_mfma_f32_16x16x32_bf16 v[104:107], v[88:91], a[192:195], v[104:107]
    ds_read_b128 v[88:91], v14 offset:55296
    s_waitcnt lgkmcnt(7)
    v_mfma_f32_16x16x32_bf16 v[108:111], v[92:95], a[192:195], v[108:111]
    ds_read_b128 v[92:95], v14 offset:56320
    s_waitcnt vmcnt(4)
    s_waitcnt lgkmcnt(7)
    v_mfma_f32_16x16x32_bf16 v[96:99], v[64:67], a[196:199], v[96:99]
    ds_read_b128 v[64:67], v14 offset:57344
    s_waitcnt lgkmcnt(7)
    v_mfma_f32_16x16x32_bf16 v[100:103], v[68:71], a[196:199], v[100:103]
    ds_read_b128 v[68:71], v14 offset:58368
    s_waitcnt lgkmcnt(7)
    v_mfma_f32_16x16x32_bf16 v[104:107], v[72:75], a[196:199], v[104:107]
    ds_read_b128 v[72:75], v14 offset:59392
    s_waitcnt lgkmcnt(7)
    v_mfma_f32_16x16x32_bf16 v[108:111], v[76:79], a[196:199], v[108:111]
    ds_read_b128 v[76:79], v14 offset:60416
    s_waitcnt vmcnt(3)
    s_waitcnt lgkmcnt(7)
    v_mfma_f32_16x16x32_bf16 v[96:99], v[80:83], a[200:203], v[96:99]
    ds_read_b128 v[80:83], v14 offset:61440
    s_waitcnt lgkmcnt(7)
    v_mfma_f32_16x16x32_bf16 v[100:103], v[84:87], a[200:203], v[100:103]
    ds_read_b128 v[84:87], v14 offset:62464
    s_waitcnt lgkmcnt(7)
    v_mfma_f32_16x16x32_bf16 v[104:107], v[88:91], a[200:203], v[104:107]
    ds_read_b128 v[88:91], v14 offset:63488
    s_waitcnt lgkmcnt(7)
    v_mfma_f32_16x16x32_bf16 v[108:111], v[92:95], a[200:203], v[108:111]
    ds_read_b128 v[92:95], v14 offset:64512
    s_waitcnt vmcnt(2)
    s_waitcnt lgkmcnt(7)
    v_mfma_f32_16x16x32_bf16 v[96:99], v[64:67], a[204:207], v[96:99]
    s_waitcnt lgkmcnt(6)
    v_mfma_f32_16x16x32_bf16 v[100:103], v[68:71], a[204:207], v[100:103]
    s_waitcnt lgkmcnt(5)
    v_mfma_f32_16x16x32_bf16 v[104:107], v[72:75], a[204:207], v[104:107]
    s_waitcnt lgkmcnt(4)
    v_mfma_f32_16x16x32_bf16 v[108:111], v[76:79], a[204:207], v[108:111]
    s_waitcnt vmcnt(1)
    s_waitcnt lgkmcnt(3)
    v_mfma_f32_16x16x32_bf16 v[96:99], v[80:83], a[208:211], v[96:99]
    s_waitcnt lgkmcnt(2)
    v_mfma_f32_16x16x32_bf16 v[100:103], v[84:87], a[208:211], v[100:103]
    s_waitcnt lgkmcnt(1)
    v_mfma_f32_16x16x32_bf16 v[104:107], v[88:91], a[208:211], v[104:107]
    s_waitcnt lgkmcnt(0)
    v_mfma_f32_16x16x32_bf16 v[108:111], v[92:95], a[208:211], v[108:111]
    s_waitcnt vmcnt(0)
    v_add_f32 v216, v216, v218
    v_add_f32 v217, v217, v219
    v_mov_b32 v218, v216
    v_mov_b32 v219, v217
    s_nop 0
    v_permlane32_swap_b32 v216, v218
    v_permlane32_swap_b32 v217, v219
    v_add_f32 v216, v216, v218
    v_add_f32 v217, v217, v219
    v_mov_b32 v218, v216
    v_mov_b32 v219, v217
    s_nop 0
    v_permlane16_swap_b32 v216, v218
    v_permlane16_swap_b32 v217, v219
    v_add_f32 v216, v216, v218
    v_add_f32 v217, v217, v219
    v_mul_f32 v216, 0xbb000000, v216
    v_mul_f32 v217, 0x3b000000, v217
    v_fma_f32 v217, -v216, v216, v217
    v_max_f32 v217, 0, v217
    v_add_f32 v217, 0x3727c5ac, v217
    v_rsq_f32 v217, v217
    s_nop 0
    s_branch L_q2_78
L_kv2_77:
    s_setprio 3
    s_add_u32 s48, s57, 24576
    s_mov_b32 s43, 0
    s_mov_b64 exec, 0xff
L_poll_83:
    buffer_load_dwordx2 v[48:49], v15, s[8:11], s48 offen sc1
L_pchk_85:
    s_add_u32 s43, s43, 1
    s_waitcnt vmcnt(0)
    v_cmp_ne_u64 vcc, s[64:65], v[48:49]
    s_cmp_ge_u32 s43, 100000
    s_cbranch_scc1 L_polled_84
    s_nop 1
    s_cbranch_vccnz L_poll_83
L_polled_84:
    s_mov_b64 exec, -1
    s_cmp_eq_u32 s56, 0
    s_cbranch_scc1 L_noacq_86
    buffer_inv sc1
    s_waitcnt vmcnt(0)
L_noacq_86:
    s_add_u32 s48, s38, 14221312
    buffer_load_dwordx4 v[216:219], v2, s[8:11], s48 offen sc1
    s_add_u32 s48, s39, 6291456
    buffer_load_dwordx4 v[16:19], v2, s[8:11], s48 offen offset:0 sc1
    buffer_load_dwordx4 v[20:23], v2, s[8:11], s48 offen offset:1024 sc1
    buffer_load_dwordx4 v[24:27], v2, s[8:11], s48 offen offset:2048 sc1
    buffer_load_dwordx4 v[28:31], v2, s[8:11], s48 offen offset:3072 sc1
    s_add_u32 s48, s39, 6295552
    buffer_load_dwordx4 v[32:35], v2, s[8:11], s48 offen offset:0 sc1
    buffer_load_dwordx4 v[36:39], v2, s[8:11], s48 offen offset:1024 sc1
    buffer_load_dwordx4 v[40:43], v2, s[8:11], s48 offen offset:2048 sc1
    buffer_load_dwordx4 v[44:47], v2, s[8:11], s48 offen offset:3072 sc1
    s_add_u32 s48, s39, 6299648
    buffer_load_dwordx4 v[52:55], v2, s[8:11], s48 offen offset:0 sc1
    buffer_load_dwordx4 v[56:59], v2, s[8:11], s48 offen offset:1024 sc1
    buffer_load_dwordx4 v[60:63], v2, s[8:11], s48 offen offset:2048 sc1
    buffer_load_dwordx4 a[192:195], v2, s[8:11], s48 offen offset:3072 sc1
    s_add_u32 s48, s39, 6303744
    buffer_load_dwordx4 a[196:199], v2, s[8:11], s48 offen offset:0 sc1
    buffer_load_dwordx4 a[200:203], v2, s[8:11], s48 offen offset:1024 sc1
    buffer_load_dwordx4 a[204:207], v2, s[8:11], s48 offen offset:2048 sc1
    buffer_load_dwordx4 a[208:211], v2, s[8:11], s48 offen offset:3072 sc1
    s_waitcnt vmcnt(16)
    v_add_f32 v216, v216, v218
    v_add_f32 v217, v217, v219
    v_mov_b32 v218, v216
    v_mov_b32 v219, v217
    s_nop 0
    v_permlane32_swap_b32 v216, v218
    v_permlane32_swap_b32 v217, v219
    v_add_f32 v216, v216, v218
    v_add_f32 v217, v217, v219
    v_mov_b32 v218, v216
    v_mov_b32 v219, v217
    s_nop 0
    v_permlane16_swap_b32 v216, v218
    v_permlane16_swap_b32 v217, v219
    v_add_f32 v216, v216, v218
    v_add_f32 v217, v217, v219
    v_mul_f32 v216, 0xbb000000, v216
    v_mul_f32 v217, 0x3b000000, v217
    v_fma_f32 v217, -v216, v216, v217
    v_max_f32 v217, 0, v217
    v_add_f32 v217, 0x3727c5ac, v217
    v_rsq_f32 v217, v217
    s_nop 0
    s_waitcnt lgkmcnt(0)
    s_cmp_eq_u32 s60, 2
    s_cbranch_scc1 L_isv_87
    v_mul_f32 v221, 0x3eb8aa3b, v217
    v_mov_b32 v220, v216
    v_mov_b32 v222, v216
    v_mov_b32 v224, v216
    v_mov_b32 v226, v216
    v_mov_b32 v223, v221
    v_mov_b32 v225, v221
    v_mov_b32 v227, v221
    s_branch L_kvd_88
L_isv_87:
    ds_write_b64 v4, v[216:217]
    s_waitcnt lgkmcnt(0)
    ds_read_b128 v[220:223], v5
    ds_read_b128 v[224:227], v5 offset:16
L_kvd_88:
    s_cmp_eq_u32 s60, 2
    s_cbranch_scc1 L_isv_89
    s_waitcnt vmcnt(15)
    v_mfma_f32_16x16x32_bf16 v[208:211], v[120:123], v[16:19], 0
    s_waitcnt vmcnt(14)
    v_mfma_f32_16x16x32_bf16 v[208:211], v[124:127], v[20:23], v[208:211]
    s_waitcnt vmcnt(13)
    v_mfma_f32_16x16x32_bf16 v[208:211], v[128:131], v[24:27], v[208:211]
    s_waitcnt vmcnt(12)
    v_mfma_f32_16x16x32_bf16 v[208:211], v[132:135], v[28:31], v[208:211]
    s_waitcnt vmcnt(11)
    v_mfma_f32_16x16x32_bf16 v[208:211], v[136:139], v[32:35], v[208:211]
    s_waitcnt vmcnt(10)
    v_mfma_f32_16x16x32_bf16 v[208:211], v[140:143], v[36:39], v[208:211]
    s_waitcnt vmcnt(9)
    v_mfma_f32_16x16x32_bf16 v[208:211], v[144:147], v[40:43], v[208:211]
    s_waitcnt vmcnt(8)
    v_mfma_f32_16x16x32_bf16 v[208:211], v[148:151], v[44:47], v[208:211]
    s_waitcnt vmcnt(7)
    v_mfma_f32_16x16x32_bf16 v[208:211], v[152:155], v[52:55], v[208:211]
    s_waitcnt vmcnt(6)
    v_mfma_f32_16x16x32_bf16 v[208:211], v[156:159], v[56:59], v[208:211]
    s_waitcnt vmcnt(5)
    v_mfma_f32_16x16x32_bf16 v[208:211], v[160:163], v[60:63], v[208:211]
    s_waitcnt vmcnt(4)
    v_mfma_f32_16x16x32_bf16 v[208:211], v[164:167], a[192:195], v[208:211]
    s_waitcnt vmcnt(3)
    v_mfma_f32_16x16x32_bf16 v[208:211], v[168:171], a[196:199], v[208:211]
    s_waitcnt vmcnt(2)
    v_mfma_f32_16x16x32_bf16 v[208:211], v[172:175], a[200:203], v[208:211]
    s_waitcnt vmcnt(1)
    v_mfma_f32_16x16x32_bf16 v[208:211], v[176:179], a[204:207], v[208:211]
    s_waitcnt vmcnt(0)
    v_mfma_f32_16x16x32_bf16 v[208:211], v[180:183], a[208:211], v[208:211]
    s_branch L_kvd_90
L_isv_89:
    s_waitcnt vmcnt(15)
    v_mfma_f32_16x16x32_bf16 v[208:211], v[16:19], v[120:123], 0
    s_waitcnt vmcnt(14)
    v_mfma_f32_16x16x32_bf16 v[208:211], v[20:23], v[124:127], v[208:211]
    s_waitcnt vmcnt(13)
    v_mfma_f32_16x16x32_bf16 v[208:211], v[24:27], v[128:131], v[208:211]
    s_waitcnt vmcnt(12)
    v_mfma_f32_16x16x32_bf16 v[208:211], v[28:31], v[132:135], v[208:211]
    s_waitcnt vmcnt(11)
    v_mfma_f32_16x16x32_bf16 v[208:211], v[32:35], v[136:139], v[208:211]
    s_waitcnt vmcnt(10)
    v_mfma_f32_16x16x32_bf16 v[208:211], v[36:39], v[140:143], v[208:211]
    s_waitcnt vmcnt(9)
    v_mfma_f32_16x16x32_bf16 v[208:211], v[40:43], v[144:147], v[208:211]
    s_waitcnt vmcnt(8)
    v_mfma_f32_16x16x32_bf16 v[208:211], v[44:47], v[148:151], v[208:211]
    s_waitcnt vmcnt(7)
    v_mfma_f32_16x16x32_bf16 v[208:211], v[52:55], v[152:155], v[208:211]
    s_waitcnt vmcnt(6)
    v_mfma_f32_16x16x32_bf16 v[208:211], v[56:59], v[156:159], v[208:211]
    s_waitcnt vmcnt(5)
    v_mfma_f32_16x16x32_bf16 v[208:211], v[60:63], v[160:163], v[208:211]
    s_waitcnt vmcnt(4)
    v_mfma_f32_16x16x32_bf16 v[208:211], a[192:195], v[164:167], v[208:211]
    s_waitcnt vmcnt(3)
    v_mfma_f32_16x16x32_bf16 v[208:211], a[196:199], v[168:171], v[208:211]
    s_waitcnt vmcnt(2)
    v_mfma_f32_16x16x32_bf16 v[208:211], a[200:203], v[172:175], v[208:211]
    s_waitcnt vmcnt(1)
    v_mfma_f32_16x16x32_bf16 v[208:211], a[204:207], v[176:179], v[208:211]
    s_waitcnt vmcnt(0)
    v_mfma_f32_16x16x32_bf16 v[208:211], a[208:211], v[180:183], v[208:211]
L_kvd_90:
    s_nop 6
    s_waitcnt lgkmcnt(0)
    v_fmac_f32 v208, v220, v200
    v_fmac_f32 v209, v222, v201
    v_fmac_f32 v210, v224, v202
    v_fmac_f32 v211, v226, v203
    v_mul_f32 v208, v221, v208
    v_mul_f32 v209, v223, v209
    v_mul_f32 v210, v225, v210
    v_mul_f32 v211, v227, v211
    v_cvt_pk_bf16_f32 v212, v208, v209
    v_cvt_pk_bf16_f32 v213, v210, v211
    buffer_store_dwordx2 v[212:213], v9, s[8:11], s61 offen sc1
    ds_read_b128 v[64:67], v14 offset:0
    ds_read_b128 v[68:71], v14 offset:1024
    ds_read_b128 v[72:75], v14 offset:2048
    ds_read_b128 v[76:79], v14 offset:3072
    ds_read_b128 v[80:83], v14 offset:4096
    ds_read_b128 v[84:87], v14 offset:5120
    ds_read_b128 v[88:91], v14 offset:6144
    ds_read_b128 v[92:95], v14 offset:7168
    s_waitcnt lgkmcnt(7)
    v_mfma_f32_16x16x32_bf16 v[96:99], v[64:67], v[16:19], 0
    ds_read_b128 v[64:67], v14 offset:8192
    s_waitcnt lgkmcnt(7)
    v_mfma_f32_16x16x32_bf16 v[100:103], v[68:71], v[16:19], 0
    ds_read_b128 v[68:71], v14 offset:9216
    s_waitcnt lgkmcnt(7)
    v_mfma_f32_16x16x32_bf16 v[104:107], v[72:75], v[16:19], 0
    ds_read_b128 v[72:75], v14 offset:10240
    s_waitcnt lgkmcnt(7)
    v_mfma_f32_16x16x32_bf16 v[108:111], v[76:79], v[16:19], 0
    ds_read_b128 v[76:79], v14 offset:11264
    s_waitcnt lgkmcnt(7)
    v_mfma_f32_16x16x32_bf16 v[96:99], v[80:83], v[20:23], v[96:99]
    ds_read_b128 v[80:83], v14 offset:12288
    s_waitcnt lgkmcnt(7)
    v_mfma_f32_16x16x32_bf16 v[100:103], v[84:87], v[20:23], v[100:103]
    ds_read_b128 v[84:87], v14 offset:13312
    s_waitcnt lgkmcnt(7)
    v_mfma_f32_16x16x32_bf16 v[104:107], v[88:91], v[20:23], v[104:107]
    ds_read_b128 v[88:91], v14 offset:14336
    s_waitcnt lgkmcnt(7)
    v_mfma_f32_16x16x32_bf16 v[108:111], v[92:95], v[20:23], v[108:111]
    ds_read_b128 v[92:95], v14 offset:15360
    s_waitcnt lgkmcnt(7)
    v_mfma_f32_16x16x32_bf16 v[96:99], v[64:67], v[24:27], v[96:99]
    ds_read_b128 v[64:67], v14 offset:16384
    s_waitcnt lgkmcnt(7)
    v_mfma_f32_16x16x32_bf16 v[100:103], v[68:71], v[24:27], v[100:103]
    ds_read_b128 v[68:71], v14 offset:17408
    s_waitcnt lgkmcnt(7)
    v_mfma_f32_16x16x32_bf16 v[104:107], v[72:75], v[24:27], v[104:107]
    ds_read_b128 v[72:75], v14 offset:18432
    s_waitcnt lgkmcnt(7)
    v_mfma_f32_16x16x32_bf16 v[108:111], v[76:79], v[24:27], v[108:111]
    ds_read_b128 v[76:79], v14 offset:19456
    s_waitcnt lgkmcnt(7)
    v_mfma_f32_16x16x32_bf16 v[96:99], v[80:83], v[28:31], v[96:99]
    ds_read_b128 v[80:83], v14 offset:20480
    s_waitcnt lgkmcnt(7)
    v_mfma_f32_16x16x32_bf16 v[100:103], v[84:87], v[28:31], v[100:103]
    ds_read_b128 v[84:87], v14 offset:21504
    s_waitcnt lgkmcnt(7)
    v_mfma_f32_16x16x32_bf16 v[104:107], v[88:91], v[28:31], v[104:107]
    ds_read_b128 v[88:91], v14 offset:22528
    s_waitcnt lgkmcnt(7)
    v_mfma_f32_16x16x32_bf16 v[108:111], v[92:95], v[28:31], v[108:111]
    ds_read_b128 v[92:95], v14 offset:23552
    s_waitcnt lgkmcnt(7)
    v_mfma_f32_16x16x32_bf16 v[96:99], v[64:67], v[32:35], v[96:99]
    ds_read_b128 v[64:67], v14 offset:24576
    s_waitcnt lgkmcnt(7)
    v_mfma_f32_16x16x32_bf16 v[100:103], v[68:71], v[32:35], v[100:103]
    ds_read_b128 v[68:71], v14 offset:25600
    s_waitcnt lgkmcnt(7)
    v_mfma_f32_16x16x32_bf16 v[104:107], v[72:75], v[32:35], v[104:107]
    ds_read_b128 v[72:75], v14 offset:26624
    s_waitcnt lgkmcnt(7)
    v_mfma_f32_16x16x32_bf16 v[108:111], v[76:79], v[32:35], v[108:111]
    ds_read_b128 v[76:79], v14 offset:27648
    s_waitcnt lgkmcnt(7)
    v_mfma_f32_16x16x32_bf16 v[96:99], v[80:83], v[36:39], v[96:99]
    ds_read_b128 v[80:83], v14 offset:28672
    s_waitcnt lgkmcnt(7)
    v_mfma_f32_16x16x32_bf16 v[100:103], v[84:87], v[36:39], v[100:103]
    ds_read_b128 v[84:87], v14 offset:29696
    s_waitcnt lgkmcnt(7)
    v_mfma_f32_16x16x32_bf16 v[104:107], v[88:91], v[36:39], v[104:107]
    ds_read_b128 v[88:91], v14 offset:30720
    s_waitcnt lgkmcnt(7)
    v_mfma_f32_16x16x32_bf16 v[108:111], v[92:95], v[36:39], v[108:111]
    ds_read_b128 v[92:95], v14 offset:31744
    s_waitcnt lgkmcnt(7)
    v_mfma_f32_16x16x32_bf16 v[96:99], v[64:67], v[40:43], v[96:99]
    ds_read_b128 v[64:67], v14 offset:32768
    s_waitcnt lgkmcnt(7)
    v_mfma_f32_16x16x32_bf16 v[100:103], v[68:71], v[40:43], v[100:103]
    ds_read_b128 v[68:71], v14 offset:33792
    s_lshl_b32 s42, s4, 7
    s_add_u32 s42, s42, 14450688
    s_waitcnt vmcnt(0)
    s_mov_b64 exec, 1
    buffer_store_dwordx2 v[12:13], v6, s[8:11], s42 offen sc1
    s_mov_b64 exec, -1
    s_waitcnt lgkmcnt(7)
    v_mfma_f32_16x16x32_bf16 v[104:107], v[72:75], v[40:43], v[104:107]
    ds_read_b128 v[72:75], v14 offset:34816
    s_waitcnt lgkmcnt(7)
    v_mfma_f32_16x16x32_bf16 v[108:111], v[76:79], v[40:43], v[108:111]
    ds_read_b128 v[76:79], v14 offset:35840
    s_waitcnt lgkmcnt(7)
    v_mfma_f32_16x16x32_bf16 v[96:99], v[80:83], v[44:47], v[96:99]
    ds_read_b128 v[80:83], v14 offset:36864
    s_waitcnt lgkmcnt(7)
    v_mfma_f32_16x16x32_bf16 v[100:103], v[84:87], v[44:47], v[100:103]
    ds_read_b128 v[84:87], v14 offset:37888
    s_waitcnt lgkmcnt(7)
    v_mfma_f32_16x16x32_bf16 v[104:107], v[88:91], v[44:47], v[104:107]
    ds_read_b128 v[88:91], v14 offset:38912
    s_waitcnt lgkmcnt(7)
    v_mfma_f32_16x16x32_bf16 v[108:111], v[92:95], v[44:47], v[108:111]
    ds_read_b128 v[92:95], v14 offset:39936
    s_waitcnt lgkmcnt(7)
    v_mfma_f32_16x16x32_bf16 v[96:99], v[64:67], v[52:55], v[96:99]
    ds_read_b128 v[64:67], v14 offset:40960
    s_waitcnt lgkmcnt(7)
    v_mfma_f32_16x16x32_bf16 v[100:103], v[68:71], v[52:55], v[100:103]
    ds_read_b128 v[68:71], v14 offset:41984
    s_waitcnt lgkmcnt(7)
    v_mfma_f32_16x16x32_bf16 v[104:107], v[72:75], v[52:55], v[104:107]
    ds_read_b128 v[72:75], v14 offset:43008
    s_waitcnt lgkmcnt(7)
    v_mfma_f32_16x16x32_bf16 v[108:111], v[76:79], v[52:55], v[108:111]
    ds_read_b128 v[76:79], v14 offset:44032
    s_waitcnt lgkmcnt(7)
    v_mfma_f32_16x16x32_bf16 v[96:99], v[80:83], v[56:59], v[96:99]
    ds_read_b128 v[80:83], v14 offset:45056
    s_waitcnt lgkmcnt(7)
    v_mfma_f32_16x16x32_bf16 v[100:103], v[84:87], v[56:59], v[100:103]
    ds_read_b128 v[84:87], v14 offset:46080
    s_waitcnt lgkmcnt(7)
    v_mfma_f32_16x16x32_bf16 v[104:107], v[88:91], v[56:59], v[104:107]
    ds_read_b128 v[88:91], v14 offset:47104
    s_waitcnt lgkmcnt(7)
    v_mfma_f32_16x16x32_bf16 v[108:111], v[92:95], v[56:59], v[108:111]
    ds_read_b128 v[92:95], v14 offset:48128
    s_waitcnt lgkmcnt(7)
    v_mfma_f32_16x16x32_bf16 v[96:99], v[64:67], v[60:63], v[96:99]
    ds_read_b128 v[64:67], v14 offset:49152
    s_waitcnt lgkmcnt(7)
    v_mfma_f32_16x16x32_bf16 v[100:103], v[68:71], v[60:63], v[100:103]
    ds_read_b128 v[68:71], v14 offset:50176
    s_waitcnt lgkmcnt(7)
    v_mfma_f32_16x16x32_bf16 v[104:107], v[72:75], v[60:63], v[104:107]
    ds_read_b128 v[72:75], v14 offset:51200
    s_waitcnt lgkmcnt(7)
    v_mfma_f32_16x16x32_bf16 v[108:111], v[76:79], v[60:63], v[108:111]
    ds_read_b128 v[76:79], v14 offset:52224
    s_waitcnt lgkmcnt(7)
    v_mfma_f32_16x16x32_bf16 v[96:99], v[80:83], a[192:195], v[96:99]
    ds_read_b128 v[80:83], v14 offset:53248
    s_waitcnt lgkmcnt(7)
    v_mfma_f32_16x16x32_bf16 v[100:103], v[84:87], a[192:195], v[100:103]
    ds_read_b128 v[84:87], v14 offset:54272
    s_waitcnt lgkmcnt(7)
    v_mfma_f32_16x16x32_bf16 v[104:107], v[88:91], a[192:195], v[104:107]
    ds_read_b128 v[88:91], v14 offset:55296
    s_waitcnt lgkmcnt(7)
    v_mfma_f32_16x16x32_bf16 v[108:111], v[92:95], a[192:195], v[108:111]
    ds_read_b128 v[92:95], v14 offset:56320
    s_waitcnt lgkmcnt(7)
    v_mfma_f32_16x16x32_bf16 v[96:99], v[64:67], a[196:199], v[96:99]
    ds_read_b128 v[64:67], v14 offset:57344
    s_waitcnt lgkmcnt(7)
    v_mfma_f32_16x16x32_bf16 v[100:103], v[68:71], a[196:199], v[100:103]
    ds_read_b128 v[68:71], v14 offset:58368
    s_waitcnt lgkmcnt(7)
    v_mfma_f32_16x16x32_bf16 v[104:107], v[72:75], a[196:199], v[104:107]
    ds_read_b128 v[72:75], v14 offset:59392
    s_waitcnt lgkmcnt(7)
    v_mfma_f32_16x16x32_bf16 v[108:111], v[76:79], a[196:199], v[108:111]
    ds_read_b128 v[76:79], v14 offset:60416
    s_waitcnt lgkmcnt(7)
    v_mfma_f32_16x16x32_bf16 v[96:99], v[80:83], a[200:203], v[96:99]
    ds_read_b128 v[80:83], v14 offset:61440
    s_waitcnt lgkmcnt(7)
    v_mfma_f32_16x16x32_bf16 v[100:103], v[84:87], a[200:203], v[100:103]
    ds_read_b128 v[84:87], v14 offset:62464
    s_waitcnt lgkmcnt(7)
    v_mfma_f32_16x16x32_bf16 v[104:107], v[88:91], a[200:203], v[104:107]
    ds_read_b128 v[88:91], v14 offset:63488
    s_waitcnt lgkmcnt(7)
    v_mfma_f32_16x16x32_bf16 v[108:111], v[92:95], a[200:203], v[108:111]
    ds_read_b128 v[92:95], v14 offset:64512
    s_waitcnt lgkmcnt(7)
    v_mfma_f32_16x16x32_bf16 v[96:99], v[64:67], a[204:207], v[96:99]
    s_waitcnt lgkmcnt(6)
    v_mfma_f32_16x16x32_bf16 v[100:103], v[68:71], a[204:207], v[100:103]
    s_waitcnt lgkmcnt(5)
    v_mfma_f32_16x16x32_bf16 v[104:107], v[72:75], a[204:207], v[104:107]
    s_waitcnt lgkmcnt(4)
    v_mfma_f32_16x16x32_bf16 v[108:111], v[76:79], a[204:207], v[108:111]
    s_waitcnt lgkmcnt(3)
    v_mfma_f32_16x16x32_bf16 v[96:99], v[80:83], a[208:211], v[96:99]
    s_waitcnt lgkmcnt(2)
    v_mfma_f32_16x16x32_bf16 v[100:103], v[84:87], a[208:211], v[100:103]
    s_waitcnt lgkmcnt(1)
    v_mfma_f32_16x16x32_bf16 v[104:107], v[88:91], a[208:211], v[104:107]
    s_waitcnt lgkmcnt(0)
    v_mfma_f32_16x16x32_bf16 v[108:111], v[92:95], a[208:211], v[108:111]
    s_setprio 0
L_q2_78:
    v_lshrrev_b32 v0, 4, v1
    v_lshlrev_b32 v0, 11, v0
    v_and_b32 v9, 15, v1
    v_lshl_add_u32 v0, v9, 4, v0
    s_lshr_b32 s42, s3, 1
    s_lshl_b32 s48, s42, 10
    s_and_b32 s42, s3, 1
    s_lshl_b32 s42, s42, 8
    s_add_u32 s48, s48, s42
    s_add_u32 s48, s48, 135168
    v_add_u32 v9, s48, v0
    v_mov_b32 v218, v217
    v_pk_fma_f32 v[96:97], v[184:185], v[216:217], v[96:97] op_sel_hi:[1,0,1]
    v_pk_fma_f32 v[98:99], v[186:187], v[216:217], v[98:99] op_sel_hi:[1,0,1]
    v_pk_fma_f32 v[100:101], v[188:189], v[216:217], v[100:101] op_sel_hi:[1,0,1]
    v_pk_fma_f32 v[102:103], v[190:191], v[216:217], v[102:103] op_sel_hi:[1,0,1]
    v_pk_fma_f32 v[104:105], v[192:193], v[216:217], v[104:105] op_sel_hi:[1,0,1]
    v_pk_fma_f32 v[106:107], v[194:195], v[216:217], v[106:107] op_sel_hi:[1,0,1]
    v_pk_fma_f32 v[108:109], v[196:197], v[216:217], v[108:109] op_sel_hi:[1,0,1]
    v_pk_fma_f32 v[110:111], v[198:199], v[216:217], v[110:111] op_sel_hi:[1,0,1]
    v_pk_mul_f32 v[96:97], v[96:97], v[218:219] op_sel_hi:[1,0]
    v_pk_mul_f32 v[98:99], v[98:99], v[218:219] op_sel_hi:[1,0]
    v_pk_mul_f32 v[100:101], v[100:101], v[218:219] op_sel_hi:[1,0]
    v_pk_mul_f32 v[102:103], v[102:103], v[218:219] op_sel_hi:[1,0]
    v_pk_mul_f32 v[104:105], v[104:105], v[218:219] op_sel_hi:[1,0]
    v_pk_mul_f32 v[106:107], v[106:107], v[218:219] op_sel_hi:[1,0]
    v_pk_mul_f32 v[108:109], v[108:109], v[218:219] op_sel_hi:[1,0]
    v_pk_mul_f32 v[110:111], v[110:111], v[218:219] op_sel_hi:[1,0]
    v_cvt_pk_bf16_f32 v232, v96, v97
    v_cvt_pk_bf16_f32 v233, v98, v99
    v_cvt_pk_bf16_f32 v234, v100, v101
    v_cvt_pk_bf16_f32 v235, v102, v103
    v_cvt_pk_bf16_f32 v236, v104, v105
    v_cvt_pk_bf16_f32 v237, v106, v107
    v_cvt_pk_bf16_f32 v238, v108, v109
    v_cvt_pk_bf16_f32 v239, v110, v111
    ds_write_b128 v9, v[232:235] offset:0
    ds_write_b128 v9, v[236:239] offset:512
    s_mov_b32 s7, 1
    s_mov_b32 s14, 0
    v_mov_b32 v64, 159744
    ds_write_b32 v64, v6 offset:0
    v_mov_b32 v5, 0xdddddddd
    s_lshl_b32 s48, s3, 14
    v_add_u32 v3, s48, v2
    s_lshl_b32 s48, s3, 10
    s_add_u32 s48, s48, 65536
    v_lshlrev_b32 v11, 2, v1
    v_add_u32 v11, s48, v11
    s_lshr_b32 s40, s3, 1
    s_lshl_b32 s42, s40, 11
    s_lshl_b32 s40, s40, 7
    s_and_b32 s48, s3, 1
    s_lshl_b32 s43, s48, 8
    s_add_u32 s42, s42, s43
    s_lshl_b32 s48, s48, 6
    s_add_u32 s40, s40, s48
    s_add_u32 s40, s40, 65536
    v_lshrrev_b32 v65, 4, v1
    v_lshlrev_b32 v4, 12, v65
    v_and_b32 v65, 15, v1
    v_lshl_add_u32 v4, v65, 4, v4
    v_add_u32 v4, s42, v4
    s_lshl_b32 s53, s7, 15
    s_lshl_b32 s48, s5, 8
    s_add_u32 s53, s53, s48
    s_add_u32 s53, s53, 4128768
    s_lshl_b32 s57, s3, 6
    s_add_u32 s57, s57, s53
    s_lshl_b32 s48, s6, 3
    s_add_u32 s70, s57, s48
    s_lshl_b32 s59, s6, 2
    s_add_u32 s59, s59, s3
    s_lshl_b32 s59, s59, 3
    s_add_u32 s59, s59, s53
    s_mul_i32 s46, s7, 10092544
    s_add_u32 s46, s46, 3932160
    s_mul_i32 s47, s3, 17408
    s_add_u32 s47, s47, s46
    s_add_u32 s47, s47, 65536
    s_lshl_b32 s48, s3, 14
    s_add_u32 s46, s46, s48
    v_and_b32 v64, 31, v1
    v_lshrrev_b32 v65, 5, v1
    v_mul_u32_u24 v10, 272, v65
    v_lshl_add_u32 v10, v64, 4, v10
    v_cmp_lt_u32 vcc, 16, v64
    v_mov_b32 v65, 0x7f000000
    v_lshlrev_b32 v0, 7, v1
    s_lshl_b32 s48, s3, 13
    v_cndmask_b32 v10, v10, v65, vcc
    s_lshl_b32 s42, s7, 15
    s_add_u32 s48, s48, s42
    s_add_u32 s48, s48, 14417920
    s_mov_b32 s43, 0
L_poll_91:
    buffer_load_dwordx2 v[48:49], v0, s[8:11], s48 offen sc1
L_pchk_93:
    s_add_u32 s43, s43, 1
    s_waitcnt vmcnt(0)
    v_cmp_ne_u64 vcc, s[64:65], v[48:49]
    s_cmp_ge_u32 s43, 100000
    s_cbranch_scc1 L_polled_92
    s_nop 1
    s_cbranch_vccz L_polled_92
    s_mov_b64 exec, vcc
    s_sleep 2
    s_branch L_poll_91
L_polled_92:
    s_mov_b64 exec, -1
    s_add_u32 s60, s46, 0
    buffer_load_dwordx4 a[0:3], v2, s[8:11], s60 offen offset:0 sc1
    s_add_u32 s61, s47, 0
    buffer_load_dwordx4 a[64:67], v10, s[8:11], s61 offen offset:0 sc1
    buffer_load_dwordx4 a[68:71], v10, s[8:11], s61 offen offset:544 sc1
    buffer_load_dwordx4 a[4:7], v2, s[8:11], s60 offen offset:1024 sc1
    buffer_load_dwordx4 a[72:75], v10, s[8:11], s61 offen offset:1088 sc1
    buffer_load_dwordx4 a[76:79], v10, s[8:11], s61 offen offset:1632 sc1
    buffer_load_dwordx4 a[8:11], v2, s[8:11], s60 offen offset:2048 sc1
    buffer_load_dwordx4 a[80:83], v10, s[8:11], s61 offen offset:2176 sc1
    buffer_load_dwordx4 a[84:87], v10, s[8:11], s61 offen offset:2720 sc1
    buffer_load_dwordx4 a[12:15], v2, s[8:11], s60 offen offset:3072 sc1
    s_add_u32 s61, s47, 3264
    buffer_load_dwordx4 a[88:91], v10, s[8:11], s61 offen offset:0 sc1
    buffer_load_dwordx4 a[92:95], v10, s[8:11], s61 offen offset:544 sc1
    s_branch L_top_2
L_last_72:
    s_mov_b32 s12, s34
    s_and_b32 s13, s35, 0xffff
    s_mov_b32 s14, 2097152
    s_mov_b32 s15, 0x20000
    v_and_b32 v9, 15, v1
    v_lshlrev_b32 v9, 10, v9
    v_lshrrev_b32 v0, 4, v1
    v_lshl_add_u32 v9, v0, 5, v9
    s_lshl_b32 s48, s6, 7
    s_add_u32 s48, s48, s39
    buffer_store_dwordx4 v[112:115], v9, s[12:15], s48 offen offset:0
    buffer_store_dwordx4 v[116:119], v9, s[12:15], s48 offen offset:16
L_end_1:
    s_endpgm
L_slow_51:
    s_waitcnt vmcnt(0)
    s_add_u32 s60, s46, 0
    buffer_load_dwordx4 a[0:3], v2, s[8:11], s60 offen offset:0 sc1
    s_add_u32 s61, s47, 0
    buffer_load_dwordx4 a[64:67], v10, s[8:11], s61 offen offset:0 sc1
    buffer_load_dwordx4 a[68:71], v10, s[8:11], s61 offen offset:544 sc1
    buffer_load_dwordx4 a[4:7], v2, s[8:11], s60 offen offset:1024 sc1
    buffer_load_dwordx4 a[72:75], v10, s[8:11], s61 offen offset:1088 sc1
    buffer_load_dwordx4 a[76:79], v10, s[8:11], s61 offen offset:1632 sc1
    buffer_load_dwordx4 a[8:11], v2, s[8:11], s60 offen offset:2048 sc1
    buffer_load_dwordx4 a[80:83], v10, s[8:11], s61 offen offset:2176 sc1
    buffer_load_dwordx4 a[84:87], v10, s[8:11], s61 offen offset:2720 sc1
    buffer_load_dwordx4 a[12:15], v2, s[8:11], s60 offen offset:3072 sc1
    s_add_u32 s61, s47, 3264
    buffer_load_dwordx4 a[88:91], v10, s[8:11], s61 offen offset:0 sc1
    buffer_load_dwordx4 a[92:95], v10, s[8:11], s61 offen offset:544 sc1
    s_add_u32 s60, s46, 4096
    buffer_load_dwordx4 a[16:19], v2, s[8:11], s60 offen offset:0 sc1
    buffer_load_dwordx4 a[96:99], v10, s[8:11], s61 offen offset:1088 sc1
    buffer_load_dwordx4 a[100:103], v10, s[8:11], s61 offen offset:1632 sc1
    buffer_load_dwordx4 a[20:23], v2, s[8:11], s60 offen offset:1024 sc1
    buffer_load_dwordx4 a[104:107], v10, s[8:11], s61 offen offset:2176 sc1
    buffer_load_dwordx4 a[108:111], v10, s[8:11], s61 offen offset:2720 sc1
    buffer_load_dwordx4 a[24:27], v2, s[8:11], s60 offen offset:2048 sc1
    s_add_u32 s61, s47, 6528
    buffer_load_dwordx4 a[112:115], v10, s[8:11], s61 offen offset:0 sc1
    buffer_load_dwordx4 a[116:119], v10, s[8:11], s61 offen offset:544 sc1
    buffer_load_dwordx4 a[28:31], v2, s[8:11], s60 offen offset:3072 sc1
    buffer_load_dwordx4 a[120:123], v10, s[8:11], s61 offen offset:1088 sc1
    buffer_load_dwordx4 a[124:127], v10, s[8:11], s61 offen offset:1632 sc1
    s_add_u32 s60, s46, 8192
    buffer_load_dwordx4 a[32:35], v2, s[8:11], s60 offen offset:0 sc1
    buffer_load_dwordx4 a[128:131], v10, s[8:11], s61 offen offset:2176 sc1
    buffer_load_dwordx4 a[132:135], v10, s[8:11], s61 offen offset:2720 sc1
    buffer_load_dwordx4 a[36:39], v2, s[8:11], s60 offen offset:1024 sc1
    s_add_u32 s61, s47, 9792
    buffer_load_dwordx4 a[136:139], v10, s[8:11], s61 offen offset:0 sc1
    buffer_load_dwordx4 a[140:143], v10, s[8:11], s61 offen offset:544 sc1
    buffer_load_dwordx4 a[40:43], v2, s[8:11], s60 offen offset:2048 sc1
    buffer_load_dwordx4 a[144:147], v10, s[8:11], s61 offen offset:1088 sc1
    buffer_load_dwordx4 a[148:151], v10, s[8:11], s61 offen offset:1632 sc1
    buffer_load_dwordx4 a[44:47], v2, s[8:11], s60 offen offset:3072 sc1
    buffer_load_dwordx4 a[152:155], v10, s[8:11], s61 offen offset:2176 sc1
    buffer_load_dwordx4 a[156:159], v10, s[8:11], s61 offen offset:2720 sc1
    s_add_u32 s60, s46, 12288
    buffer_load_dwordx4 a[48:51], v2, s[8:11], s60 offen offset:0 sc1
    s_add_u32 s61, s47, 13056
    buffer_load_dwordx4 a[160:163], v10, s[8:11], s61 offen offset:0 sc1
    buffer_load_dwordx4 a[164:167], v10, s[8:11], s61 offen offset:544 sc1
    buffer_load_dwordx4 a[52:55], v2, s[8:11], s60 offen offset:1024 sc1
    buffer_load_dwordx4 a[168:171], v10, s[8:11], s61 offen offset:1088 sc1
    buffer_load_dwordx4 a[172:175], v10, s[8:11], s61 offen offset:1632 sc1
    buffer_load_dwordx4 a[56:59], v2, s[8:11], s60 offen offset:2048 sc1
    buffer_load_dwordx4 a[176:179], v10, s[8:11], s61 offen offset:2176 sc1
    buffer_load_dwordx4 a[180:183], v10, s[8:11], s61 offen offset:2720 sc1
    buffer_load_dwordx4 a[60:63], v2, s[8:11], s60 offen offset:3072 sc1
    s_add_u32 s61, s47, 16320
    buffer_load_dwordx4 a[184:187], v10, s[8:11], s61 offen offset:0 sc1
    buffer_load_dwordx4 a[188:191], v10, s[8:11], s61 offen offset:544 sc1
    v_add_u32 v0, 135168, v2
    ds_read_b128 v[16:19], v0 offset:0
    ds_read_b128 v[20:23], v0 offset:1024
    ds_read_b128 v[24:27], v0 offset:2048
    ds_read_b128 v[28:31], v0 offset:3072
    ds_read_b128 v[32:35], v0 offset:4096
    ds_read_b128 v[36:39], v0 offset:5120
    ds_read_b128 v[40:43], v0 offset:6144
    ds_read_b128 v[44:47], v0 offset:7168
    v_lshlrev_b32 v8, 2, v1
    s_lshl_b32 s48, s3, 8
    s_add_u32 s48, s48, 161792
    v_add_u32 v8, s48, v8
    v_mov_b32 v48, 0xff800000
    ds_write_b32 v8, v48
    s_waitcnt vmcnt(0) lgkmcnt(0)
    s_barrier
    v_and_b32 v8, 31, v1
    v_lshlrev_b32 v8, 2, v8
    v_add_u32 v8, 161792, v8
    s_mov_b32 s42, 0
L_p1_94:
    v_mov_b32 v96, 0xff800000
    s_nop 1
    v_mfma_f32_32x32x16_bf16 v[48:63], a[0:3], v[16:19], 0
    s_nop 7
    s_nop 4
    v_max3_f32 v96, v48, v49, v96
    v_max3_f32 v96, v50, v51, v96
    v_max3_f32 v96, v52, v53, v96
    v_max3_f32 v96, v54, v55, v96
    v_max3_f32 v96, v56, v57, v96
    v_max3_f32 v96, v58, v59, v96
    v_max3_f32 v96, v60, v61, v96
    v_max3_f32 v96, v62, v63, v96
    v_mfma_f32_32x32x16_bf16 v[48:63], a[4:7], v[16:19], 0
    s_nop 7
    s_nop 4
    v_max3_f32 v96, v48, v49, v96
    v_max3_f32 v96, v50, v51, v96
    v_max3_f32 v96, v52, v53, v96
    v_max3_f32 v96, v54, v55, v96
    v_max3_f32 v96, v56, v57, v96
    v_max3_f32 v96, v58, v59, v96
    v_max3_f32 v96, v60, v61, v96
    v_max3_f32 v96, v62, v63, v96
    v_mfma_f32_32x32x16_bf16 v[48:63], a[8:11], v[16:19], 0
    s_nop 7
    s_nop 4
    v_max3_f32 v96, v48, v49, v96
    v_max3_f32 v96, v50, v51, v96
    v_max3_f32 v96, v52, v53, v96
    v_max3_f32 v96, v54, v55, v96
    v_max3_f32 v96, v56, v57, v96
    v_max3_f32 v96, v58, v59, v96
    v_max3_f32 v96, v60, v61, v96
    v_max3_f32 v96, v62, v63, v96
    v_mfma_f32_32x32x16_bf16 v[48:63], a[12:15], v[16:19], 0
    s_nop 7
    s_nop 4
    v_max3_f32 v96, v48, v49, v96
    v_max3_f32 v96, v50, v51, v96
    v_max3_f32 v96, v52, v53, v96
    v_max3_f32 v96, v54, v55, v96
    v_max3_f32 v96, v56, v57, v96
    v_max3_f32 v96, v58, v59, v96
    v_max3_f32 v96, v60, v61, v96
    v_max3_f32 v96, v62, v63, v96
    v_mfma_f32_32x32x16_bf16 v[48:63], a[16:19], v[16:19], 0
    s_nop 7
    s_nop 4
    v_max3_f32 v96, v48, v49, v96
    v_max3_f32 v96, v50, v51, v96
    v_max3_f32 v96, v52, v53, v96
    v_max3_f32 v96, v54, v55, v96
    v_max3_f32 v96, v56, v57, v96
    v_max3_f32 v96, v58, v59, v96
    v_max3_f32 v96, v60, v61, v96
    v_max3_f32 v96, v62, v63, v96
    v_mfma_f32_32x32x16_bf16 v[48:63], a[20:23], v[16:19], 0
    s_nop 7
    s_nop 4
    v_max3_f32 v96, v48, v49, v96
    v_max3_f32 v96, v50, v51, v96
    v_max3_f32 v96, v52, v53, v96
    v_max3_f32 v96, v54, v55, v96
    v_max3_f32 v96, v56, v57, v96
    v_max3_f32 v96, v58, v59, v96
    v_max3_f32 v96, v60, v61, v96
    v_max3_f32 v96, v62, v63, v96
    v_mfma_f32_32x32x16_bf16 v[48:63], a[24:27], v[16:19], 0
    s_nop 7
    s_nop 4
    v_max3_f32 v96, v48, v49, v96
    v_max3_f32 v96, v50, v51, v96
    v_max3_f32 v96, v52, v53, v96
    v_max3_f32 v96, v54, v55, v96
    v_max3_f32 v96, v56, v57, v96
    v_max3_f32 v96, v58, v59, v96
    v_max3_f32 v96, v60, v61, v96
    v_max3_f32 v96, v62, v63, v96
    v_mfma_f32_32x32x16_bf16 v[48:63], a[28:31], v[16:19], 0
    s_nop 7
    s_nop 4
    v_max3_f32 v96, v48, v49, v96
    v_max3_f32 v96, v50, v51, v96
    v_max3_f32 v96, v52, v53, v96
    v_max3_f32 v96, v54, v55, v96
    v_max3_f32 v96, v56, v57, v96
    v_max3_f32 v96, v58, v59, v96
    v_max3_f32 v96, v60, v61, v96
    v_max3_f32 v96, v62, v63, v96
    v_mfma_f32_32x32x16_bf16 v[48:63], a[32:35], v[16:19], 0
    s_nop 7
    s_nop 4
    v_max3_f32 v96, v48, v49, v96
    v_max3_f32 v96, v50, v51, v96
    v_max3_f32 v96, v52, v53, v96
    v_max3_f32 v96, v54, v55, v96
    v_max3_f32 v96, v56, v57, v96
    v_max3_f32 v96, v58, v59, v96
    v_max3_f32 v96, v60, v61, v96
    v_max3_f32 v96, v62, v63, v96
    v_mfma_f32_32x32x16_bf16 v[48:63], a[36:39], v[16:19], 0
    s_nop 7
    s_nop 4
    v_max3_f32 v96, v48, v49, v96
    v_max3_f32 v96, v50, v51, v96
    v_max3_f32 v96, v52, v53, v96
    v_max3_f32 v96, v54, v55, v96
    v_max3_f32 v96, v56, v57, v96
    v_max3_f32 v96, v58, v59, v96
    v_max3_f32 v96, v60, v61, v96
    v_max3_f32 v96, v62, v63, v96
    v_mfma_f32_32x32x16_bf16 v[48:63], a[40:43], v[16:19], 0
    s_nop 7
    s_nop 4
    v_max3_f32 v96, v48, v49, v96
    v_max3_f32 v96, v50, v51, v96
    v_max3_f32 v96, v52, v53, v96
    v_max3_f32 v96, v54, v55, v96
    v_max3_f32 v96, v56, v57, v96
    v_max3_f32 v96, v58, v59, v96
    v_max3_f32 v96, v60, v61, v96
    v_max3_f32 v96, v62, v63, v96
    v_mfma_f32_32x32x16_bf16 v[48:63], a[44:47], v[16:19], 0
    s_nop 7
    s_nop 4
    v_max3_f32 v96, v48, v49, v96
    v_max3_f32 v96, v50, v51, v96
    v_max3_f32 v96, v52, v53, v96
    v_max3_f32 v96, v54, v55, v96
    v_max3_f32 v96, v56, v57, v96
    v_max3_f32 v96, v58, v59, v96
    v_max3_f32 v96, v60, v61, v96
    v_max3_f32 v96, v62, v63, v96
    v_mfma_f32_32x32x16_bf16 v[48:63], a[48:51], v[16:19], 0
    s_nop 7
    s_nop 4
    v_max3_f32 v96, v48, v49, v96
    v_max3_f32 v96, v50, v51, v96
    v_max3_f32 v96, v52, v53, v96
    v_max3_f32 v96, v54, v55, v96
    v_max3_f32 v96, v56, v57, v96
    v_max3_f32 v96, v58, v59, v96
    v_max3_f32 v96, v60, v61, v96
    v_max3_f32 v96, v62, v63, v96
    v_mfma_f32_32x32x16_bf16 v[48:63], a[52:55], v[16:19], 0
    s_nop 7
    s_nop 4
    v_max3_f32 v96, v48, v49, v96
    v_max3_f32 v96, v50, v51, v96
    v_max3_f32 v96, v52, v53, v96
    v_max3_f32 v96, v54, v55, v96
    v_max3_f32 v96, v56, v57, v96
    v_max3_f32 v96, v58, v59, v96
    v_max3_f32 v96, v60, v61, v96
    v_max3_f32 v96, v62, v63, v96
    v_mfma_f32_32x32x16_bf16 v[48:63], a[56:59], v[16:19], 0
    s_nop 7
    s_nop 4
    v_max3_f32 v96, v48, v49, v96
    v_max3_f32 v96, v50, v51, v96
    v_max3_f32 v96, v52, v53, v96
    v_max3_f32 v96, v54, v55, v96
    v_max3_f32 v96, v56, v57, v96
    v_max3_f32 v96, v58, v59, v96
    v_max3_f32 v96, v60, v61, v96
    v_max3_f32 v96, v62, v63, v96
    v_mfma_f32_32x32x16_bf16 v[48:63], a[60:63], v[16:19], 0
    s_nop 7
    s_nop 4
    v_max3_f32 v96, v48, v49, v96
    v_max3_f32 v96, v50, v51, v96
    v_max3_f32 v96, v52, v53, v96
    v_max3_f32 v96, v54, v55, v96
    v_max3_f32 v96, v56, v57, v96
    v_max3_f32 v96, v58, v59, v96
    v_max3_f32 v96, v60, v61, v96
    v_max3_f32 v96, v62, v63, v96
    ds_max_f32 v8, v96
    v_add_u32 v8, 128, v8
    v_mov_b32 v97, v16
    v_mov_b32 v98, v17
    v_mov_b32 v99, v18
    v_mov_b32 v100, v19
    v_mov_b32 v16, v20
    v_mov_b32 v17, v21
    v_mov_b32 v18, v22
    v_mov_b32 v19, v23
    v_mov_b32 v20, v24
    v_mov_b32 v21, v25
    v_mov_b32 v22, v26
    v_mov_b32 v23, v27
    v_mov_b32 v24, v28
    v_mov_b32 v25, v29
    v_mov_b32 v26, v30
    v_mov_b32 v27, v31
    v_mov_b32 v28, v32
    v_mov_b32 v29, v33
    v_mov_b32 v30, v34
    v_mov_b32 v31, v35
    v_mov_b32 v32, v36
    v_mov_b32 v33, v37
    v_mov_b32 v34, v38
    v_mov_b32 v35, v39
    v_mov_b32 v36, v40
    v_mov_b32 v37, v41
    v_mov_b32 v38, v42
    v_mov_b32 v39, v43
    v_mov_b32 v40, v44
    v_mov_b32 v41, v45
    v_mov_b32 v42, v46
    v_mov_b32 v43, v47
    v_mov_b32 v44, v97
    v_mov_b32 v45, v98
    v_mov_b32 v46, v99
    v_mov_b32 v47, v100
    s_waitcnt lgkmcnt(0)
    s_add_u32 s42, s42, 1
    s_cmp_lt_u32 s42, 8
    s_cbranch_scc1 L_p1_94
    s_barrier
    v_subrev_u32 v8, 1024, v8
    s_mul_i32 s48, s3, 16384
    v_add_u32 v3, s48, v2
    s_mov_b32 s42, 0
L_p2_95:
    ds_read_b32 v96, v8
    s_waitcnt lgkmcnt(0)
    v_sub_f32 v64, 0, v96
    v_sub_f32 v65, 0, v96
    v_sub_f32 v66, 0, v96
    v_sub_f32 v67, 0, v96
    v_sub_f32 v68, 0, v96
    v_sub_f32 v69, 0, v96
    v_sub_f32 v70, 0, v96
    v_sub_f32 v71, 0, v96
    v_sub_f32 v72, 0, v96
    v_sub_f32 v73, 0, v96
    v_sub_f32 v74, 0, v96
    v_sub_f32 v75, 0, v96
    v_sub_f32 v76, 0, v96
    v_sub_f32 v77, 0, v96
    v_sub_f32 v78, 0, v96
    v_sub_f32 v79, 0, v96
    v_mov_b32 v80, 0
    v_mov_b32 v81, 0
    v_mov_b32 v82, 0
    v_mov_b32 v83, 0
    v_mov_b32 v84, 0
    v_mov_b32 v85, 0
    v_mov_b32 v86, 0
    v_mov_b32 v87, 0
    v_mov_b32 v88, 0
    v_mov_b32 v89, 0
    v_mov_b32 v90, 0
    v_mov_b32 v91, 0
    v_mov_b32 v92, 0
    v_mov_b32 v93, 0
    v_mov_b32 v94, 0
    v_mov_b32 v95, 0
    s_nop 1
    v_mfma_f32_32x32x16_bf16 v[48:63], a[0:3], v[16:19], v[64:79]
    s_nop 7
    s_nop 4
    v_exp_f32 v48, v48
    v_exp_f32 v49, v49
    v_exp_f32 v50, v50
    v_exp_f32 v51, v51
    v_exp_f32 v52, v52
    v_exp_f32 v53, v53
    v_exp_f32 v54, v54
    v_exp_f32 v55, v55
    v_exp_f32 v56, v56
    v_exp_f32 v57, v57
    v_exp_f32 v58, v58
    v_exp_f32 v59, v59
    v_exp_f32 v60, v60
    v_exp_f32 v61, v61
    v_exp_f32 v62, v62
    v_exp_f32 v63, v63
    s_nop 1
    v_smfmac_f32_32x32x32_bf16 v[80:95], a[64:67], v[48:55], v5
    v_smfmac_f32_32x32x32_bf16 v[80:95], a[68:71], v[56:63], v5
    v_mfma_f32_32x32x16_bf16 v[48:63], a[4:7], v[16:19], v[64:79]
    s_nop 7
    s_nop 4
    v_exp_f32 v48, v48
    v_exp_f32 v49, v49
    v_exp_f32 v50, v50
    v_exp_f32 v51, v51
    v_exp_f32 v52, v52
    v_exp_f32 v53, v53
    v_exp_f32 v54, v54
    v_exp_f32 v55, v55
    v_exp_f32 v56, v56
    v_exp_f32 v57, v57
    v_exp_f32 v58, v58
    v_exp_f32 v59, v59
    v_exp_f32 v60, v60
    v_exp_f32 v61, v61
    v_exp_f32 v62, v62
    v_exp_f32 v63, v63
    s_nop 1
    v_smfmac_f32_32x32x32_bf16 v[80:95], a[72:75], v[48:55], v5
    v_smfmac_f32_32x32x32_bf16 v[80:95], a[76:79], v[56:63], v5
    v_mfma_f32_32x32x16_bf16 v[48:63], a[8:11], v[16:19], v[64:79]
    s_nop 7
    s_nop 4
    v_exp_f32 v48, v48
    v_exp_f32 v49, v49
    v_exp_f32 v50, v50
    v_exp_f32 v51, v51
    v_exp_f32 v52, v52
    v_exp_f32 v53, v53
    v_exp_f32 v54, v54
    v_exp_f32 v55, v55
    v_exp_f32 v56, v56
    v_exp_f32 v57, v57
    v_exp_f32 v58, v58
    v_exp_f32 v59, v59
    v_exp_f32 v60, v60
    v_exp_f32 v61, v61
    v_exp_f32 v62, v62
    v_exp_f32 v63, v63
    s_nop 1
    v_smfmac_f32_32x32x32_bf16 v[80:95], a[80:83], v[48:55], v5
    v_smfmac_f32_32x32x32_bf16 v[80:95], a[84:87], v[56:63], v5
    v_mfma_f32_32x32x16_bf16 v[48:63], a[12:15], v[16:19], v[64:79]
    s_nop 7
    s_nop 4
    v_exp_f32 v48, v48
    v_exp_f32 v49, v49
    v_exp_f32 v50, v50
    v_exp_f32 v51, v51
    v_exp_f32 v52, v52
    v_exp_f32 v53, v53
    v_exp_f32 v54, v54
    v_exp_f32 v55, v55
    v_exp_f32 v56, v56
    v_exp_f32 v57, v57
    v_exp_f32 v58, v58
    v_exp_f32 v59, v59
    v_exp_f32 v60, v60
    v_exp_f32 v61, v61
    v_exp_f32 v62, v62
    v_exp_f32 v63, v63
    s_nop 1
    v_smfmac_f32_32x32x32_bf16 v[80:95], a[88:91], v[48:55], v5
    v_smfmac_f32_32x32x32_bf16 v[80:95], a[92:95], v[56:63], v5
    v_mfma_f32_32x32x16_bf16 v[48:63], a[16:19], v[16:19], v[64:79]
    s_nop 7
    s_nop 4
    v_exp_f32 v48, v48
    v_exp_f32 v49, v49
    v_exp_f32 v50, v50
    v_exp_f32 v51, v51
    v_exp_f32 v52, v52
    v_exp_f32 v53, v53
    v_exp_f32 v54, v54
    v_exp_f32 v55, v55
    v_exp_f32 v56, v56
    v_exp_f32 v57, v57
    v_exp_f32 v58, v58
    v_exp_f32 v59, v59
    v_exp_f32 v60, v60
    v_exp_f32 v61, v61
    v_exp_f32 v62, v62
    v_exp_f32 v63, v63
    s_nop 1
    v_smfmac_f32_32x32x32_bf16 v[80:95], a[96:99], v[48:55], v5
    v_smfmac_f32_32x32x32_bf16 v[80:95], a[100:103], v[56:63], v5
    v_mfma_f32_32x32x16_bf16 v[48:63], a[20:23], v[16:19], v[64:79]
    s_nop 7
    s_nop 4
    v_exp_f32 v48, v48
    v_exp_f32 v49, v49
    v_exp_f32 v50, v50
    v_exp_f32 v51, v51
    v_exp_f32 v52, v52
    v_exp_f32 v53, v53
    v_exp_f32 v54, v54
    v_exp_f32 v55, v55
    v_exp_f32 v56, v56
    v_exp_f32 v57, v57
    v_exp_f32 v58, v58
    v_exp_f32 v59, v59
    v_exp_f32 v60, v60
    v_exp_f32 v61, v61
    v_exp_f32 v62, v62
    v_exp_f32 v63, v63
    s_nop 1
    v_smfmac_f32_32x32x32_bf16 v[80:95], a[104:107], v[48:55], v5
    v_smfmac_f32_32x32x32_bf16 v[80:95], a[108:111], v[56:63], v5
    v_mfma_f32_32x32x16_bf16 v[48:63], a[24:27], v[16:19], v[64:79]
    s_nop 7
    s_nop 4
    v_exp_f32 v48, v48
    v_exp_f32 v49, v49
    v_exp_f32 v50, v50
    v_exp_f32 v51, v51
    v_exp_f32 v52, v52
    v_exp_f32 v53, v53
    v_exp_f32 v54, v54
    v_exp_f32 v55, v55
    v_exp_f32 v56, v56
    v_exp_f32 v57, v57
    v_exp_f32 v58, v58
    v_exp_f32 v59, v59
    v_exp_f32 v60, v60
    v_exp_f32 v61, v61
    v_exp_f32 v62, v62
    v_exp_f32 v63, v63
    s_nop 1
    v_smfmac_f32_32x32x32_bf16 v[80:95], a[112:115], v[48:55], v5
    v_smfmac_f32_32x32x32_bf16 v[80:95], a[116:119], v[56:63], v5
    v_mfma_f32_32x32x16_bf16 v[48:63], a[28:31], v[16:19], v[64:79]
    s_nop 7
    s_nop 4
    v_exp_f32 v48, v48
    v_exp_f32 v49, v49
    v_exp_f32 v50, v50
    v_exp_f32 v51, v51
    v_exp_f32 v52, v52
    v_exp_f32 v53, v53
    v_exp_f32 v54, v54
    v_exp_f32 v55, v55
    v_exp_f32 v56, v56
    v_exp_f32 v57, v57
    v_exp_f32 v58, v58
    v_exp_f32 v59, v59
    v_exp_f32 v60, v60
    v_exp_f32 v61, v61
    v_exp_f32 v62, v62
    v_exp_f32 v63, v63
    s_nop 1
    v_smfmac_f32_32x32x32_bf16 v[80:95], a[120:123], v[48:55], v5
    v_smfmac_f32_32x32x32_bf16 v[80:95], a[124:127], v[56:63], v5
    v_mfma_f32_32x32x16_bf16 v[48:63], a[32:35], v[16:19], v[64:79]
    s_nop 7
    s_nop 4
    v_exp_f32 v48, v48
    v_exp_f32 v49, v49
    v_exp_f32 v50, v50
    v_exp_f32 v51, v51
    v_exp_f32 v52, v52
    v_exp_f32 v53, v53
    v_exp_f32 v54, v54
    v_exp_f32 v55, v55
    v_exp_f32 v56, v56
    v_exp_f32 v57, v57
    v_exp_f32 v58, v58
    v_exp_f32 v59, v59
    v_exp_f32 v60, v60
    v_exp_f32 v61, v61
    v_exp_f32 v62, v62
    v_exp_f32 v63, v63
    s_nop 1
    v_smfmac_f32_32x32x32_bf16 v[80:95], a[128:131], v[48:55], v5
    v_smfmac_f32_32x32x32_bf16 v[80:95], a[132:135], v[56:63], v5
    v_mfma_f32_32x32x16_bf16 v[48:63], a[36:39], v[16:19], v[64:79]
    s_nop 7
    s_nop 4
    v_exp_f32 v48, v48
    v_exp_f32 v49, v49
    v_exp_f32 v50, v50
    v_exp_f32 v51, v51
    v_exp_f32 v52, v52
    v_exp_f32 v53, v53
    v_exp_f32 v54, v54
    v_exp_f32 v55, v55
    v_exp_f32 v56, v56
    v_exp_f32 v57, v57
    v_exp_f32 v58, v58
    v_exp_f32 v59, v59
    v_exp_f32 v60, v60
    v_exp_f32 v61, v61
    v_exp_f32 v62, v62
    v_exp_f32 v63, v63
    s_nop 1
    v_smfmac_f32_32x32x32_bf16 v[80:95], a[136:139], v[48:55], v5
    v_smfmac_f32_32x32x32_bf16 v[80:95], a[140:143], v[56:63], v5
    v_mfma_f32_32x32x16_bf16 v[48:63], a[40:43], v[16:19], v[64:79]
    s_nop 7
    s_nop 4
    v_exp_f32 v48, v48
    v_exp_f32 v49, v49
    v_exp_f32 v50, v50
    v_exp_f32 v51, v51
    v_exp_f32 v52, v52
    v_exp_f32 v53, v53
    v_exp_f32 v54, v54
    v_exp_f32 v55, v55
    v_exp_f32 v56, v56
    v_exp_f32 v57, v57
    v_exp_f32 v58, v58
    v_exp_f32 v59, v59
    v_exp_f32 v60, v60
    v_exp_f32 v61, v61
    v_exp_f32 v62, v62
    v_exp_f32 v63, v63
    s_nop 1
    v_smfmac_f32_32x32x32_bf16 v[80:95], a[144:147], v[48:55], v5
    v_smfmac_f32_32x32x32_bf16 v[80:95], a[148:151], v[56:63], v5
    v_mfma_f32_32x32x16_bf16 v[48:63], a[44:47], v[16:19], v[64:79]
    s_nop 7
    s_nop 4
    v_exp_f32 v48, v48
    v_exp_f32 v49, v49
    v_exp_f32 v50, v50
    v_exp_f32 v51, v51
    v_exp_f32 v52, v52
    v_exp_f32 v53, v53
    v_exp_f32 v54, v54
    v_exp_f32 v55, v55
    v_exp_f32 v56, v56
    v_exp_f32 v57, v57
    v_exp_f32 v58, v58
    v_exp_f32 v59, v59
    v_exp_f32 v60, v60
    v_exp_f32 v61, v61
    v_exp_f32 v62, v62
    v_exp_f32 v63, v63
    s_nop 1
    v_smfmac_f32_32x32x32_bf16 v[80:95], a[152:155], v[48:55], v5
    v_smfmac_f32_32x32x32_bf16 v[80:95], a[156:159], v[56:63], v5
    v_mfma_f32_32x32x16_bf16 v[48:63], a[48:51], v[16:19], v[64:79]
    s_nop 7
    s_nop 4
    v_exp_f32 v48, v48
    v_exp_f32 v49, v49
    v_exp_f32 v50, v50
    v_exp_f32 v51, v51
    v_exp_f32 v52, v52
    v_exp_f32 v53, v53
    v_exp_f32 v54, v54
    v_exp_f32 v55, v55
    v_exp_f32 v56, v56
    v_exp_f32 v57, v57
    v_exp_f32 v58, v58
    v_exp_f32 v59, v59
    v_exp_f32 v60, v60
    v_exp_f32 v61, v61
    v_exp_f32 v62, v62
    v_exp_f32 v63, v63
    s_nop 1
    v_smfmac_f32_32x32x32_bf16 v[80:95], a[160:163], v[48:55], v5
    v_smfmac_f32_32x32x32_bf16 v[80:95], a[164:167], v[56:63], v5
    v_mfma_f32_32x32x16_bf16 v[48:63], a[52:55], v[16:19], v[64:79]
    s_nop 7
    s_nop 4
    v_exp_f32 v48, v48
    v_exp_f32 v49, v49
    v_exp_f32 v50, v50
    v_exp_f32 v51, v51
    v_exp_f32 v52, v52
    v_exp_f32 v53, v53
    v_exp_f32 v54, v54
    v_exp_f32 v55, v55
    v_exp_f32 v56, v56
    v_exp_f32 v57, v57
    v_exp_f32 v58, v58
    v_exp_f32 v59, v59
    v_exp_f32 v60, v60
    v_exp_f32 v61, v61
    v_exp_f32 v62, v62
    v_exp_f32 v63, v63
    s_nop 1
    v_smfmac_f32_32x32x32_bf16 v[80:95], a[168:171], v[48:55], v5
    v_smfmac_f32_32x32x32_bf16 v[80:95], a[172:175], v[56:63], v5
    v_mfma_f32_32x32x16_bf16 v[48:63], a[56:59], v[16:19], v[64:79]
    s_nop 7
    s_nop 4
    v_exp_f32 v48, v48
    v_exp_f32 v49, v49
    v_exp_f32 v50, v50
    v_exp_f32 v51, v51
    v_exp_f32 v52, v52
    v_exp_f32 v53, v53
    v_exp_f32 v54, v54
    v_exp_f32 v55, v55
    v_exp_f32 v56, v56
    v_exp_f32 v57, v57
    v_exp_f32 v58, v58
    v_exp_f32 v59, v59
    v_exp_f32 v60, v60
    v_exp_f32 v61, v61
    v_exp_f32 v62, v62
    v_exp_f32 v63, v63
    s_nop 1
    v_smfmac_f32_32x32x32_bf16 v[80:95], a[176:179], v[48:55], v5
    v_smfmac_f32_32x32x32_bf16 v[80:95], a[180:183], v[56:63], v5
    v_mfma_f32_32x32x16_bf16 v[48:63], a[60:63], v[16:19], v[64:79]
    s_nop 7
    s_nop 4
    v_exp_f32 v48, v48
    v_exp_f32 v49, v49
    v_exp_f32 v50, v50
    v_exp_f32 v51, v51
    v_exp_f32 v52, v52
    v_exp_f32 v53, v53
    v_exp_f32 v54, v54
    v_exp_f32 v55, v55
    v_exp_f32 v56, v56
    v_exp_f32 v57, v57
    v_exp_f32 v58, v58
    v_exp_f32 v59, v59
    v_exp_f32 v60, v60
    v_exp_f32 v61, v61
    v_exp_f32 v62, v62
    v_exp_f32 v63, v63
    s_nop 1
    v_smfmac_f32_32x32x32_bf16 v[80:95], a[184:187], v[48:55], v5
    v_smfmac_f32_32x32x32_bf16 v[80:95], a[188:191], v[56:63], v5
    s_nop 7
    s_nop 4
    ds_write_b128 v3, v[80:83] offset:0
    ds_write_b128 v3, v[84:87] offset:1024
    s_mov_b32 exec_hi, 0
    ds_write_b32 v11, v88 offset:0
    s_mov_b32 exec_hi, -1
    v_add_u32 v8, 128, v8
    v_mov_b32 v97, v16
    v_mov_b32 v98, v17
    v_mov_b32 v99, v18
    v_mov_b32 v100, v19
    v_mov_b32 v16, v20
    v_mov_b32 v17, v21
    v_mov_b32 v18, v22
    v_mov_b32 v19, v23
    v_mov_b32 v20, v24
    v_mov_b32 v21, v25
    v_mov_b32 v22, v26
    v_mov_b32 v23, v27
    v_mov_b32 v24, v28
    v_mov_b32 v25, v29
    v_mov_b32 v26, v30
    v_mov_b32 v27, v31
    v_mov_b32 v28, v32
    v_mov_b32 v29, v33
    v_mov_b32 v30, v34
    v_mov_b32 v31, v35
    v_mov_b32 v32, v36
    v_mov_b32 v33, v37
    v_mov_b32 v34, v38
    v_mov_b32 v35, v39
    v_mov_b32 v36, v40
    v_mov_b32 v37, v41
    v_mov_b32 v38, v42
    v_mov_b32 v39, v43
    v_mov_b32 v40, v44
    v_mov_b32 v41, v45
    v_mov_b32 v42, v46
    v_mov_b32 v43, v47
    v_mov_b32 v44, v97
    v_mov_b32 v45, v98
    v_mov_b32 v46, v99
    v_mov_b32 v47, v100
    s_waitcnt lgkmcnt(0)
    v_add_u32 v3, 2048, v3
    v_add_u32 v11, 128, v11
    s_add_u32 s42, s42, 1
    s_cmp_lt_u32 s42, 8
    s_cbranch_scc1 L_p2_95
    v_lshrrev_b32 v0, 4, v1
    v_lshlrev_b32 v0, 8, v0
    v_and_b32 v48, 15, v1
    v_lshl_add_u32 v0, v48, 2, v0
    v_add_u32 v0, s40, v0
    s_barrier
    ds_read_b32 v88, v0 offset:0
    ds_read_b32 v89, v0 offset:1024
    ds_read_b32 v90, v0 offset:2048
    ds_read_b32 v91, v0 offset:3072
    ds_read_b128 v[16:19], v4 offset:0
    ds_read_b128 v[20:23], v4 offset:512
    ds_read_b128 v[24:27], v4 offset:1024
    ds_read_b128 v[28:31], v4 offset:1536
    ds_read_b128 v[32:35], v4 offset:16384
    ds_read_b128 v[36:39], v4 offset:16896
    ds_read_b128 v[40:43], v4 offset:17408
    ds_read_b128 v[44:47], v4 offset:17920
    ds_read_b128 v[48:51], v4 offset:32768
    ds_read_b128 v[52:55], v4 offset:33280
    ds_read_b128 v[56:59], v4 offset:33792
    ds_read_b128 v[60:63], v4 offset:34304
    ds_read_b128 v[64:67], v4 offset:49152
    ds_read_b128 v[68:71], v4 offset:49664
    ds_read_b128 v[72:75], v4 offset:50176
    ds_read_b128 v[76:79], v4 offset:50688
    s_waitcnt lgkmcnt(8)
    v_add_f32 v88, v88, v89
    v_add_f32 v90, v90, v91
    v_pk_add_f32 v[16:17], v[16:17], v[32:33]
    v_pk_add_f32 v[18:19], v[18:19], v[34:35]
    v_pk_add_f32 v[20:21], v[20:21], v[36:37]
    v_pk_add_f32 v[22:23], v[22:23], v[38:39]
    v_pk_add_f32 v[24:25], v[24:25], v[40:41]
    v_pk_add_f32 v[26:27], v[26:27], v[42:43]
    v_pk_add_f32 v[28:29], v[28:29], v[44:45]
    v_pk_add_f32 v[30:31], v[30:31], v[46:47]
    v_add_f32 v88, v88, v90
    v_rcp_f32 v90, v88
    v_subrev_u32 v8, s52, v88
    s_waitcnt lgkmcnt(0)
    v_pk_add_f32 v[48:49], v[48:49], v[64:65]
    v_pk_add_f32 v[50:51], v[50:51], v[66:67]
    v_pk_add_f32 v[52:53], v[52:53], v[68:69]
    v_pk_add_f32 v[54:55], v[54:55], v[70:71]
    v_pk_add_f32 v[56:57], v[56:57], v[72:73]
    v_pk_add_f32 v[58:59], v[58:59], v[74:75]
    v_pk_add_f32 v[60:61], v[60:61], v[76:77]
    v_pk_add_f32 v[62:63], v[62:63], v[78:79]
    v_pk_add_f32 v[16:17], v[16:17], v[48:49]
    v_pk_add_f32 v[18:19], v[18:19], v[50:51]
    v_pk_add_f32 v[20:21], v[20:21], v[52:53]
    v_pk_add_f32 v[22:23], v[22:23], v[54:55]
    v_pk_add_f32 v[24:25], v[24:25], v[56:57]
    v_pk_add_f32 v[26:27], v[26:27], v[58:59]
    v_pk_add_f32 v[28:29], v[28:29], v[60:61]
    v_pk_add_f32 v[30:31], v[30:31], v[62:63]
    v_pk_mul_f32 v[16:17], v[16:17], v[90:91] op_sel_hi:[1,0]
    v_pk_mul_f32 v[18:19], v[18:19], v[90:91] op_sel_hi:[1,0]
    v_pk_mul_f32 v[20:21], v[20:21], v[90:91] op_sel_hi:[1,0]
    v_pk_mul_f32 v[22:23], v[22:23], v[90:91] op_sel_hi:[1,0]
    v_pk_mul_f32 v[24:25], v[24:25], v[90:91] op_sel_hi:[1,0]
    v_pk_mul_f32 v[26:27], v[26:27], v[90:91] op_sel_hi:[1,0]
    v_pk_mul_f32 v[28:29], v[28:29], v[90:91] op_sel_hi:[1,0]
    v_pk_mul_f32 v[30:31], v[30:31], v[90:91] op_sel_hi:[1,0]
    v_cvt_pk_bf16_f32 v80, v16, v17
    v_cvt_pk_bf16_f32 v81, v18, v19
    v_cvt_pk_bf16_f32 v82, v20, v21
    v_cvt_pk_bf16_f32 v83, v22, v23
    v_cvt_pk_bf16_f32 v84, v24, v25
    v_cvt_pk_bf16_f32 v85, v26, v27
    v_cvt_pk_bf16_f32 v86, v28, v29
    v_cvt_pk_bf16_f32 v87, v30, v31
    s_lshl_b32 s48, s3, 10
    buffer_store_dwordx4 v[80:83], v2, s[24:27], s48 offen
    s_add_u32 s48, s48, 4096
    buffer_store_dwordx4 v[84:87], v2, s[24:27], s48 offen
    s_add_u32 s48, s48, 4096
    v_mov_b32 v3, 159744
    s_add_u32 s50, s55, 0
    buffer_load_dwordx4 a[0:3], v2, s[20:23], s50 offen offset:0 sc1
    buffer_load_dwordx4 a[64:67], v2, s[20:23], s50 offen offset:1024 sc1
    buffer_load_dwordx4 a[68:71], v2, s[20:23], s50 offen offset:2048 sc1
    buffer_load_dwordx4 a[4:7], v2, s[20:23], s50 offen offset:3072 sc1
    s_add_u32 s50, s55, 4096
    buffer_load_dwordx4 a[72:75], v2, s[20:23], s50 offen offset:0 sc1
    buffer_load_dwordx4 a[76:79], v2, s[20:23], s50 offen offset:1024 sc1
    buffer_load_dwordx4 a[8:11], v2, s[20:23], s50 offen offset:2048 sc1
    buffer_load_dwordx4 a[80:83], v2, s[20:23], s50 offen offset:3072 sc1
    s_add_u32 s50, s55, 8192
    buffer_load_dwordx4 a[84:87], v2, s[20:23], s50 offen offset:0 sc1
    buffer_load_dwordx4 a[12:15], v2, s[20:23], s50 offen offset:1024 sc1
    buffer_load_dwordx4 a[88:91], v2, s[20:23], s50 offen offset:2048 sc1
    buffer_load_dwordx4 a[92:95], v2, s[20:23], s50 offen offset:3072 sc1
    s_add_u32 s50, s55, 12288
    buffer_load_dwordx4 a[16:19], v2, s[20:23], s50 offen offset:0 sc1
    buffer_load_dwordx4 a[96:99], v2, s[20:23], s50 offen offset:1024 sc1
    buffer_load_dwordx4 a[100:103], v2, s[20:23], s50 offen offset:2048 sc1
    buffer_load_dwordx4 a[20:23], v2, s[20:23], s50 offen offset:3072 sc1
    s_add_u32 s50, s55, 16384
    buffer_load_dwordx4 a[104:107], v2, s[20:23], s50 offen offset:0 sc1
    buffer_load_dwordx4 a[108:111], v2, s[20:23], s50 offen offset:1024 sc1
    buffer_load_dwordx4 a[24:27], v2, s[20:23], s50 offen offset:2048 sc1
    buffer_load_dwordx4 a[112:115], v2, s[20:23], s50 offen offset:3072 sc1
    s_add_u32 s50, s55, 20480
    buffer_load_dwordx4 a[116:119], v2, s[20:23], s50 offen offset:0 sc1
    buffer_load_dwordx4 a[28:31], v2, s[20:23], s50 offen offset:1024 sc1
    buffer_load_dwordx4 a[120:123], v2, s[20:23], s50 offen offset:2048 sc1
    buffer_load_dwordx4 a[124:127], v2, s[20:23], s50 offen offset:3072 sc1
    s_add_u32 s50, s55, 24576
    buffer_load_dwordx4 a[32:35], v2, s[20:23], s50 offen offset:0 sc1
    buffer_load_dwordx4 a[128:131], v2, s[20:23], s50 offen offset:1024 sc1
    buffer_load_dwordx4 a[132:135], v2, s[20:23], s50 offen offset:2048 sc1
    buffer_load_dwordx4 a[36:39], v2, s[20:23], s50 offen offset:3072 sc1
    s_add_u32 s50, s55, 28672
    buffer_load_dwordx4 a[136:139], v2, s[20:23], s50 offen offset:0 sc1
    buffer_load_dwordx4 a[140:143], v2, s[20:23], s50 offen offset:1024 sc1
    buffer_load_dwordx4 a[40:43], v2, s[20:23], s50 offen offset:2048 sc1
    buffer_load_dwordx4 a[144:147], v2, s[20:23], s50 offen offset:3072 sc1
    s_add_u32 s50, s55, 32768
    buffer_load_dwordx4 a[148:151], v2, s[20:23], s50 offen offset:0 sc1
    buffer_load_dwordx4 a[44:47], v2, s[20:23], s50 offen offset:1024 sc1
    buffer_load_dwordx4 a[152:155], v2, s[20:23], s50 offen offset:2048 sc1
    buffer_load_dwordx4 a[156:159], v2, s[20:23], s50 offen offset:3072 sc1
    s_add_u32 s50, s55, 36864
    buffer_load_dwordx4 a[48:51], v2, s[20:23], s50 offen offset:0 sc1
    buffer_load_dwordx4 a[160:163], v2, s[20:23], s50 offen offset:1024 sc1
    buffer_load_dwordx4 a[164:167], v2, s[20:23], s50 offen offset:2048 sc1
    buffer_load_dwordx4 a[52:55], v2, s[20:23], s50 offen offset:3072 sc1
    s_add_u32 s50, s55, 40960
    buffer_load_dwordx4 a[168:171], v2, s[20:23], s50 offen offset:0 sc1
    buffer_load_dwordx4 a[172:175], v2, s[20:23], s50 offen offset:1024 sc1
    s_barrier
    s_branch L_back_52
L_code_end:
.section .rodata,"a"
.p2align 6
.amdhsa_kernel interleave_layers__grouped_kv_mqa__dense_activation_silu__prompt_kernel
  .amdhsa_next_free_vgpr 512
  .amdhsa_next_free_sgpr 72
  .amdhsa_accum_offset 256
  .amdhsa_group_segment_fixed_size 0
  .amdhsa_kernarg_size 88
  .amdhsa_user_sgpr_count 2
  .amdhsa_user_sgpr_kernarg_segment_ptr 1
  .amdhsa_system_sgpr_workgroup_id_x 1
.end_amdhsa_kernel
```
